```python
import torch

def _softmax(x, axis=-1):
    return torch.softmax(x, dim=axis)
def _gelu(x):
    return torch.nn.functional.gelu(x, approximate="tanh")
def _silu(x):
    return torch.nn.functional.silu(x)
def _sigmoid(x):
    return torch.sigmoid(x)
def _layernorm(x, axis=-1, eps=1e-5):
    m = x.mean(dim=axis, keepdim=True)
    v = x.var(dim=axis, keepdim=True, unbiased=False)
    return (x - m) / torch.sqrt(v + eps)
def _scatter_add(tgt, idx, src, axis=0):
    return tgt.clone().index_add_(axis, idx, src)
def _segment_sum(src, seg, n):
    out = torch.zeros((n,) + src.shape[1:], dtype=src.dtype)
    return out.index_add_(0, seg, src)
def _pad(x, pw):
    flat = tuple(v for pair in reversed(pw) for v in pair)
    return torch.nn.functional.pad(x, flat)

kernel_name = 'standalone__mha_block_cached__near_ridge'

def setup_inputs():

    _w = (lambda a: (lambda t: t.to(torch.bfloat16) if t.is_floating_point() else t)(torch.as_tensor(a)))
    B, Sq, D = 8, 192, 448
    H, Sk, Dh = 16, 1024, 256
    return {
        "x": _w((lambda *s: torch.randn(*s, dtype=torch.bfloat16) * 0.8)(B, Sq, D)),
        "k_cache": _w((lambda *s: torch.randn(*s, dtype=torch.bfloat16) * 0.8)(B, H, Sk, Dh)),
        "v_cache": _w((lambda *s: torch.randn(*s, dtype=torch.bfloat16) * 0.05)(B, H, Sk, Dh)),
        "wq": _w((lambda *s: torch.randn(*s, dtype=torch.bfloat16) * 0.8)(D, H * Dh) * (D ** -0.5)),
        "wo": _w((lambda *s: torch.randn(*s, dtype=torch.bfloat16) * 0.05)(H * Dh, D) * ((H * Dh) ** -0.5)),
    }

def reference(x, k_cache, v_cache, wq, wo):
    B, Sq, D = x.shape
    H, Dh = 16, 256
    q = (lambda x, *d: x.permute(*d))((x @ wq).reshape(B, Sq, H, Dh), 0, 2, 1, 3)
    scores = torch.einsum("bhqd,bhkd->bhqk", q, k_cache) * (Dh ** -0.5)
    p = _softmax(scores, axis=-1)
    o = torch.einsum("bhqk,bhkd->bhqd", p, v_cache)
    return (lambda x, *d: x.permute(*d))(o, 0, 2, 1, 3).reshape(B, Sq, H * Dh) @ wo
```

```asm
; @launch kernel=attn_kernel grid=(256,1,1) block=(256,1,1) lds=131072
; @launch kernel=reduce_kernel grid=(336,1,1) block=(256,1,1) lds=0
.amdgcn_target "amdgcn-amd-amdhsa--gfx950"
.text
.globl attn_kernel
.p2align 8
.type attn_kernel,@function
attn_kernel:
    s_cmp_ge_u32 s2, 256
    s_cbranch_scc1 attn_kernel_end
    s_load_dwordx4 s[40:43], s[0:1], 0
    s_load_dwordx4 s[44:47], s[0:1], 16
    s_load_dwordx2 s[48:49], s[0:1], 56
    s_load_dwordx2 s[56:57], s[0:1], 32
    v_lshrrev_b32 v1, 6, v0
    s_nop 0
    v_readfirstlane_b32 s24, v1
    s_and_b32 s28, s2, 7
    s_lshr_b32 s29, s2, 3
    s_and_b32 s26, s29, 1
    s_lshr_b32 s27, s29, 2
    s_lshl_b32 s28, s28, 1
    s_bfe_u32 s29, s29, 0x10001
    s_add_u32 s28, s28, s29
    s_lshl_b32 s25, s27, 4
    s_add_u32 s25, s25, s28
    s_waitcnt lgkmcnt(0)
    s_mov_b32 s4, s40
    s_and_b32 s5, s41, 0xffff
    s_mov_b32 s6, 1376256
    s_mov_b32 s7, 0x00020000
    s_mov_b32 s8, s42
    s_and_b32 s9, s43, 0xffff
    s_mov_b32 s10, 67108864
    s_mov_b32 s11, 0x00020000
    s_mov_b32 s12, s44
    s_and_b32 s13, s45, 0xffff
    s_mov_b32 s14, 67108864
    s_mov_b32 s15, 0x00020000
    s_mov_b32 s16, s46
    s_and_b32 s17, s47, 0xffff
    s_mov_b32 s18, 3670016
    s_mov_b32 s19, 0x00020000
    s_mov_b32 s20, s48
    s_and_b32 s21, s49, 0xffff
    s_mov_b32 s22, 22020096
    s_mov_b32 s23, 0x00020000
    s_mov_b32 s64, s56
    s_and_b32 s65, s57, 0xffff
    s_mov_b32 s66, 3670016
    s_mov_b32 s67, 0x00020000
    s_cmp_lt_u32 s24, 3
    s_cbranch_scc1 attn_kernel_compute
attn_kernel_loader:
    v_and_b32 v1, 63, v0
    v_lshrrev_b32 v2, 5, v1
    v_and_b32 v3, 31, v1
    v_add_u32 v4, 0, v2
    v_and_b32 v4, 3, v4
    v_lshlrev_b32 v4, 2, v4
    v_xor_b32 v4, v4, v3
    v_lshlrev_b32 v4, 4, v4
    v_lshl_add_u32 v24, v2, 9, v4
    v_lshl_add_u32 v26, v2, 13, v4
    v_mul_u32_u24 v5, 896, v2
    v_add_u32 v28, v5, v4
    v_add_u32 v4, 2, v2
    v_and_b32 v4, 3, v4
    v_lshlrev_b32 v4, 2, v4
    v_xor_b32 v4, v4, v3
    v_lshlrev_b32 v4, 4, v4
    v_lshl_add_u32 v25, v2, 9, v4
    v_lshl_add_u32 v27, v2, 13, v4
    v_mul_u32_u24 v5, 896, v2
    v_add_u32 v29, v5, v4
    s_lshl_b32 s35, s25, 19
    s_lshl_b32 s36, s28, 9
    s_mul_i32 s37, s28, 256*896
    s_mov_b32 s39, 0
    s_mov_b32 s40, s36
    s_mov_b32 s41, s35
    s_mov_b32 s42, s35
    s_mov_b32 s43, s37
    s_add_u32 m0, s39, 0
    s_add_u32 s38, s40, 0
    buffer_load_dwordx4 v26, s[16:19], s38 offen lds
    s_add_u32 m0, s39, 1024
    s_add_u32 s38, s40, 16384
    buffer_load_dwordx4 v27, s[16:19], s38 offen lds
    s_add_u32 m0, s39, 2048
    s_add_u32 s38, s40, 32768
    buffer_load_dwordx4 v26, s[16:19], s38 offen lds
    s_add_u32 m0, s39, 3072
    s_add_u32 s38, s40, 49152
    buffer_load_dwordx4 v27, s[16:19], s38 offen lds
    s_add_u32 m0, s39, 4096
    s_add_u32 s38, s40, 65536
    buffer_load_dwordx4 v26, s[16:19], s38 offen lds
    s_add_u32 m0, s39, 5120
    s_add_u32 s38, s40, 81920
    buffer_load_dwordx4 v27, s[16:19], s38 offen lds
    s_add_u32 m0, s39, 6144
    s_add_u32 s38, s40, 98304
    buffer_load_dwordx4 v26, s[16:19], s38 offen lds
    s_add_u32 m0, s39, 7168
    s_add_u32 s38, s40, 114688
    buffer_load_dwordx4 v27, s[16:19], s38 offen lds
    s_add_u32 m0, s39, 8192
    s_add_u32 s38, s40, 131072
    buffer_load_dwordx4 v26, s[16:19], s38 offen lds
    s_add_u32 m0, s39, 9216
    s_add_u32 s38, s40, 147456
    buffer_load_dwordx4 v27, s[16:19], s38 offen lds
    s_add_u32 m0, s39, 10240
    s_add_u32 s38, s40, 163840
    buffer_load_dwordx4 v26, s[16:19], s38 offen lds
    s_add_u32 m0, s39, 11264
    s_add_u32 s38, s40, 180224
    buffer_load_dwordx4 v27, s[16:19], s38 offen lds
    s_add_u32 m0, s39, 12288
    s_add_u32 s38, s40, 196608
    buffer_load_dwordx4 v26, s[16:19], s38 offen lds
    s_add_u32 m0, s39, 13312
    s_add_u32 s38, s40, 212992
    buffer_load_dwordx4 v27, s[16:19], s38 offen lds
    s_add_u32 m0, s39, 14336
    s_add_u32 s38, s40, 229376
    buffer_load_dwordx4 v26, s[16:19], s38 offen lds
    s_add_u32 m0, s39, 15360
    s_add_u32 s38, s40, 245760
    buffer_load_dwordx4 v27, s[16:19], s38 offen lds
    s_add_u32 s40, s40, 262144
    s_add_u32 s39, s39, 0x4000
    s_and_b32 s39, s39, 0x1ffff
    s_add_u32 m0, s39, 0
    s_add_u32 s38, s40, 0
    buffer_load_dwordx4 v26, s[16:19], s38 offen lds
    s_add_u32 m0, s39, 1024
    s_add_u32 s38, s40, 16384
    buffer_load_dwordx4 v27, s[16:19], s38 offen lds
    s_add_u32 m0, s39, 2048
    s_add_u32 s38, s40, 32768
    buffer_load_dwordx4 v26, s[16:19], s38 offen lds
    s_add_u32 m0, s39, 3072
    s_add_u32 s38, s40, 49152
    buffer_load_dwordx4 v27, s[16:19], s38 offen lds
    s_add_u32 m0, s39, 4096
    s_add_u32 s38, s40, 65536
    buffer_load_dwordx4 v26, s[16:19], s38 offen lds
    s_add_u32 m0, s39, 5120
    s_add_u32 s38, s40, 81920
    buffer_load_dwordx4 v27, s[16:19], s38 offen lds
    s_add_u32 m0, s39, 6144
    s_add_u32 s38, s40, 98304
    buffer_load_dwordx4 v26, s[16:19], s38 offen lds
    s_add_u32 m0, s39, 7168
    s_add_u32 s38, s40, 114688
    buffer_load_dwordx4 v27, s[16:19], s38 offen lds
    s_add_u32 m0, s39, 8192
    s_add_u32 s38, s40, 131072
    buffer_load_dwordx4 v26, s[16:19], s38 offen lds
    s_add_u32 m0, s39, 9216
    s_add_u32 s38, s40, 147456
    buffer_load_dwordx4 v27, s[16:19], s38 offen lds
    s_add_u32 m0, s39, 10240
    s_add_u32 s38, s40, 163840
    buffer_load_dwordx4 v26, s[16:19], s38 offen lds
    s_add_u32 m0, s39, 11264
    s_add_u32 s38, s40, 180224
    buffer_load_dwordx4 v27, s[16:19], s38 offen lds
    s_add_u32 m0, s39, 12288
    s_add_u32 s38, s40, 196608
    buffer_load_dwordx4 v26, s[16:19], s38 offen lds
    s_add_u32 m0, s39, 13312
    s_add_u32 s38, s40, 212992
    buffer_load_dwordx4 v27, s[16:19], s38 offen lds
    s_add_u32 m0, s39, 14336
    s_add_u32 s38, s40, 229376
    buffer_load_dwordx4 v26, s[16:19], s38 offen lds
    s_add_u32 m0, s39, 15360
    s_add_u32 s38, s40, 245760
    buffer_load_dwordx4 v27, s[16:19], s38 offen lds
    s_add_u32 s40, s40, 262144
    s_add_u32 s39, s39, 0x4000
    s_and_b32 s39, s39, 0x1ffff
    s_add_u32 m0, s39, 0
    s_add_u32 s38, s40, 0
    buffer_load_dwordx4 v26, s[16:19], s38 offen lds
    s_add_u32 m0, s39, 1024
    s_add_u32 s38, s40, 16384
    buffer_load_dwordx4 v27, s[16:19], s38 offen lds
    s_add_u32 m0, s39, 2048
    s_add_u32 s38, s40, 32768
    buffer_load_dwordx4 v26, s[16:19], s38 offen lds
    s_add_u32 m0, s39, 3072
    s_add_u32 s38, s40, 49152
    buffer_load_dwordx4 v27, s[16:19], s38 offen lds
    s_add_u32 m0, s39, 4096
    s_add_u32 s38, s40, 65536
    buffer_load_dwordx4 v26, s[16:19], s38 offen lds
    s_add_u32 m0, s39, 5120
    s_add_u32 s38, s40, 81920
    buffer_load_dwordx4 v27, s[16:19], s38 offen lds
    s_add_u32 m0, s39, 6144
    s_add_u32 s38, s40, 98304
    buffer_load_dwordx4 v26, s[16:19], s38 offen lds
    s_add_u32 m0, s39, 7168
    s_add_u32 s38, s40, 114688
    buffer_load_dwordx4 v27, s[16:19], s38 offen lds
    s_add_u32 m0, s39, 8192
    s_add_u32 s38, s40, 131072
    buffer_load_dwordx4 v26, s[16:19], s38 offen lds
    s_add_u32 m0, s39, 9216
    s_add_u32 s38, s40, 147456
    buffer_load_dwordx4 v27, s[16:19], s38 offen lds
    s_add_u32 m0, s39, 10240
    s_add_u32 s38, s40, 163840
    buffer_load_dwordx4 v26, s[16:19], s38 offen lds
    s_add_u32 m0, s39, 11264
    s_add_u32 s38, s40, 180224
    buffer_load_dwordx4 v27, s[16:19], s38 offen lds
    s_add_u32 m0, s39, 12288
    s_add_u32 s38, s40, 196608
    buffer_load_dwordx4 v26, s[16:19], s38 offen lds
    s_add_u32 m0, s39, 13312
    s_add_u32 s38, s40, 212992
    buffer_load_dwordx4 v27, s[16:19], s38 offen lds
    s_add_u32 m0, s39, 14336
    s_add_u32 s38, s40, 229376
    buffer_load_dwordx4 v26, s[16:19], s38 offen lds
    s_add_u32 m0, s39, 15360
    s_add_u32 s38, s40, 245760
    buffer_load_dwordx4 v27, s[16:19], s38 offen lds
    s_add_u32 s40, s40, 262144
    s_add_u32 s39, s39, 0x4000
    s_and_b32 s39, s39, 0x1ffff
    v_add_u32 v4, 0, v2
    v_and_b32 v4, 15, v4
    v_xor_b32 v4, v4, v3
    v_lshlrev_b32 v4, 4, v4
    v_lshl_add_u32 v16, v2, 9, v4
    v_add_u32 v4, 2, v2
    v_and_b32 v4, 15, v4
    v_xor_b32 v4, v4, v3
    v_lshlrev_b32 v4, 4, v4
    v_lshl_add_u32 v17, v2, 9, v4
    v_add_u32 v4, 4, v2
    v_and_b32 v4, 15, v4
    v_xor_b32 v4, v4, v3
    v_lshlrev_b32 v4, 4, v4
    v_lshl_add_u32 v18, v2, 9, v4
    v_add_u32 v4, 6, v2
    v_and_b32 v4, 15, v4
    v_xor_b32 v4, v4, v3
    v_lshlrev_b32 v4, 4, v4
    v_lshl_add_u32 v19, v2, 9, v4
    v_add_u32 v4, 8, v2
    v_and_b32 v4, 15, v4
    v_xor_b32 v4, v4, v3
    v_lshlrev_b32 v4, 4, v4
    v_lshl_add_u32 v20, v2, 9, v4
    v_add_u32 v4, 10, v2
    v_and_b32 v4, 15, v4
    v_xor_b32 v4, v4, v3
    v_lshlrev_b32 v4, 4, v4
    v_lshl_add_u32 v21, v2, 9, v4
    v_add_u32 v4, 12, v2
    v_and_b32 v4, 15, v4
    v_xor_b32 v4, v4, v3
    v_lshlrev_b32 v4, 4, v4
    v_lshl_add_u32 v22, v2, 9, v4
    v_add_u32 v4, 14, v2
    v_and_b32 v4, 15, v4
    v_xor_b32 v4, v4, v3
    v_lshlrev_b32 v4, 4, v4
    v_lshl_add_u32 v23, v2, 9, v4
    s_mov_b32 s34, 0
attn_kernel_lw:
    s_waitcnt vmcnt(32)
    s_barrier
    s_add_u32 m0, s39, 0
    s_add_u32 s38, s40, 0
    buffer_load_dwordx4 v26, s[16:19], s38 offen lds
    s_add_u32 m0, s39, 1024
    s_add_u32 s38, s40, 16384
    buffer_load_dwordx4 v27, s[16:19], s38 offen lds
    s_add_u32 m0, s39, 2048
    s_add_u32 s38, s40, 32768
    buffer_load_dwordx4 v26, s[16:19], s38 offen lds
    s_add_u32 m0, s39, 3072
    s_add_u32 s38, s40, 49152
    buffer_load_dwordx4 v27, s[16:19], s38 offen lds
    s_add_u32 m0, s39, 4096
    s_add_u32 s38, s40, 65536
    buffer_load_dwordx4 v26, s[16:19], s38 offen lds
    s_add_u32 m0, s39, 5120
    s_add_u32 s38, s40, 81920
    buffer_load_dwordx4 v27, s[16:19], s38 offen lds
    s_add_u32 m0, s39, 6144
    s_add_u32 s38, s40, 98304
    buffer_load_dwordx4 v26, s[16:19], s38 offen lds
    s_add_u32 m0, s39, 7168
    s_add_u32 s38, s40, 114688
    buffer_load_dwordx4 v27, s[16:19], s38 offen lds
    s_add_u32 m0, s39, 8192
    s_add_u32 s38, s40, 131072
    buffer_load_dwordx4 v26, s[16:19], s38 offen lds
    s_add_u32 m0, s39, 9216
    s_add_u32 s38, s40, 147456
    buffer_load_dwordx4 v27, s[16:19], s38 offen lds
    s_add_u32 m0, s39, 10240
    s_add_u32 s38, s40, 163840
    buffer_load_dwordx4 v26, s[16:19], s38 offen lds
    s_add_u32 m0, s39, 11264
    s_add_u32 s38, s40, 180224
    buffer_load_dwordx4 v27, s[16:19], s38 offen lds
    s_add_u32 m0, s39, 12288
    s_add_u32 s38, s40, 196608
    buffer_load_dwordx4 v26, s[16:19], s38 offen lds
    s_add_u32 m0, s39, 13312
    s_add_u32 s38, s40, 212992
    buffer_load_dwordx4 v27, s[16:19], s38 offen lds
    s_add_u32 m0, s39, 14336
    s_add_u32 s38, s40, 229376
    buffer_load_dwordx4 v26, s[16:19], s38 offen lds
    s_add_u32 m0, s39, 15360
    s_add_u32 s38, s40, 245760
    buffer_load_dwordx4 v27, s[16:19], s38 offen lds
    s_add_u32 s40, s40, 262144
    s_add_u32 s39, s39, 0x4000
    s_and_b32 s39, s39, 0x1ffff
    s_add_u32 s34, s34, 1
    s_cmp_lt_u32 s34, 11
    s_cbranch_scc1 attn_kernel_lw
    s_waitcnt vmcnt(32)
    s_barrier
    s_add_u32 m0, s39, 0
    s_add_u32 s38, s41, 0
    buffer_load_dwordx4 v16, s[8:11], s38 offen nt lds
    s_add_u32 m0, s39, 1024
    s_add_u32 s38, s41, 1024
    buffer_load_dwordx4 v17, s[8:11], s38 offen nt lds
    s_add_u32 m0, s39, 2048
    s_add_u32 s38, s41, 2048
    buffer_load_dwordx4 v18, s[8:11], s38 offen nt lds
    s_add_u32 m0, s39, 3072
    s_add_u32 s38, s41, 3072
    buffer_load_dwordx4 v19, s[8:11], s38 offen nt lds
    s_add_u32 m0, s39, 4096
    s_add_u32 s38, s41, 4096
    buffer_load_dwordx4 v20, s[8:11], s38 offen nt lds
    s_add_u32 m0, s39, 5120
    s_add_u32 s38, s41, 5120
    buffer_load_dwordx4 v21, s[8:11], s38 offen nt lds
    s_add_u32 m0, s39, 6144
    s_add_u32 s38, s41, 6144
    buffer_load_dwordx4 v22, s[8:11], s38 offen nt lds
    s_add_u32 m0, s39, 7168
    s_add_u32 s38, s41, 7168
    buffer_load_dwordx4 v23, s[8:11], s38 offen nt lds
    s_add_u32 m0, s39, 8192
    s_add_u32 s38, s41, 8192
    buffer_load_dwordx4 v16, s[8:11], s38 offen nt lds
    s_add_u32 m0, s39, 9216
    s_add_u32 s38, s41, 9216
    buffer_load_dwordx4 v17, s[8:11], s38 offen nt lds
    s_add_u32 m0, s39, 10240
    s_add_u32 s38, s41, 10240
    buffer_load_dwordx4 v18, s[8:11], s38 offen nt lds
    s_add_u32 m0, s39, 11264
    s_add_u32 s38, s41, 11264
    buffer_load_dwordx4 v19, s[8:11], s38 offen nt lds
    s_add_u32 m0, s39, 12288
    s_add_u32 s38, s41, 12288
    buffer_load_dwordx4 v20, s[8:11], s38 offen nt lds
    s_add_u32 m0, s39, 13312
    s_add_u32 s38, s41, 13312
    buffer_load_dwordx4 v21, s[8:11], s38 offen nt lds
    s_add_u32 m0, s39, 14336
    s_add_u32 s38, s41, 14336
    buffer_load_dwordx4 v22, s[8:11], s38 offen nt lds
    s_add_u32 m0, s39, 15360
    s_add_u32 s38, s41, 15360
    buffer_load_dwordx4 v23, s[8:11], s38 offen nt lds
    s_add_u32 s41, s41, 16384
    s_add_u32 s39, s39, 0x4000
    s_and_b32 s39, s39, 0x1ffff
    s_mov_b32 s34, 0
attn_kernel_lm:
    s_waitcnt vmcnt(32)
    s_barrier
    s_add_u32 m0, s39, 0
    s_add_u32 s38, s41, 0
    buffer_load_dwordx4 v16, s[8:11], s38 offen nt lds
    s_add_u32 m0, s39, 1024
    s_add_u32 s38, s41, 1024
    buffer_load_dwordx4 v17, s[8:11], s38 offen nt lds
    s_add_u32 m0, s39, 2048
    s_add_u32 s38, s41, 2048
    buffer_load_dwordx4 v18, s[8:11], s38 offen nt lds
    s_add_u32 m0, s39, 3072
    s_add_u32 s38, s41, 3072
    buffer_load_dwordx4 v19, s[8:11], s38 offen nt lds
    s_add_u32 m0, s39, 4096
    s_add_u32 s38, s41, 4096
    buffer_load_dwordx4 v20, s[8:11], s38 offen nt lds
    s_add_u32 m0, s39, 5120
    s_add_u32 s38, s41, 5120
    buffer_load_dwordx4 v21, s[8:11], s38 offen nt lds
    s_add_u32 m0, s39, 6144
    s_add_u32 s38, s41, 6144
    buffer_load_dwordx4 v22, s[8:11], s38 offen nt lds
    s_add_u32 m0, s39, 7168
    s_add_u32 s38, s41, 7168
    buffer_load_dwordx4 v23, s[8:11], s38 offen nt lds
    s_add_u32 m0, s39, 8192
    s_add_u32 s38, s41, 8192
    buffer_load_dwordx4 v16, s[8:11], s38 offen nt lds
    s_add_u32 m0, s39, 9216
    s_add_u32 s38, s41, 9216
    buffer_load_dwordx4 v17, s[8:11], s38 offen nt lds
    s_add_u32 m0, s39, 10240
    s_add_u32 s38, s41, 10240
    buffer_load_dwordx4 v18, s[8:11], s38 offen nt lds
    s_add_u32 m0, s39, 11264
    s_add_u32 s38, s41, 11264
    buffer_load_dwordx4 v19, s[8:11], s38 offen nt lds
    s_add_u32 m0, s39, 12288
    s_add_u32 s38, s41, 12288
    buffer_load_dwordx4 v20, s[8:11], s38 offen nt lds
    s_add_u32 m0, s39, 13312
    s_add_u32 s38, s41, 13312
    buffer_load_dwordx4 v21, s[8:11], s38 offen nt lds
    s_add_u32 m0, s39, 14336
    s_add_u32 s38, s41, 14336
    buffer_load_dwordx4 v22, s[8:11], s38 offen nt lds
    s_add_u32 m0, s39, 15360
    s_add_u32 s38, s41, 15360
    buffer_load_dwordx4 v23, s[8:11], s38 offen nt lds
    s_add_u32 s41, s41, 16384
    s_add_u32 s39, s39, 0x4000
    s_and_b32 s39, s39, 0x1ffff
    s_waitcnt vmcnt(32)
    s_barrier
    s_add_u32 m0, s39, 0
    s_add_u32 s38, s42, 0
    buffer_load_dwordx4 v24, s[12:15], s38 offen nt lds
    s_add_u32 m0, s39, 1024
    s_add_u32 s38, s42, 1024
    buffer_load_dwordx4 v25, s[12:15], s38 offen nt lds
    s_add_u32 m0, s39, 2048
    s_add_u32 s38, s42, 2048
    buffer_load_dwordx4 v24, s[12:15], s38 offen nt lds
    s_add_u32 m0, s39, 3072
    s_add_u32 s38, s42, 3072
    buffer_load_dwordx4 v25, s[12:15], s38 offen nt lds
    s_add_u32 m0, s39, 4096
    s_add_u32 s38, s42, 4096
    buffer_load_dwordx4 v24, s[12:15], s38 offen nt lds
    s_add_u32 m0, s39, 5120
    s_add_u32 s38, s42, 5120
    buffer_load_dwordx4 v25, s[12:15], s38 offen nt lds
    s_add_u32 m0, s39, 6144
    s_add_u32 s38, s42, 6144
    buffer_load_dwordx4 v24, s[12:15], s38 offen nt lds
    s_add_u32 m0, s39, 7168
    s_add_u32 s38, s42, 7168
    buffer_load_dwordx4 v25, s[12:15], s38 offen nt lds
    s_add_u32 m0, s39, 8192
    s_add_u32 s38, s42, 8192
    buffer_load_dwordx4 v24, s[12:15], s38 offen nt lds
    s_add_u32 m0, s39, 9216
    s_add_u32 s38, s42, 9216
    buffer_load_dwordx4 v25, s[12:15], s38 offen nt lds
    s_add_u32 m0, s39, 10240
    s_add_u32 s38, s42, 10240
    buffer_load_dwordx4 v24, s[12:15], s38 offen nt lds
    s_add_u32 m0, s39, 11264
    s_add_u32 s38, s42, 11264
    buffer_load_dwordx4 v25, s[12:15], s38 offen nt lds
    s_add_u32 m0, s39, 12288
    s_add_u32 s38, s42, 12288
    buffer_load_dwordx4 v24, s[12:15], s38 offen nt lds
    s_add_u32 m0, s39, 13312
    s_add_u32 s38, s42, 13312
    buffer_load_dwordx4 v25, s[12:15], s38 offen nt lds
    s_add_u32 m0, s39, 14336
    s_add_u32 s38, s42, 14336
    buffer_load_dwordx4 v24, s[12:15], s38 offen nt lds
    s_add_u32 m0, s39, 15360
    s_add_u32 s38, s42, 15360
    buffer_load_dwordx4 v25, s[12:15], s38 offen nt lds
    s_add_u32 s42, s42, 16384
    s_add_u32 s39, s39, 0x4000
    s_and_b32 s39, s39, 0x1ffff
    s_add_u32 s34, s34, 1
    s_cmp_lt_u32 s34, 31
    s_cbranch_scc1 attn_kernel_lm
    s_waitcnt vmcnt(32)
    s_barrier
    s_add_u32 m0, s39, 0
    s_add_u32 s38, s42, 0
    buffer_load_dwordx4 v24, s[12:15], s38 offen nt lds
    s_add_u32 m0, s39, 1024
    s_add_u32 s38, s42, 1024
    buffer_load_dwordx4 v25, s[12:15], s38 offen nt lds
    s_add_u32 m0, s39, 2048
    s_add_u32 s38, s42, 2048
    buffer_load_dwordx4 v24, s[12:15], s38 offen nt lds
    s_add_u32 m0, s39, 3072
    s_add_u32 s38, s42, 3072
    buffer_load_dwordx4 v25, s[12:15], s38 offen nt lds
    s_add_u32 m0, s39, 4096
    s_add_u32 s38, s42, 4096
    buffer_load_dwordx4 v24, s[12:15], s38 offen nt lds
    s_add_u32 m0, s39, 5120
    s_add_u32 s38, s42, 5120
    buffer_load_dwordx4 v25, s[12:15], s38 offen nt lds
    s_add_u32 m0, s39, 6144
    s_add_u32 s38, s42, 6144
    buffer_load_dwordx4 v24, s[12:15], s38 offen nt lds
    s_add_u32 m0, s39, 7168
    s_add_u32 s38, s42, 7168
    buffer_load_dwordx4 v25, s[12:15], s38 offen nt lds
    s_add_u32 m0, s39, 8192
    s_add_u32 s38, s42, 8192
    buffer_load_dwordx4 v24, s[12:15], s38 offen nt lds
    s_add_u32 m0, s39, 9216
    s_add_u32 s38, s42, 9216
    buffer_load_dwordx4 v25, s[12:15], s38 offen nt lds
    s_add_u32 m0, s39, 10240
    s_add_u32 s38, s42, 10240
    buffer_load_dwordx4 v24, s[12:15], s38 offen nt lds
    s_add_u32 m0, s39, 11264
    s_add_u32 s38, s42, 11264
    buffer_load_dwordx4 v25, s[12:15], s38 offen nt lds
    s_add_u32 m0, s39, 12288
    s_add_u32 s38, s42, 12288
    buffer_load_dwordx4 v24, s[12:15], s38 offen nt lds
    s_add_u32 m0, s39, 13312
    s_add_u32 s38, s42, 13312
    buffer_load_dwordx4 v25, s[12:15], s38 offen nt lds
    s_add_u32 m0, s39, 14336
    s_add_u32 s38, s42, 14336
    buffer_load_dwordx4 v24, s[12:15], s38 offen nt lds
    s_add_u32 m0, s39, 15360
    s_add_u32 s38, s42, 15360
    buffer_load_dwordx4 v25, s[12:15], s38 offen nt lds
    s_add_u32 s42, s42, 16384
    s_add_u32 s39, s39, 0x4000
    s_and_b32 s39, s39, 0x1ffff
    s_mov_b32 s34, 0
attn_kernel_lo1:
    s_waitcnt vmcnt(32)
    s_barrier
    s_add_u32 m0, s39, 0
    s_add_u32 s38, s43, 0
    buffer_load_dwordx4 v28, s[64:67], s38 offen lds
    s_add_u32 m0, s39, 1024
    s_add_u32 s38, s43, 1792
    buffer_load_dwordx4 v29, s[64:67], s38 offen lds
    s_add_u32 m0, s39, 2048
    s_add_u32 s38, s43, 3584
    buffer_load_dwordx4 v28, s[64:67], s38 offen lds
    s_add_u32 m0, s39, 3072
    s_add_u32 s38, s43, 5376
    buffer_load_dwordx4 v29, s[64:67], s38 offen lds
    s_add_u32 m0, s39, 4096
    s_add_u32 s38, s43, 7168
    buffer_load_dwordx4 v28, s[64:67], s38 offen lds
    s_add_u32 m0, s39, 5120
    s_add_u32 s38, s43, 8960
    buffer_load_dwordx4 v29, s[64:67], s38 offen lds
    s_add_u32 m0, s39, 6144
    s_add_u32 s38, s43, 10752
    buffer_load_dwordx4 v28, s[64:67], s38 offen lds
    s_add_u32 m0, s39, 7168
    s_add_u32 s38, s43, 12544
    buffer_load_dwordx4 v29, s[64:67], s38 offen lds
    s_add_u32 m0, s39, 8192
    s_add_u32 s38, s43, 14336
    buffer_load_dwordx4 v28, s[64:67], s38 offen lds
    s_add_u32 m0, s39, 9216
    s_add_u32 s38, s43, 16128
    buffer_load_dwordx4 v29, s[64:67], s38 offen lds
    s_add_u32 m0, s39, 10240
    s_add_u32 s38, s43, 17920
    buffer_load_dwordx4 v28, s[64:67], s38 offen lds
    s_add_u32 m0, s39, 11264
    s_add_u32 s38, s43, 19712
    buffer_load_dwordx4 v29, s[64:67], s38 offen lds
    s_add_u32 m0, s39, 12288
    s_add_u32 s38, s43, 21504
    buffer_load_dwordx4 v28, s[64:67], s38 offen lds
    s_add_u32 m0, s39, 13312
    s_add_u32 s38, s43, 23296
    buffer_load_dwordx4 v29, s[64:67], s38 offen lds
    s_add_u32 m0, s39, 14336
    s_add_u32 s38, s43, 25088
    buffer_load_dwordx4 v28, s[64:67], s38 offen lds
    s_add_u32 m0, s39, 15360
    s_add_u32 s38, s43, 26880
    buffer_load_dwordx4 v29, s[64:67], s38 offen lds
    s_add_u32 s43, s43, 28672
    s_add_u32 s39, s39, 0x4000
    s_and_b32 s39, s39, 0x1ffff
    s_add_u32 s34, s34, 1
    s_cmp_lt_u32 s34, 8
    s_cbranch_scc1 attn_kernel_lo1
    s_add_u32 s43, s37, 448
    s_mov_b32 s34, 0
attn_kernel_lo2:
    s_waitcnt vmcnt(32)
    s_barrier
    s_add_u32 m0, s39, 0
    s_add_u32 s38, s43, 0
    buffer_load_dwordx4 v28, s[64:67], s38 offen lds
    s_add_u32 m0, s39, 1024
    s_add_u32 s38, s43, 1792
    buffer_load_dwordx4 v29, s[64:67], s38 offen lds
    s_add_u32 m0, s39, 2048
    s_add_u32 s38, s43, 3584
    buffer_load_dwordx4 v28, s[64:67], s38 offen lds
    s_add_u32 m0, s39, 3072
    s_add_u32 s38, s43, 5376
    buffer_load_dwordx4 v29, s[64:67], s38 offen lds
    s_add_u32 m0, s39, 4096
    s_add_u32 s38, s43, 7168
    buffer_load_dwordx4 v28, s[64:67], s38 offen lds
    s_add_u32 m0, s39, 5120
    s_add_u32 s38, s43, 8960
    buffer_load_dwordx4 v29, s[64:67], s38 offen lds
    s_add_u32 m0, s39, 6144
    s_add_u32 s38, s43, 10752
    buffer_load_dwordx4 v28, s[64:67], s38 offen lds
    s_add_u32 m0, s39, 7168
    s_add_u32 s38, s43, 12544
    buffer_load_dwordx4 v29, s[64:67], s38 offen lds
    s_add_u32 m0, s39, 8192
    s_add_u32 s38, s43, 14336
    buffer_load_dwordx4 v28, s[64:67], s38 offen lds
    s_add_u32 m0, s39, 9216
    s_add_u32 s38, s43, 16128
    buffer_load_dwordx4 v29, s[64:67], s38 offen lds
    s_add_u32 m0, s39, 10240
    s_add_u32 s38, s43, 17920
    buffer_load_dwordx4 v28, s[64:67], s38 offen lds
    s_add_u32 m0, s39, 11264
    s_add_u32 s38, s43, 19712
    buffer_load_dwordx4 v29, s[64:67], s38 offen lds
    s_add_u32 m0, s39, 12288
    s_add_u32 s38, s43, 21504
    buffer_load_dwordx4 v28, s[64:67], s38 offen lds
    s_add_u32 m0, s39, 13312
    s_add_u32 s38, s43, 23296
    buffer_load_dwordx4 v29, s[64:67], s38 offen lds
    s_add_u32 m0, s39, 14336
    s_add_u32 s38, s43, 25088
    buffer_load_dwordx4 v28, s[64:67], s38 offen lds
    s_add_u32 m0, s39, 15360
    s_add_u32 s38, s43, 26880
    buffer_load_dwordx4 v29, s[64:67], s38 offen lds
    s_add_u32 s43, s43, 28672
    s_add_u32 s39, s39, 0x4000
    s_and_b32 s39, s39, 0x1ffff
    s_add_u32 s34, s34, 1
    s_cmp_lt_u32 s34, 8
    s_cbranch_scc1 attn_kernel_lo2
    s_waitcnt vmcnt(32)
    s_barrier
    s_waitcnt vmcnt(16)
    s_barrier
    s_waitcnt vmcnt(0)
    s_barrier
    s_endpgm
attn_kernel_compute:
    s_mov_b32 s30, 0x3db8aa3b
    s_mov_b32 s31, 0x42b17218
    v_and_b32 v226, 63, v0
    v_and_b32 v227, 31, v0
    v_bfe_u32 v228, v0, 5, 1
    s_mul_i32 s32, s27, 192
    s_mul_i32 s33, s26, 96
    s_add_u32 s32, s32, s33
    s_lshl_b32 s33, s24, 5
    s_add_u32 s32, s32, s33
    v_add_u32 v220, s32, v227
    v_mul_u32_u24 v224, 896, v220
    v_lshlrev_b32 v221, 4, v228
    v_add_u32 v224, v224, v221
    buffer_load_dwordx4 a[64:67], v224, s[4:7], 0 offen
    buffer_load_dwordx4 a[68:71], v224, s[4:7], 0 offen offset:32
    buffer_load_dwordx4 a[72:75], v224, s[4:7], 0 offen offset:64
    buffer_load_dwordx4 a[76:79], v224, s[4:7], 0 offen offset:96
    buffer_load_dwordx4 a[80:83], v224, s[4:7], 0 offen offset:128
    buffer_load_dwordx4 a[84:87], v224, s[4:7], 0 offen offset:160
    buffer_load_dwordx4 a[88:91], v224, s[4:7], 0 offen offset:192
    buffer_load_dwordx4 a[92:95], v224, s[4:7], 0 offen offset:224
    v_lshrrev_b32 v222, 2, v226
    v_and_b32 v223, 3, v226
    v_lshlrev_b32 v223, 7, v223
    v_lshl_add_u32 v240, v222, 13, v223
    v_lshlrev_b32 v241, 7, v226
    s_lshr_b32 s33, s32, 5
    s_mul_i32 s47, s28, 48
    s_add_u32 s33, s33, s47
    s_mul_i32 s47, s33, 28*1024
    v_lshlrev_b32 v225, 4, v226
    v_and_b32 v220, 19, v227
    v_lshrrev_b32 v221, 1, v227
    v_and_b32 v221, 4, v221
    v_or_b32 v220, v220, v221
    v_lshlrev_b32 v221, 1, v227
    v_and_b32 v221, 8, v221
    v_or_b32 v220, v220, v221
    v_and_b32 v221, 15, v220
    v_xor_b32 v221, v221, v228
    v_lshlrev_b32 v220, 9, v220
    v_xor_b32 v222, 0, v221
    v_lshl_add_u32 v200, v222, 4, v220
    v_add_u32 v232, 0x10000, v200
    v_xor_b32 v222, 2, v221
    v_lshl_add_u32 v201, v222, 4, v220
    v_add_u32 v233, 0x10000, v201
    v_xor_b32 v222, 4, v221
    v_lshl_add_u32 v202, v222, 4, v220
    v_add_u32 v234, 0x10000, v202
    v_xor_b32 v222, 6, v221
    v_lshl_add_u32 v203, v222, 4, v220
    v_add_u32 v235, 0x10000, v203
    v_xor_b32 v222, 8, v221
    v_lshl_add_u32 v204, v222, 4, v220
    v_add_u32 v236, 0x10000, v204
    v_xor_b32 v222, 10, v221
    v_lshl_add_u32 v205, v222, 4, v220
    v_add_u32 v237, 0x10000, v205
    v_xor_b32 v222, 12, v221
    v_lshl_add_u32 v206, v222, 4, v220
    v_add_u32 v238, 0x10000, v206
    v_xor_b32 v222, 14, v221
    v_lshl_add_u32 v207, v222, 4, v220
    v_add_u32 v239, 0x10000, v207
    v_bfe_u32 v220, v226, 2, 2
    v_and_b32 v221, 1, v226
    v_bfe_u32 v222, v226, 1, 1
    v_bfe_u32 v223, v226, 4, 1
    v_lshl_add_u32 v221, v223, 1, v221
    v_lshlrev_b32 v221, 4, v221
    v_lshl_add_u32 v221, v222, 3, v221
    v_lshl_add_u32 v222, v228, 3, v220
    v_lshl_add_u32 v221, v222, 9, v221
    v_xor_b32 v222, 0, v220
    v_lshl_add_u32 v208, v222, 6, v221
    v_add_u32 v212, 0x10000, v208
    v_xor_b32 v222, 1, v220
    v_lshl_add_u32 v209, v222, 6, v221
    v_add_u32 v213, 0x10000, v209
    v_xor_b32 v222, 2, v220
    v_lshl_add_u32 v210, v222, 6, v221
    v_add_u32 v214, 0x10000, v210
    v_xor_b32 v222, 3, v220
    v_lshl_add_u32 v211, v222, 6, v221
    v_add_u32 v215, 0x10000, v211
    v_mov_b32 v216, 0xff800000
    v_mov_b32 v218, 0xff800000
    v_mov_b32 v217, 0
    v_mov_b32 v192, 0x3f803f80
    v_mov_b32 v193, 0x3f803f80
    v_mov_b32 v194, 0x3f803f80
    v_mov_b32 v195, 0x3f803f80
    v_mov_b32 v176, 0
    v_mov_b32 v177, 0
    v_mov_b32 v178, 0
    v_mov_b32 v179, 0
    v_mov_b32 v180, 0
    v_mov_b32 v181, 0
    v_mov_b32 v182, 0
    v_mov_b32 v183, 0
    v_mov_b32 v184, 0
    v_mov_b32 v185, 0
    v_mov_b32 v186, 0
    v_mov_b32 v187, 0
    v_mov_b32 v188, 0
    v_mov_b32 v189, 0
    v_mov_b32 v190, 0
    v_mov_b32 v191, 0
    s_barrier
    ds_read_b64_tr_b16 a[176:177], v208
    ds_read_b64_tr_b16 a[178:179], v208 offset:2048
    ds_read_b64_tr_b16 a[180:181], v208 offset:8192
    ds_read_b64_tr_b16 a[182:183], v208 offset:10240
    ds_read_b64_tr_b16 a[184:185], v209
    ds_read_b64_tr_b16 a[186:187], v209 offset:2048
    ds_read_b64_tr_b16 a[188:189], v209 offset:8192
    ds_read_b64_tr_b16 a[190:191], v209 offset:10240
    s_barrier
    ds_read_b64_tr_b16 a[192:193], v210
    ds_read_b64_tr_b16 a[194:195], v210 offset:2048
    s_waitcnt lgkmcnt(6)
    s_waitcnt vmcnt(7)
    v_mfma_f32_32x32x16_bf16 v[0:15], a[176:179], a[64:67], 0
    buffer_load_dwordx4 a[96:99], v224, s[4:7], 0 offen offset:256
    ds_read_b64_tr_b16 a[196:197], v210 offset:8192
    ds_read_b64_tr_b16 a[198:199], v210 offset:10240
    s_waitcnt vmcnt(7)
    v_mfma_f32_32x32x16_bf16 v[0:15], a[180:183], a[68:71], v[0:15]
    ds_read_b64_tr_b16 a[200:201], v211
    ds_read_b64_tr_b16 a[202:203], v211 offset:2048
    s_waitcnt lgkmcnt(6)
    v_mfma_f32_32x32x16_bf16 v[16:31], a[184:187], a[64:67], 0
    ds_read_b64_tr_b16 a[204:205], v211 offset:8192
    ds_read_b64_tr_b16 a[206:207], v211 offset:10240
    v_mfma_f32_32x32x16_bf16 v[16:31], a[188:191], a[68:71], v[16:31]
    ds_read_b64_tr_b16 a[176:177], v208 offset:256
    ds_read_b64_tr_b16 a[178:179], v208 offset:2304
    s_waitcnt lgkmcnt(6)
    v_mfma_f32_32x32x16_bf16 v[32:47], a[192:195], a[64:67], 0
    ds_read_b64_tr_b16 a[180:181], v208 offset:8448
    ds_read_b64_tr_b16 a[182:183], v208 offset:10496
    v_mfma_f32_32x32x16_bf16 v[32:47], a[196:199], a[68:71], v[32:47]
    ds_read_b64_tr_b16 a[184:185], v209 offset:256
    ds_read_b64_tr_b16 a[186:187], v209 offset:2304
    s_waitcnt lgkmcnt(6)
    v_mfma_f32_32x32x16_bf16 v[48:63], a[200:203], a[64:67], 0
    ds_read_b64_tr_b16 a[188:189], v209 offset:8448
    ds_read_b64_tr_b16 a[190:191], v209 offset:10496
    v_mfma_f32_32x32x16_bf16 v[48:63], a[204:207], a[68:71], v[48:63]
    ds_read_b64_tr_b16 a[192:193], v210 offset:256
    ds_read_b64_tr_b16 a[194:195], v210 offset:2304
    s_waitcnt lgkmcnt(6)
    v_mfma_f32_32x32x16_bf16 v[64:79], a[176:179], a[64:67], 0
    buffer_load_dwordx4 a[100:103], v224, s[4:7], 0 offen offset:288
    ds_read_b64_tr_b16 a[196:197], v210 offset:8448
    ds_read_b64_tr_b16 a[198:199], v210 offset:10496
    v_mfma_f32_32x32x16_bf16 v[64:79], a[180:183], a[68:71], v[64:79]
    ds_read_b64_tr_b16 a[200:201], v211 offset:256
    ds_read_b64_tr_b16 a[202:203], v211 offset:2304
    s_waitcnt lgkmcnt(6)
    v_mfma_f32_32x32x16_bf16 v[80:95], a[184:187], a[64:67], 0
    ds_read_b64_tr_b16 a[204:205], v211 offset:8448
    ds_read_b64_tr_b16 a[206:207], v211 offset:10496
    v_mfma_f32_32x32x16_bf16 v[80:95], a[188:191], a[68:71], v[80:95]
    ds_read_b64_tr_b16 a[176:177], v208 offset:16384
    ds_read_b64_tr_b16 a[178:179], v208 offset:18432
    s_waitcnt lgkmcnt(6)
    v_mfma_f32_32x32x16_bf16 v[96:111], a[192:195], a[64:67], 0
    ds_read_b64_tr_b16 a[180:181], v208 offset:24576
    ds_read_b64_tr_b16 a[182:183], v208 offset:26624
    v_mfma_f32_32x32x16_bf16 v[96:111], a[196:199], a[68:71], v[96:111]
    ds_read_b64_tr_b16 a[184:185], v209 offset:16384
    ds_read_b64_tr_b16 a[186:187], v209 offset:18432
    s_waitcnt lgkmcnt(6)
    v_mfma_f32_32x32x16_bf16 v[112:127], a[200:203], a[64:67], 0
    ds_read_b64_tr_b16 a[188:189], v209 offset:24576
    ds_read_b64_tr_b16 a[190:191], v209 offset:26624
    v_mfma_f32_32x32x16_bf16 v[112:127], a[204:207], a[68:71], v[112:127]
    s_barrier
    ds_read_b64_tr_b16 a[192:193], v210 offset:16384
    ds_read_b64_tr_b16 a[194:195], v210 offset:18432
    s_waitcnt lgkmcnt(6)
    s_waitcnt vmcnt(7)
    v_mfma_f32_32x32x16_bf16 v[0:15], a[176:179], a[72:75], v[0:15]
    buffer_load_dwordx4 a[104:107], v224, s[4:7], 0 offen offset:320
    ds_read_b64_tr_b16 a[196:197], v210 offset:24576
    ds_read_b64_tr_b16 a[198:199], v210 offset:26624
    s_waitcnt vmcnt(7)
    v_mfma_f32_32x32x16_bf16 v[0:15], a[180:183], a[76:79], v[0:15]
    ds_read_b64_tr_b16 a[200:201], v211 offset:16384
    ds_read_b64_tr_b16 a[202:203], v211 offset:18432
    s_waitcnt lgkmcnt(6)
    v_mfma_f32_32x32x16_bf16 v[16:31], a[184:187], a[72:75], v[16:31]
    ds_read_b64_tr_b16 a[204:205], v211 offset:24576
    ds_read_b64_tr_b16 a[206:207], v211 offset:26624
    v_mfma_f32_32x32x16_bf16 v[16:31], a[188:191], a[76:79], v[16:31]
    ds_read_b64_tr_b16 a[176:177], v208 offset:16640
    ds_read_b64_tr_b16 a[178:179], v208 offset:18688
    s_waitcnt lgkmcnt(6)
    v_mfma_f32_32x32x16_bf16 v[32:47], a[192:195], a[72:75], v[32:47]
    ds_read_b64_tr_b16 a[180:181], v208 offset:24832
    ds_read_b64_tr_b16 a[182:183], v208 offset:26880
    v_mfma_f32_32x32x16_bf16 v[32:47], a[196:199], a[76:79], v[32:47]
    ds_read_b64_tr_b16 a[184:185], v209 offset:16640
    ds_read_b64_tr_b16 a[186:187], v209 offset:18688
    s_waitcnt lgkmcnt(6)
    v_mfma_f32_32x32x16_bf16 v[48:63], a[200:203], a[72:75], v[48:63]
    ds_read_b64_tr_b16 a[188:189], v209 offset:24832
    ds_read_b64_tr_b16 a[190:191], v209 offset:26880
    v_mfma_f32_32x32x16_bf16 v[48:63], a[204:207], a[76:79], v[48:63]
    ds_read_b64_tr_b16 a[192:193], v210 offset:16640
    ds_read_b64_tr_b16 a[194:195], v210 offset:18688
    s_waitcnt lgkmcnt(6)
    v_mfma_f32_32x32x16_bf16 v[64:79], a[176:179], a[72:75], v[64:79]
    buffer_load_dwordx4 a[108:111], v224, s[4:7], 0 offen offset:352
    ds_read_b64_tr_b16 a[196:197], v210 offset:24832
    ds_read_b64_tr_b16 a[198:199], v210 offset:26880
    v_mfma_f32_32x32x16_bf16 v[64:79], a[180:183], a[76:79], v[64:79]
    ds_read_b64_tr_b16 a[200:201], v211 offset:16640
    ds_read_b64_tr_b16 a[202:203], v211 offset:18688
    s_waitcnt lgkmcnt(6)
    v_mfma_f32_32x32x16_bf16 v[80:95], a[184:187], a[72:75], v[80:95]
    ds_read_b64_tr_b16 a[204:205], v211 offset:24832
    ds_read_b64_tr_b16 a[206:207], v211 offset:26880
    v_mfma_f32_32x32x16_bf16 v[80:95], a[188:191], a[76:79], v[80:95]
    ds_read_b64_tr_b16 a[176:177], v208 offset:32768
    ds_read_b64_tr_b16 a[178:179], v208 offset:34816
    s_waitcnt lgkmcnt(6)
    v_mfma_f32_32x32x16_bf16 v[96:111], a[192:195], a[72:75], v[96:111]
    ds_read_b64_tr_b16 a[180:181], v208 offset:40960
    ds_read_b64_tr_b16 a[182:183], v208 offset:43008
    v_mfma_f32_32x32x16_bf16 v[96:111], a[196:199], a[76:79], v[96:111]
    ds_read_b64_tr_b16 a[184:185], v209 offset:32768
    ds_read_b64_tr_b16 a[186:187], v209 offset:34816
    s_waitcnt lgkmcnt(6)
    v_mfma_f32_32x32x16_bf16 v[112:127], a[200:203], a[72:75], v[112:127]
    ds_read_b64_tr_b16 a[188:189], v209 offset:40960
    ds_read_b64_tr_b16 a[190:191], v209 offset:43008
    v_mfma_f32_32x32x16_bf16 v[112:127], a[204:207], a[76:79], v[112:127]
    s_barrier
    ds_read_b64_tr_b16 a[192:193], v210 offset:32768
    ds_read_b64_tr_b16 a[194:195], v210 offset:34816
    s_waitcnt lgkmcnt(6)
    s_waitcnt vmcnt(7)
    v_mfma_f32_32x32x16_bf16 v[0:15], a[176:179], a[80:83], v[0:15]
    buffer_load_dwordx4 a[112:115], v224, s[4:7], 0 offen offset:384
    ds_read_b64_tr_b16 a[196:197], v210 offset:40960
    ds_read_b64_tr_b16 a[198:199], v210 offset:43008
    s_waitcnt vmcnt(7)
    v_mfma_f32_32x32x16_bf16 v[0:15], a[180:183], a[84:87], v[0:15]
    ds_read_b64_tr_b16 a[200:201], v211 offset:32768
    ds_read_b64_tr_b16 a[202:203], v211 offset:34816
    s_waitcnt lgkmcnt(6)
    v_mfma_f32_32x32x16_bf16 v[16:31], a[184:187], a[80:83], v[16:31]
    ds_read_b64_tr_b16 a[204:205], v211 offset:40960
    ds_read_b64_tr_b16 a[206:207], v211 offset:43008
    v_mfma_f32_32x32x16_bf16 v[16:31], a[188:191], a[84:87], v[16:31]
    ds_read_b64_tr_b16 a[176:177], v208 offset:33024
    ds_read_b64_tr_b16 a[178:179], v208 offset:35072
    s_waitcnt lgkmcnt(6)
    v_mfma_f32_32x32x16_bf16 v[32:47], a[192:195], a[80:83], v[32:47]
    ds_read_b64_tr_b16 a[180:181], v208 offset:41216
    ds_read_b64_tr_b16 a[182:183], v208 offset:43264
    v_mfma_f32_32x32x16_bf16 v[32:47], a[196:199], a[84:87], v[32:47]
    ds_read_b64_tr_b16 a[184:185], v209 offset:33024
    ds_read_b64_tr_b16 a[186:187], v209 offset:35072
    s_waitcnt lgkmcnt(6)
    v_mfma_f32_32x32x16_bf16 v[48:63], a[200:203], a[80:83], v[48:63]
    ds_read_b64_tr_b16 a[188:189], v209 offset:41216
    ds_read_b64_tr_b16 a[190:191], v209 offset:43264
    v_mfma_f32_32x32x16_bf16 v[48:63], a[204:207], a[84:87], v[48:63]
    ds_read_b64_tr_b16 a[192:193], v210 offset:33024
    ds_read_b64_tr_b16 a[194:195], v210 offset:35072
    s_waitcnt lgkmcnt(6)
    v_mfma_f32_32x32x16_bf16 v[64:79], a[176:179], a[80:83], v[64:79]
    buffer_load_dwordx4 a[116:119], v224, s[4:7], 0 offen offset:416
    ds_read_b64_tr_b16 a[196:197], v210 offset:41216
    ds_read_b64_tr_b16 a[198:199], v210 offset:43264
    v_mfma_f32_32x32x16_bf16 v[64:79], a[180:183], a[84:87], v[64:79]
    ds_read_b64_tr_b16 a[200:201], v211 offset:33024
    ds_read_b64_tr_b16 a[202:203], v211 offset:35072
    s_waitcnt lgkmcnt(6)
    v_mfma_f32_32x32x16_bf16 v[80:95], a[184:187], a[80:83], v[80:95]
    ds_read_b64_tr_b16 a[204:205], v211 offset:41216
    ds_read_b64_tr_b16 a[206:207], v211 offset:43264
    v_mfma_f32_32x32x16_bf16 v[80:95], a[188:191], a[84:87], v[80:95]
    ds_read_b64_tr_b16 a[176:177], v208 offset:49152
    ds_read_b64_tr_b16 a[178:179], v208 offset:51200
    s_waitcnt lgkmcnt(6)
    v_mfma_f32_32x32x16_bf16 v[96:111], a[192:195], a[80:83], v[96:111]
    ds_read_b64_tr_b16 a[180:181], v208 offset:57344
    ds_read_b64_tr_b16 a[182:183], v208 offset:59392
    v_mfma_f32_32x32x16_bf16 v[96:111], a[196:199], a[84:87], v[96:111]
    ds_read_b64_tr_b16 a[184:185], v209 offset:49152
    ds_read_b64_tr_b16 a[186:187], v209 offset:51200
    s_waitcnt lgkmcnt(6)
    v_mfma_f32_32x32x16_bf16 v[112:127], a[200:203], a[80:83], v[112:127]
    ds_read_b64_tr_b16 a[188:189], v209 offset:57344
    ds_read_b64_tr_b16 a[190:191], v209 offset:59392
    v_mfma_f32_32x32x16_bf16 v[112:127], a[204:207], a[84:87], v[112:127]
    s_barrier
    ds_read_b64_tr_b16 a[192:193], v210 offset:49152
    ds_read_b64_tr_b16 a[194:195], v210 offset:51200
    s_waitcnt lgkmcnt(6)
    s_waitcnt vmcnt(7)
    v_mfma_f32_32x32x16_bf16 v[0:15], a[176:179], a[88:91], v[0:15]
    buffer_load_dwordx4 a[120:123], v224, s[4:7], 0 offen offset:448
    ds_read_b64_tr_b16 a[196:197], v210 offset:57344
    ds_read_b64_tr_b16 a[198:199], v210 offset:59392
    s_waitcnt vmcnt(7)
    v_mfma_f32_32x32x16_bf16 v[0:15], a[180:183], a[92:95], v[0:15]
    ds_read_b64_tr_b16 a[200:201], v211 offset:49152
    ds_read_b64_tr_b16 a[202:203], v211 offset:51200
    s_waitcnt lgkmcnt(6)
    v_mfma_f32_32x32x16_bf16 v[16:31], a[184:187], a[88:91], v[16:31]
    ds_read_b64_tr_b16 a[204:205], v211 offset:57344
    ds_read_b64_tr_b16 a[206:207], v211 offset:59392
    v_mfma_f32_32x32x16_bf16 v[16:31], a[188:191], a[92:95], v[16:31]
    ds_read_b64_tr_b16 a[176:177], v208 offset:49408
    ds_read_b64_tr_b16 a[178:179], v208 offset:51456
    s_waitcnt lgkmcnt(6)
    v_mfma_f32_32x32x16_bf16 v[32:47], a[192:195], a[88:91], v[32:47]
    ds_read_b64_tr_b16 a[180:181], v208 offset:57600
    ds_read_b64_tr_b16 a[182:183], v208 offset:59648
    v_mfma_f32_32x32x16_bf16 v[32:47], a[196:199], a[92:95], v[32:47]
    ds_read_b64_tr_b16 a[184:185], v209 offset:49408
    ds_read_b64_tr_b16 a[186:187], v209 offset:51456
    s_waitcnt lgkmcnt(6)
    v_mfma_f32_32x32x16_bf16 v[48:63], a[200:203], a[88:91], v[48:63]
    ds_read_b64_tr_b16 a[188:189], v209 offset:57600
    ds_read_b64_tr_b16 a[190:191], v209 offset:59648
    v_mfma_f32_32x32x16_bf16 v[48:63], a[204:207], a[92:95], v[48:63]
    ds_read_b64_tr_b16 a[192:193], v210 offset:49408
    ds_read_b64_tr_b16 a[194:195], v210 offset:51456
    s_waitcnt lgkmcnt(6)
    v_mfma_f32_32x32x16_bf16 v[64:79], a[176:179], a[88:91], v[64:79]
    buffer_load_dwordx4 a[124:127], v224, s[4:7], 0 offen offset:480
    ds_read_b64_tr_b16 a[196:197], v210 offset:57600
    ds_read_b64_tr_b16 a[198:199], v210 offset:59648
    v_mfma_f32_32x32x16_bf16 v[64:79], a[180:183], a[92:95], v[64:79]
    ds_read_b64_tr_b16 a[200:201], v211 offset:49408
    ds_read_b64_tr_b16 a[202:203], v211 offset:51456
    s_waitcnt lgkmcnt(6)
    v_mfma_f32_32x32x16_bf16 v[80:95], a[184:187], a[88:91], v[80:95]
    ds_read_b64_tr_b16 a[204:205], v211 offset:57600
    ds_read_b64_tr_b16 a[206:207], v211 offset:59648
    v_mfma_f32_32x32x16_bf16 v[80:95], a[188:191], a[92:95], v[80:95]
    ds_read_b64_tr_b16 a[176:177], v212
    ds_read_b64_tr_b16 a[178:179], v212 offset:2048
    s_waitcnt lgkmcnt(6)
    v_mfma_f32_32x32x16_bf16 v[96:111], a[192:195], a[88:91], v[96:111]
    ds_read_b64_tr_b16 a[180:181], v212 offset:8192
    ds_read_b64_tr_b16 a[182:183], v212 offset:10240
    v_mfma_f32_32x32x16_bf16 v[96:111], a[196:199], a[92:95], v[96:111]
    ds_read_b64_tr_b16 a[184:185], v213
    ds_read_b64_tr_b16 a[186:187], v213 offset:2048
    s_waitcnt lgkmcnt(6)
    v_mfma_f32_32x32x16_bf16 v[112:127], a[200:203], a[88:91], v[112:127]
    ds_read_b64_tr_b16 a[188:189], v213 offset:8192
    ds_read_b64_tr_b16 a[190:191], v213 offset:10240
    v_mfma_f32_32x32x16_bf16 v[112:127], a[204:207], a[92:95], v[112:127]
    s_barrier
    ds_read_b64_tr_b16 a[192:193], v214
    ds_read_b64_tr_b16 a[194:195], v214 offset:2048
    s_waitcnt lgkmcnt(6)
    s_waitcnt vmcnt(7)
    v_mfma_f32_32x32x16_bf16 v[0:15], a[176:179], a[96:99], v[0:15]
    buffer_load_dwordx4 a[128:131], v224, s[4:7], 0 offen offset:512
    ds_read_b64_tr_b16 a[196:197], v214 offset:8192
    ds_read_b64_tr_b16 a[198:199], v214 offset:10240
    s_waitcnt vmcnt(7)
    v_mfma_f32_32x32x16_bf16 v[0:15], a[180:183], a[100:103], v[0:15]
    ds_read_b64_tr_b16 a[200:201], v215
    ds_read_b64_tr_b16 a[202:203], v215 offset:2048
    s_waitcnt lgkmcnt(6)
    v_mfma_f32_32x32x16_bf16 v[16:31], a[184:187], a[96:99], v[16:31]
    ds_read_b64_tr_b16 a[204:205], v215 offset:8192
    ds_read_b64_tr_b16 a[206:207], v215 offset:10240
    v_mfma_f32_32x32x16_bf16 v[16:31], a[188:191], a[100:103], v[16:31]
    ds_read_b64_tr_b16 a[176:177], v212 offset:256
    ds_read_b64_tr_b16 a[178:179], v212 offset:2304
    s_waitcnt lgkmcnt(6)
    v_mfma_f32_32x32x16_bf16 v[32:47], a[192:195], a[96:99], v[32:47]
    ds_read_b64_tr_b16 a[180:181], v212 offset:8448
    ds_read_b64_tr_b16 a[182:183], v212 offset:10496
    v_mfma_f32_32x32x16_bf16 v[32:47], a[196:199], a[100:103], v[32:47]
    ds_read_b64_tr_b16 a[184:185], v213 offset:256
    ds_read_b64_tr_b16 a[186:187], v213 offset:2304
    s_waitcnt lgkmcnt(6)
    v_mfma_f32_32x32x16_bf16 v[48:63], a[200:203], a[96:99], v[48:63]
    ds_read_b64_tr_b16 a[188:189], v213 offset:8448
    ds_read_b64_tr_b16 a[190:191], v213 offset:10496
    v_mfma_f32_32x32x16_bf16 v[48:63], a[204:207], a[100:103], v[48:63]
    ds_read_b64_tr_b16 a[192:193], v214 offset:256
    ds_read_b64_tr_b16 a[194:195], v214 offset:2304
    s_waitcnt lgkmcnt(6)
    v_mfma_f32_32x32x16_bf16 v[64:79], a[176:179], a[96:99], v[64:79]
    buffer_load_dwordx4 a[132:135], v224, s[4:7], 0 offen offset:544
    ds_read_b64_tr_b16 a[196:197], v214 offset:8448
    ds_read_b64_tr_b16 a[198:199], v214 offset:10496
    v_mfma_f32_32x32x16_bf16 v[64:79], a[180:183], a[100:103], v[64:79]
    ds_read_b64_tr_b16 a[200:201], v215 offset:256
    ds_read_b64_tr_b16 a[202:203], v215 offset:2304
    s_waitcnt lgkmcnt(6)
    v_mfma_f32_32x32x16_bf16 v[80:95], a[184:187], a[96:99], v[80:95]
    ds_read_b64_tr_b16 a[204:205], v215 offset:8448
    ds_read_b64_tr_b16 a[206:207], v215 offset:10496
    v_mfma_f32_32x32x16_bf16 v[80:95], a[188:191], a[100:103], v[80:95]
    ds_read_b64_tr_b16 a[176:177], v212 offset:16384
    ds_read_b64_tr_b16 a[178:179], v212 offset:18432
    s_waitcnt lgkmcnt(6)
    v_mfma_f32_32x32x16_bf16 v[96:111], a[192:195], a[96:99], v[96:111]
    ds_read_b64_tr_b16 a[180:181], v212 offset:24576
    ds_read_b64_tr_b16 a[182:183], v212 offset:26624
    v_mfma_f32_32x32x16_bf16 v[96:111], a[196:199], a[100:103], v[96:111]
    ds_read_b64_tr_b16 a[184:185], v213 offset:16384
    ds_read_b64_tr_b16 a[186:187], v213 offset:18432
    s_waitcnt lgkmcnt(6)
    v_mfma_f32_32x32x16_bf16 v[112:127], a[200:203], a[96:99], v[112:127]
    ds_read_b64_tr_b16 a[188:189], v213 offset:24576
    ds_read_b64_tr_b16 a[190:191], v213 offset:26624
    v_mfma_f32_32x32x16_bf16 v[112:127], a[204:207], a[100:103], v[112:127]
    s_barrier
    ds_read_b64_tr_b16 a[192:193], v214 offset:16384
    ds_read_b64_tr_b16 a[194:195], v214 offset:18432
    s_waitcnt lgkmcnt(6)
    s_waitcnt vmcnt(7)
    v_mfma_f32_32x32x16_bf16 v[0:15], a[176:179], a[104:107], v[0:15]
    buffer_load_dwordx4 a[136:139], v224, s[4:7], 0 offen offset:576
    ds_read_b64_tr_b16 a[196:197], v214 offset:24576
    ds_read_b64_tr_b16 a[198:199], v214 offset:26624
    s_waitcnt vmcnt(7)
    v_mfma_f32_32x32x16_bf16 v[0:15], a[180:183], a[108:111], v[0:15]
    ds_read_b64_tr_b16 a[200:201], v215 offset:16384
    ds_read_b64_tr_b16 a[202:203], v215 offset:18432
    s_waitcnt lgkmcnt(6)
    v_mfma_f32_32x32x16_bf16 v[16:31], a[184:187], a[104:107], v[16:31]
    ds_read_b64_tr_b16 a[204:205], v215 offset:24576
    ds_read_b64_tr_b16 a[206:207], v215 offset:26624
    v_mfma_f32_32x32x16_bf16 v[16:31], a[188:191], a[108:111], v[16:31]
    ds_read_b64_tr_b16 a[176:177], v212 offset:16640
    ds_read_b64_tr_b16 a[178:179], v212 offset:18688
    s_waitcnt lgkmcnt(6)
    v_mfma_f32_32x32x16_bf16 v[32:47], a[192:195], a[104:107], v[32:47]
    ds_read_b64_tr_b16 a[180:181], v212 offset:24832
    ds_read_b64_tr_b16 a[182:183], v212 offset:26880
    v_mfma_f32_32x32x16_bf16 v[32:47], a[196:199], a[108:111], v[32:47]
    ds_read_b64_tr_b16 a[184:185], v213 offset:16640
    ds_read_b64_tr_b16 a[186:187], v213 offset:18688
    s_waitcnt lgkmcnt(6)
    v_mfma_f32_32x32x16_bf16 v[48:63], a[200:203], a[104:107], v[48:63]
    ds_read_b64_tr_b16 a[188:189], v213 offset:24832
    ds_read_b64_tr_b16 a[190:191], v213 offset:26880
    v_mfma_f32_32x32x16_bf16 v[48:63], a[204:207], a[108:111], v[48:63]
    ds_read_b64_tr_b16 a[192:193], v214 offset:16640
    ds_read_b64_tr_b16 a[194:195], v214 offset:18688
    s_waitcnt lgkmcnt(6)
    v_mfma_f32_32x32x16_bf16 v[64:79], a[176:179], a[104:107], v[64:79]
    buffer_load_dwordx4 a[140:143], v224, s[4:7], 0 offen offset:608
    ds_read_b64_tr_b16 a[196:197], v214 offset:24832
    ds_read_b64_tr_b16 a[198:199], v214 offset:26880
    v_mfma_f32_32x32x16_bf16 v[64:79], a[180:183], a[108:111], v[64:79]
    ds_read_b64_tr_b16 a[200:201], v215 offset:16640
    ds_read_b64_tr_b16 a[202:203], v215 offset:18688
    s_waitcnt lgkmcnt(6)
    v_mfma_f32_32x32x16_bf16 v[80:95], a[184:187], a[104:107], v[80:95]
    ds_read_b64_tr_b16 a[204:205], v215 offset:24832
    ds_read_b64_tr_b16 a[206:207], v215 offset:26880
    v_mfma_f32_32x32x16_bf16 v[80:95], a[188:191], a[108:111], v[80:95]
    ds_read_b64_tr_b16 a[176:177], v212 offset:32768
    ds_read_b64_tr_b16 a[178:179], v212 offset:34816
    s_waitcnt lgkmcnt(6)
    v_mfma_f32_32x32x16_bf16 v[96:111], a[192:195], a[104:107], v[96:111]
    ds_read_b64_tr_b16 a[180:181], v212 offset:40960
    ds_read_b64_tr_b16 a[182:183], v212 offset:43008
    v_mfma_f32_32x32x16_bf16 v[96:111], a[196:199], a[108:111], v[96:111]
    ds_read_b64_tr_b16 a[184:185], v213 offset:32768
    ds_read_b64_tr_b16 a[186:187], v213 offset:34816
    s_waitcnt lgkmcnt(6)
    v_mfma_f32_32x32x16_bf16 v[112:127], a[200:203], a[104:107], v[112:127]
    ds_read_b64_tr_b16 a[188:189], v213 offset:40960
    ds_read_b64_tr_b16 a[190:191], v213 offset:43008
    v_mfma_f32_32x32x16_bf16 v[112:127], a[204:207], a[108:111], v[112:127]
    s_barrier
    ds_read_b64_tr_b16 a[192:193], v214 offset:32768
    ds_read_b64_tr_b16 a[194:195], v214 offset:34816
    s_waitcnt lgkmcnt(6)
    s_waitcnt vmcnt(7)
    v_mfma_f32_32x32x16_bf16 v[0:15], a[176:179], a[112:115], v[0:15]
    buffer_load_dwordx4 a[144:147], v224, s[4:7], 0 offen offset:640
    ds_read_b64_tr_b16 a[196:197], v214 offset:40960
    ds_read_b64_tr_b16 a[198:199], v214 offset:43008
    s_waitcnt vmcnt(7)
    v_mfma_f32_32x32x16_bf16 v[0:15], a[180:183], a[116:119], v[0:15]
    ds_read_b64_tr_b16 a[200:201], v215 offset:32768
    ds_read_b64_tr_b16 a[202:203], v215 offset:34816
    s_waitcnt lgkmcnt(6)
    v_mfma_f32_32x32x16_bf16 v[16:31], a[184:187], a[112:115], v[16:31]
    ds_read_b64_tr_b16 a[204:205], v215 offset:40960
    ds_read_b64_tr_b16 a[206:207], v215 offset:43008
    v_mfma_f32_32x32x16_bf16 v[16:31], a[188:191], a[116:119], v[16:31]
    ds_read_b64_tr_b16 a[176:177], v212 offset:33024
    ds_read_b64_tr_b16 a[178:179], v212 offset:35072
    s_waitcnt lgkmcnt(6)
    v_mfma_f32_32x32x16_bf16 v[32:47], a[192:195], a[112:115], v[32:47]
    ds_read_b64_tr_b16 a[180:181], v212 offset:41216
    ds_read_b64_tr_b16 a[182:183], v212 offset:43264
    v_mfma_f32_32x32x16_bf16 v[32:47], a[196:199], a[116:119], v[32:47]
    ds_read_b64_tr_b16 a[184:185], v213 offset:33024
    ds_read_b64_tr_b16 a[186:187], v213 offset:35072
    s_waitcnt lgkmcnt(6)
    v_mfma_f32_32x32x16_bf16 v[48:63], a[200:203], a[112:115], v[48:63]
    ds_read_b64_tr_b16 a[188:189], v213 offset:41216
    ds_read_b64_tr_b16 a[190:191], v213 offset:43264
    v_mfma_f32_32x32x16_bf16 v[48:63], a[204:207], a[116:119], v[48:63]
    ds_read_b64_tr_b16 a[192:193], v214 offset:33024
    ds_read_b64_tr_b16 a[194:195], v214 offset:35072
    s_waitcnt lgkmcnt(6)
    v_mfma_f32_32x32x16_bf16 v[64:79], a[176:179], a[112:115], v[64:79]
    buffer_load_dwordx4 a[148:151], v224, s[4:7], 0 offen offset:672
    ds_read_b64_tr_b16 a[196:197], v214 offset:41216
    ds_read_b64_tr_b16 a[198:199], v214 offset:43264
    v_mfma_f32_32x32x16_bf16 v[64:79], a[180:183], a[116:119], v[64:79]
    ds_read_b64_tr_b16 a[200:201], v215 offset:33024
    ds_read_b64_tr_b16 a[202:203], v215 offset:35072
    s_waitcnt lgkmcnt(6)
    v_mfma_f32_32x32x16_bf16 v[80:95], a[184:187], a[112:115], v[80:95]
    ds_read_b64_tr_b16 a[204:205], v215 offset:41216
    ds_read_b64_tr_b16 a[206:207], v215 offset:43264
    v_mfma_f32_32x32x16_bf16 v[80:95], a[188:191], a[116:119], v[80:95]
    ds_read_b64_tr_b16 a[176:177], v212 offset:49152
    ds_read_b64_tr_b16 a[178:179], v212 offset:51200
    s_waitcnt lgkmcnt(6)
    v_mfma_f32_32x32x16_bf16 v[96:111], a[192:195], a[112:115], v[96:111]
    ds_read_b64_tr_b16 a[180:181], v212 offset:57344
    ds_read_b64_tr_b16 a[182:183], v212 offset:59392
    v_mfma_f32_32x32x16_bf16 v[96:111], a[196:199], a[116:119], v[96:111]
    ds_read_b64_tr_b16 a[184:185], v213 offset:49152
    ds_read_b64_tr_b16 a[186:187], v213 offset:51200
    s_waitcnt lgkmcnt(6)
    v_mfma_f32_32x32x16_bf16 v[112:127], a[200:203], a[112:115], v[112:127]
    ds_read_b64_tr_b16 a[188:189], v213 offset:57344
    ds_read_b64_tr_b16 a[190:191], v213 offset:59392
    v_mfma_f32_32x32x16_bf16 v[112:127], a[204:207], a[116:119], v[112:127]
    s_barrier
    ds_read_b64_tr_b16 a[192:193], v214 offset:49152
    ds_read_b64_tr_b16 a[194:195], v214 offset:51200
    s_waitcnt lgkmcnt(6)
    s_waitcnt vmcnt(7)
    v_mfma_f32_32x32x16_bf16 v[0:15], a[176:179], a[120:123], v[0:15]
    buffer_load_dwordx4 a[152:155], v224, s[4:7], 0 offen offset:704
    ds_read_b64_tr_b16 a[196:197], v214 offset:57344
    ds_read_b64_tr_b16 a[198:199], v214 offset:59392
    s_waitcnt vmcnt(7)
    v_mfma_f32_32x32x16_bf16 v[0:15], a[180:183], a[124:127], v[0:15]
    ds_read_b64_tr_b16 a[200:201], v215 offset:49152
    ds_read_b64_tr_b16 a[202:203], v215 offset:51200
    s_waitcnt lgkmcnt(6)
    v_mfma_f32_32x32x16_bf16 v[16:31], a[184:187], a[120:123], v[16:31]
    ds_read_b64_tr_b16 a[204:205], v215 offset:57344
    ds_read_b64_tr_b16 a[206:207], v215 offset:59392
    v_mfma_f32_32x32x16_bf16 v[16:31], a[188:191], a[124:127], v[16:31]
    ds_read_b64_tr_b16 a[176:177], v212 offset:49408
    ds_read_b64_tr_b16 a[178:179], v212 offset:51456
    s_waitcnt lgkmcnt(6)
    v_mfma_f32_32x32x16_bf16 v[32:47], a[192:195], a[120:123], v[32:47]
    ds_read_b64_tr_b16 a[180:181], v212 offset:57600
    ds_read_b64_tr_b16 a[182:183], v212 offset:59648
    v_mfma_f32_32x32x16_bf16 v[32:47], a[196:199], a[124:127], v[32:47]
    ds_read_b64_tr_b16 a[184:185], v213 offset:49408
    ds_read_b64_tr_b16 a[186:187], v213 offset:51456
    s_waitcnt lgkmcnt(6)
    v_mfma_f32_32x32x16_bf16 v[48:63], a[200:203], a[120:123], v[48:63]
    ds_read_b64_tr_b16 a[188:189], v213 offset:57600
    ds_read_b64_tr_b16 a[190:191], v213 offset:59648
    v_mfma_f32_32x32x16_bf16 v[48:63], a[204:207], a[124:127], v[48:63]
    ds_read_b64_tr_b16 a[192:193], v214 offset:49408
    ds_read_b64_tr_b16 a[194:195], v214 offset:51456
    s_waitcnt lgkmcnt(6)
    v_mfma_f32_32x32x16_bf16 v[64:79], a[176:179], a[120:123], v[64:79]
    buffer_load_dwordx4 a[156:159], v224, s[4:7], 0 offen offset:736
    ds_read_b64_tr_b16 a[196:197], v214 offset:57600
    ds_read_b64_tr_b16 a[198:199], v214 offset:59648
    v_mfma_f32_32x32x16_bf16 v[64:79], a[180:183], a[124:127], v[64:79]
    ds_read_b64_tr_b16 a[200:201], v215 offset:49408
    ds_read_b64_tr_b16 a[202:203], v215 offset:51456
    s_waitcnt lgkmcnt(6)
    v_mfma_f32_32x32x16_bf16 v[80:95], a[184:187], a[120:123], v[80:95]
    ds_read_b64_tr_b16 a[204:205], v215 offset:57600
    ds_read_b64_tr_b16 a[206:207], v215 offset:59648
    v_mfma_f32_32x32x16_bf16 v[80:95], a[188:191], a[124:127], v[80:95]
    ds_read_b64_tr_b16 a[176:177], v208
    ds_read_b64_tr_b16 a[178:179], v208 offset:2048
    s_waitcnt lgkmcnt(6)
    v_mfma_f32_32x32x16_bf16 v[96:111], a[192:195], a[120:123], v[96:111]
    ds_read_b64_tr_b16 a[180:181], v208 offset:8192
    ds_read_b64_tr_b16 a[182:183], v208 offset:10240
    v_mfma_f32_32x32x16_bf16 v[96:111], a[196:199], a[124:127], v[96:111]
    ds_read_b64_tr_b16 a[184:185], v209
    ds_read_b64_tr_b16 a[186:187], v209 offset:2048
    s_waitcnt lgkmcnt(6)
    v_mfma_f32_32x32x16_bf16 v[112:127], a[200:203], a[120:123], v[112:127]
    ds_read_b64_tr_b16 a[188:189], v209 offset:8192
    ds_read_b64_tr_b16 a[190:191], v209 offset:10240
    v_mfma_f32_32x32x16_bf16 v[112:127], a[204:207], a[124:127], v[112:127]
    s_barrier
    ds_read_b64_tr_b16 a[192:193], v210
    ds_read_b64_tr_b16 a[194:195], v210 offset:2048
    s_waitcnt lgkmcnt(6)
    s_waitcnt vmcnt(7)
    v_mfma_f32_32x32x16_bf16 v[0:15], a[176:179], a[128:131], v[0:15]
    buffer_load_dwordx4 a[160:163], v224, s[4:7], 0 offen offset:768
    ds_read_b64_tr_b16 a[196:197], v210 offset:8192
    ds_read_b64_tr_b16 a[198:199], v210 offset:10240
    s_waitcnt vmcnt(7)
    v_mfma_f32_32x32x16_bf16 v[0:15], a[180:183], a[132:135], v[0:15]
    ds_read_b64_tr_b16 a[200:201], v211
    ds_read_b64_tr_b16 a[202:203], v211 offset:2048
    s_waitcnt lgkmcnt(6)
    v_mfma_f32_32x32x16_bf16 v[16:31], a[184:187], a[128:131], v[16:31]
    ds_read_b64_tr_b16 a[204:205], v211 offset:8192
    ds_read_b64_tr_b16 a[206:207], v211 offset:10240
    v_mfma_f32_32x32x16_bf16 v[16:31], a[188:191], a[132:135], v[16:31]
    ds_read_b64_tr_b16 a[176:177], v208 offset:256
    ds_read_b64_tr_b16 a[178:179], v208 offset:2304
    s_waitcnt lgkmcnt(6)
    v_mfma_f32_32x32x16_bf16 v[32:47], a[192:195], a[128:131], v[32:47]
    ds_read_b64_tr_b16 a[180:181], v208 offset:8448
    ds_read_b64_tr_b16 a[182:183], v208 offset:10496
    v_mfma_f32_32x32x16_bf16 v[32:47], a[196:199], a[132:135], v[32:47]
    ds_read_b64_tr_b16 a[184:185], v209 offset:256
    ds_read_b64_tr_b16 a[186:187], v209 offset:2304
    s_waitcnt lgkmcnt(6)
    v_mfma_f32_32x32x16_bf16 v[48:63], a[200:203], a[128:131], v[48:63]
    ds_read_b64_tr_b16 a[188:189], v209 offset:8448
    ds_read_b64_tr_b16 a[190:191], v209 offset:10496
    v_mfma_f32_32x32x16_bf16 v[48:63], a[204:207], a[132:135], v[48:63]
    ds_read_b64_tr_b16 a[192:193], v210 offset:256
    ds_read_b64_tr_b16 a[194:195], v210 offset:2304
    s_waitcnt lgkmcnt(6)
    v_mfma_f32_32x32x16_bf16 v[64:79], a[176:179], a[128:131], v[64:79]
    buffer_load_dwordx4 a[164:167], v224, s[4:7], 0 offen offset:800
    ds_read_b64_tr_b16 a[196:197], v210 offset:8448
    ds_read_b64_tr_b16 a[198:199], v210 offset:10496
    v_mfma_f32_32x32x16_bf16 v[64:79], a[180:183], a[132:135], v[64:79]
    ds_read_b64_tr_b16 a[200:201], v211 offset:256
    ds_read_b64_tr_b16 a[202:203], v211 offset:2304
    s_waitcnt lgkmcnt(6)
    v_mfma_f32_32x32x16_bf16 v[80:95], a[184:187], a[128:131], v[80:95]
    ds_read_b64_tr_b16 a[204:205], v211 offset:8448
    ds_read_b64_tr_b16 a[206:207], v211 offset:10496
    v_mfma_f32_32x32x16_bf16 v[80:95], a[188:191], a[132:135], v[80:95]
    ds_read_b64_tr_b16 a[176:177], v208 offset:16384
    ds_read_b64_tr_b16 a[178:179], v208 offset:18432
    s_waitcnt lgkmcnt(6)
    v_mfma_f32_32x32x16_bf16 v[96:111], a[192:195], a[128:131], v[96:111]
    ds_read_b64_tr_b16 a[180:181], v208 offset:24576
    ds_read_b64_tr_b16 a[182:183], v208 offset:26624
    v_mfma_f32_32x32x16_bf16 v[96:111], a[196:199], a[132:135], v[96:111]
    ds_read_b64_tr_b16 a[184:185], v209 offset:16384
    ds_read_b64_tr_b16 a[186:187], v209 offset:18432
    s_waitcnt lgkmcnt(6)
    v_mfma_f32_32x32x16_bf16 v[112:127], a[200:203], a[128:131], v[112:127]
    ds_read_b64_tr_b16 a[188:189], v209 offset:24576
    ds_read_b64_tr_b16 a[190:191], v209 offset:26624
    v_mfma_f32_32x32x16_bf16 v[112:127], a[204:207], a[132:135], v[112:127]
    s_barrier
    ds_read_b64_tr_b16 a[192:193], v210 offset:16384
    ds_read_b64_tr_b16 a[194:195], v210 offset:18432
    s_waitcnt lgkmcnt(6)
    s_waitcnt vmcnt(7)
    v_mfma_f32_32x32x16_bf16 v[0:15], a[176:179], a[136:139], v[0:15]
    buffer_load_dwordx4 a[168:171], v224, s[4:7], 0 offen offset:832
    ds_read_b64_tr_b16 a[196:197], v210 offset:24576
    ds_read_b64_tr_b16 a[198:199], v210 offset:26624
    s_waitcnt vmcnt(7)
    v_mfma_f32_32x32x16_bf16 v[0:15], a[180:183], a[140:143], v[0:15]
    ds_read_b64_tr_b16 a[200:201], v211 offset:16384
    ds_read_b64_tr_b16 a[202:203], v211 offset:18432
    s_waitcnt lgkmcnt(6)
    v_mfma_f32_32x32x16_bf16 v[16:31], a[184:187], a[136:139], v[16:31]
    ds_read_b64_tr_b16 a[204:205], v211 offset:24576
    ds_read_b64_tr_b16 a[206:207], v211 offset:26624
    v_mfma_f32_32x32x16_bf16 v[16:31], a[188:191], a[140:143], v[16:31]
    ds_read_b64_tr_b16 a[176:177], v208 offset:16640
    ds_read_b64_tr_b16 a[178:179], v208 offset:18688
    s_waitcnt lgkmcnt(6)
    v_mfma_f32_32x32x16_bf16 v[32:47], a[192:195], a[136:139], v[32:47]
    ds_read_b64_tr_b16 a[180:181], v208 offset:24832
    ds_read_b64_tr_b16 a[182:183], v208 offset:26880
    v_mfma_f32_32x32x16_bf16 v[32:47], a[196:199], a[140:143], v[32:47]
    ds_read_b64_tr_b16 a[184:185], v209 offset:16640
    ds_read_b64_tr_b16 a[186:187], v209 offset:18688
    s_waitcnt lgkmcnt(6)
    v_mfma_f32_32x32x16_bf16 v[48:63], a[200:203], a[136:139], v[48:63]
    ds_read_b64_tr_b16 a[188:189], v209 offset:24832
    ds_read_b64_tr_b16 a[190:191], v209 offset:26880
    v_mfma_f32_32x32x16_bf16 v[48:63], a[204:207], a[140:143], v[48:63]
    ds_read_b64_tr_b16 a[192:193], v210 offset:16640
    ds_read_b64_tr_b16 a[194:195], v210 offset:18688
    s_waitcnt lgkmcnt(6)
    v_mfma_f32_32x32x16_bf16 v[64:79], a[176:179], a[136:139], v[64:79]
    buffer_load_dwordx4 a[172:175], v224, s[4:7], 0 offen offset:864
    ds_read_b64_tr_b16 a[196:197], v210 offset:24832
    ds_read_b64_tr_b16 a[198:199], v210 offset:26880
    v_mfma_f32_32x32x16_bf16 v[64:79], a[180:183], a[140:143], v[64:79]
    ds_read_b64_tr_b16 a[200:201], v211 offset:16640
    ds_read_b64_tr_b16 a[202:203], v211 offset:18688
    s_waitcnt lgkmcnt(6)
    v_mfma_f32_32x32x16_bf16 v[80:95], a[184:187], a[136:139], v[80:95]
    ds_read_b64_tr_b16 a[204:205], v211 offset:24832
    ds_read_b64_tr_b16 a[206:207], v211 offset:26880
    v_mfma_f32_32x32x16_bf16 v[80:95], a[188:191], a[140:143], v[80:95]
    ds_read_b64_tr_b16 a[176:177], v208 offset:32768
    ds_read_b64_tr_b16 a[178:179], v208 offset:34816
    s_waitcnt lgkmcnt(6)
    v_mfma_f32_32x32x16_bf16 v[96:111], a[192:195], a[136:139], v[96:111]
    ds_read_b64_tr_b16 a[180:181], v208 offset:40960
    ds_read_b64_tr_b16 a[182:183], v208 offset:43008
    v_mfma_f32_32x32x16_bf16 v[96:111], a[196:199], a[140:143], v[96:111]
    ds_read_b64_tr_b16 a[184:185], v209 offset:32768
    ds_read_b64_tr_b16 a[186:187], v209 offset:34816
    s_waitcnt lgkmcnt(6)
    v_mfma_f32_32x32x16_bf16 v[112:127], a[200:203], a[136:139], v[112:127]
    ds_read_b64_tr_b16 a[188:189], v209 offset:40960
    ds_read_b64_tr_b16 a[190:191], v209 offset:43008
    v_mfma_f32_32x32x16_bf16 v[112:127], a[204:207], a[140:143], v[112:127]
    s_barrier
    ds_read_b64_tr_b16 a[192:193], v210 offset:32768
    ds_read_b64_tr_b16 a[194:195], v210 offset:34816
    s_waitcnt lgkmcnt(6)
    s_waitcnt vmcnt(7)
    v_mfma_f32_32x32x16_bf16 v[0:15], a[176:179], a[144:147], v[0:15]
    ds_read_b64_tr_b16 a[196:197], v210 offset:40960
    ds_read_b64_tr_b16 a[198:199], v210 offset:43008
    s_waitcnt vmcnt(6)
    v_mfma_f32_32x32x16_bf16 v[0:15], a[180:183], a[148:151], v[0:15]
    ds_read_b64_tr_b16 a[200:201], v211 offset:32768
    ds_read_b64_tr_b16 a[202:203], v211 offset:34816
    s_waitcnt lgkmcnt(6)
    v_mfma_f32_32x32x16_bf16 v[16:31], a[184:187], a[144:147], v[16:31]
    ds_read_b64_tr_b16 a[204:205], v211 offset:40960
    ds_read_b64_tr_b16 a[206:207], v211 offset:43008
    v_mfma_f32_32x32x16_bf16 v[16:31], a[188:191], a[148:151], v[16:31]
    ds_read_b64_tr_b16 a[176:177], v208 offset:33024
    ds_read_b64_tr_b16 a[178:179], v208 offset:35072
    s_waitcnt lgkmcnt(6)
    v_mfma_f32_32x32x16_bf16 v[32:47], a[192:195], a[144:147], v[32:47]
    ds_read_b64_tr_b16 a[180:181], v208 offset:41216
    ds_read_b64_tr_b16 a[182:183], v208 offset:43264
    v_mfma_f32_32x32x16_bf16 v[32:47], a[196:199], a[148:151], v[32:47]
    ds_read_b64_tr_b16 a[184:185], v209 offset:33024
    ds_read_b64_tr_b16 a[186:187], v209 offset:35072
    s_waitcnt lgkmcnt(6)
    v_mfma_f32_32x32x16_bf16 v[48:63], a[200:203], a[144:147], v[48:63]
    ds_read_b64_tr_b16 a[188:189], v209 offset:41216
    ds_read_b64_tr_b16 a[190:191], v209 offset:43264
    v_mfma_f32_32x32x16_bf16 v[48:63], a[204:207], a[148:151], v[48:63]
    ds_read_b64_tr_b16 a[192:193], v210 offset:33024
    ds_read_b64_tr_b16 a[194:195], v210 offset:35072
    s_waitcnt lgkmcnt(6)
    v_mfma_f32_32x32x16_bf16 v[64:79], a[176:179], a[144:147], v[64:79]
    ds_read_b64_tr_b16 a[196:197], v210 offset:41216
    ds_read_b64_tr_b16 a[198:199], v210 offset:43264
    v_mfma_f32_32x32x16_bf16 v[64:79], a[180:183], a[148:151], v[64:79]
    ds_read_b64_tr_b16 a[200:201], v211 offset:33024
    ds_read_b64_tr_b16 a[202:203], v211 offset:35072
    s_waitcnt lgkmcnt(6)
    v_mfma_f32_32x32x16_bf16 v[80:95], a[184:187], a[144:147], v[80:95]
    ds_read_b64_tr_b16 a[204:205], v211 offset:41216
    ds_read_b64_tr_b16 a[206:207], v211 offset:43264
    v_mfma_f32_32x32x16_bf16 v[80:95], a[188:191], a[148:151], v[80:95]
    ds_read_b64_tr_b16 a[176:177], v208 offset:49152
    ds_read_b64_tr_b16 a[178:179], v208 offset:51200
    s_waitcnt lgkmcnt(6)
    v_mfma_f32_32x32x16_bf16 v[96:111], a[192:195], a[144:147], v[96:111]
    ds_read_b64_tr_b16 a[180:181], v208 offset:57344
    ds_read_b64_tr_b16 a[182:183], v208 offset:59392
    v_mfma_f32_32x32x16_bf16 v[96:111], a[196:199], a[148:151], v[96:111]
    ds_read_b64_tr_b16 a[184:185], v209 offset:49152
    ds_read_b64_tr_b16 a[186:187], v209 offset:51200
    s_waitcnt lgkmcnt(6)
    v_mfma_f32_32x32x16_bf16 v[112:127], a[200:203], a[144:147], v[112:127]
    ds_read_b64_tr_b16 a[188:189], v209 offset:57344
    ds_read_b64_tr_b16 a[190:191], v209 offset:59392
    v_mfma_f32_32x32x16_bf16 v[112:127], a[204:207], a[148:151], v[112:127]
    s_barrier
    ds_read_b64_tr_b16 a[192:193], v210 offset:49152
    ds_read_b64_tr_b16 a[194:195], v210 offset:51200
    s_waitcnt lgkmcnt(6)
    s_waitcnt vmcnt(5)
    v_mfma_f32_32x32x16_bf16 v[0:15], a[176:179], a[152:155], v[0:15]
    ds_read_b64_tr_b16 a[196:197], v210 offset:57344
    ds_read_b64_tr_b16 a[198:199], v210 offset:59392
    s_waitcnt vmcnt(4)
    v_mfma_f32_32x32x16_bf16 v[0:15], a[180:183], a[156:159], v[0:15]
    ds_read_b64_tr_b16 a[200:201], v211 offset:49152
    ds_read_b64_tr_b16 a[202:203], v211 offset:51200
    s_waitcnt lgkmcnt(6)
    v_mfma_f32_32x32x16_bf16 v[16:31], a[184:187], a[152:155], v[16:31]
    ds_read_b64_tr_b16 a[204:205], v211 offset:57344
    ds_read_b64_tr_b16 a[206:207], v211 offset:59392
    v_mfma_f32_32x32x16_bf16 v[16:31], a[188:191], a[156:159], v[16:31]
    ds_read_b64_tr_b16 a[176:177], v208 offset:49408
    ds_read_b64_tr_b16 a[178:179], v208 offset:51456
    s_waitcnt lgkmcnt(6)
    v_mfma_f32_32x32x16_bf16 v[32:47], a[192:195], a[152:155], v[32:47]
    ds_read_b64_tr_b16 a[180:181], v208 offset:57600
    ds_read_b64_tr_b16 a[182:183], v208 offset:59648
    v_mfma_f32_32x32x16_bf16 v[32:47], a[196:199], a[156:159], v[32:47]
    ds_read_b64_tr_b16 a[184:185], v209 offset:49408
    ds_read_b64_tr_b16 a[186:187], v209 offset:51456
    s_waitcnt lgkmcnt(6)
    v_mfma_f32_32x32x16_bf16 v[48:63], a[200:203], a[152:155], v[48:63]
    ds_read_b64_tr_b16 a[188:189], v209 offset:57600
    ds_read_b64_tr_b16 a[190:191], v209 offset:59648
    v_mfma_f32_32x32x16_bf16 v[48:63], a[204:207], a[156:159], v[48:63]
    ds_read_b64_tr_b16 a[192:193], v210 offset:49408
    ds_read_b64_tr_b16 a[194:195], v210 offset:51456
    s_waitcnt lgkmcnt(6)
    v_mfma_f32_32x32x16_bf16 v[64:79], a[176:179], a[152:155], v[64:79]
    ds_read_b64_tr_b16 a[196:197], v210 offset:57600
    ds_read_b64_tr_b16 a[198:199], v210 offset:59648
    v_mfma_f32_32x32x16_bf16 v[64:79], a[180:183], a[156:159], v[64:79]
    ds_read_b64_tr_b16 a[200:201], v211 offset:49408
    ds_read_b64_tr_b16 a[202:203], v211 offset:51456
    s_waitcnt lgkmcnt(6)
    v_mfma_f32_32x32x16_bf16 v[80:95], a[184:187], a[152:155], v[80:95]
    ds_read_b64_tr_b16 a[204:205], v211 offset:57600
    ds_read_b64_tr_b16 a[206:207], v211 offset:59648
    v_mfma_f32_32x32x16_bf16 v[80:95], a[188:191], a[156:159], v[80:95]
    ds_read_b64_tr_b16 a[176:177], v212
    ds_read_b64_tr_b16 a[178:179], v212 offset:2048
    s_waitcnt lgkmcnt(6)
    v_mfma_f32_32x32x16_bf16 v[96:111], a[192:195], a[152:155], v[96:111]
    ds_read_b64_tr_b16 a[180:181], v212 offset:8192
    ds_read_b64_tr_b16 a[182:183], v212 offset:10240
    v_mfma_f32_32x32x16_bf16 v[96:111], a[196:199], a[156:159], v[96:111]
    ds_read_b64_tr_b16 a[184:185], v213
    ds_read_b64_tr_b16 a[186:187], v213 offset:2048
    s_waitcnt lgkmcnt(6)
    v_mfma_f32_32x32x16_bf16 v[112:127], a[200:203], a[152:155], v[112:127]
    ds_read_b64_tr_b16 a[188:189], v213 offset:8192
    ds_read_b64_tr_b16 a[190:191], v213 offset:10240
    v_mfma_f32_32x32x16_bf16 v[112:127], a[204:207], a[156:159], v[112:127]
    s_barrier
    ds_read_b64_tr_b16 a[192:193], v214
    ds_read_b64_tr_b16 a[194:195], v214 offset:2048
    s_waitcnt lgkmcnt(6)
    s_waitcnt vmcnt(3)
    v_mfma_f32_32x32x16_bf16 v[0:15], a[176:179], a[160:163], v[0:15]
    ds_read_b64_tr_b16 a[196:197], v214 offset:8192
    ds_read_b64_tr_b16 a[198:199], v214 offset:10240
    s_waitcnt vmcnt(2)
    v_mfma_f32_32x32x16_bf16 v[0:15], a[180:183], a[164:167], v[0:15]
    ds_read_b64_tr_b16 a[200:201], v215
    ds_read_b64_tr_b16 a[202:203], v215 offset:2048
    s_waitcnt lgkmcnt(6)
    v_mfma_f32_32x32x16_bf16 v[16:31], a[184:187], a[160:163], v[16:31]
    ds_read_b64_tr_b16 a[204:205], v215 offset:8192
    ds_read_b64_tr_b16 a[206:207], v215 offset:10240
    v_mfma_f32_32x32x16_bf16 v[16:31], a[188:191], a[164:167], v[16:31]
    ds_read_b64_tr_b16 a[176:177], v212 offset:256
    ds_read_b64_tr_b16 a[178:179], v212 offset:2304
    s_waitcnt lgkmcnt(6)
    v_mfma_f32_32x32x16_bf16 v[32:47], a[192:195], a[160:163], v[32:47]
    ds_read_b64_tr_b16 a[180:181], v212 offset:8448
    ds_read_b64_tr_b16 a[182:183], v212 offset:10496
    v_mfma_f32_32x32x16_bf16 v[32:47], a[196:199], a[164:167], v[32:47]
    ds_read_b64_tr_b16 a[184:185], v213 offset:256
    ds_read_b64_tr_b16 a[186:187], v213 offset:2304
    s_waitcnt lgkmcnt(6)
    v_mfma_f32_32x32x16_bf16 v[48:63], a[200:203], a[160:163], v[48:63]
    ds_read_b64_tr_b16 a[188:189], v213 offset:8448
    ds_read_b64_tr_b16 a[190:191], v213 offset:10496
    v_mfma_f32_32x32x16_bf16 v[48:63], a[204:207], a[164:167], v[48:63]
    ds_read_b64_tr_b16 a[192:193], v214 offset:256
    ds_read_b64_tr_b16 a[194:195], v214 offset:2304
    s_waitcnt lgkmcnt(6)
    v_mfma_f32_32x32x16_bf16 v[64:79], a[176:179], a[160:163], v[64:79]
    ds_read_b64_tr_b16 a[196:197], v214 offset:8448
    ds_read_b64_tr_b16 a[198:199], v214 offset:10496
    v_mfma_f32_32x32x16_bf16 v[64:79], a[180:183], a[164:167], v[64:79]
    ds_read_b64_tr_b16 a[200:201], v215 offset:256
    ds_read_b64_tr_b16 a[202:203], v215 offset:2304
    s_waitcnt lgkmcnt(6)
    v_mfma_f32_32x32x16_bf16 v[80:95], a[184:187], a[160:163], v[80:95]
    ds_read_b64_tr_b16 a[204:205], v215 offset:8448
    ds_read_b64_tr_b16 a[206:207], v215 offset:10496
    v_mfma_f32_32x32x16_bf16 v[80:95], a[188:191], a[164:167], v[80:95]
    ds_read_b64_tr_b16 a[176:177], v212 offset:16384
    ds_read_b64_tr_b16 a[178:179], v212 offset:18432
    s_waitcnt lgkmcnt(6)
    v_mfma_f32_32x32x16_bf16 v[96:111], a[192:195], a[160:163], v[96:111]
    ds_read_b64_tr_b16 a[180:181], v212 offset:24576
    ds_read_b64_tr_b16 a[182:183], v212 offset:26624
    v_mfma_f32_32x32x16_bf16 v[96:111], a[196:199], a[164:167], v[96:111]
    ds_read_b64_tr_b16 a[184:185], v213 offset:16384
    ds_read_b64_tr_b16 a[186:187], v213 offset:18432
    s_waitcnt lgkmcnt(6)
    v_mfma_f32_32x32x16_bf16 v[112:127], a[200:203], a[160:163], v[112:127]
    ds_read_b64_tr_b16 a[188:189], v213 offset:24576
    ds_read_b64_tr_b16 a[190:191], v213 offset:26624
    v_mfma_f32_32x32x16_bf16 v[112:127], a[204:207], a[164:167], v[112:127]
    s_barrier
    ds_read_b64_tr_b16 a[192:193], v214 offset:16384
    ds_read_b64_tr_b16 a[194:195], v214 offset:18432
    s_waitcnt lgkmcnt(6)
    s_waitcnt vmcnt(1)
    v_mfma_f32_32x32x16_bf16 v[0:15], a[176:179], a[168:171], v[0:15]
    ds_read_b64_tr_b16 a[196:197], v214 offset:24576
    ds_read_b64_tr_b16 a[198:199], v214 offset:26624
    s_waitcnt vmcnt(0)
    v_mfma_f32_32x32x16_bf16 v[0:15], a[180:183], a[172:175], v[0:15]
    ds_read_b64_tr_b16 a[200:201], v215 offset:16384
    ds_read_b64_tr_b16 a[202:203], v215 offset:18432
    s_waitcnt lgkmcnt(6)
    v_mfma_f32_32x32x16_bf16 v[16:31], a[184:187], a[168:171], v[16:31]
    ds_read_b64_tr_b16 a[204:205], v215 offset:24576
    ds_read_b64_tr_b16 a[206:207], v215 offset:26624
    v_mfma_f32_32x32x16_bf16 v[16:31], a[188:191], a[172:175], v[16:31]
    ds_read_b64_tr_b16 a[176:177], v212 offset:16640
    ds_read_b64_tr_b16 a[178:179], v212 offset:18688
    s_waitcnt lgkmcnt(6)
    v_mfma_f32_32x32x16_bf16 v[32:47], a[192:195], a[168:171], v[32:47]
    ds_read_b64_tr_b16 a[180:181], v212 offset:24832
    ds_read_b64_tr_b16 a[182:183], v212 offset:26880
    v_mfma_f32_32x32x16_bf16 v[32:47], a[196:199], a[172:175], v[32:47]
    ds_read_b64_tr_b16 a[184:185], v213 offset:16640
    ds_read_b64_tr_b16 a[186:187], v213 offset:18688
    s_waitcnt lgkmcnt(6)
    v_mfma_f32_32x32x16_bf16 v[48:63], a[200:203], a[168:171], v[48:63]
    ds_read_b64_tr_b16 a[188:189], v213 offset:24832
    ds_read_b64_tr_b16 a[190:191], v213 offset:26880
    v_mfma_f32_32x32x16_bf16 v[48:63], a[204:207], a[172:175], v[48:63]
    ds_read_b64_tr_b16 a[192:193], v214 offset:16640
    ds_read_b64_tr_b16 a[194:195], v214 offset:18688
    s_waitcnt lgkmcnt(6)
    v_mfma_f32_32x32x16_bf16 v[64:79], a[176:179], a[168:171], v[64:79]
    ds_read_b64_tr_b16 a[196:197], v214 offset:24832
    ds_read_b64_tr_b16 a[198:199], v214 offset:26880
    v_mfma_f32_32x32x16_bf16 v[64:79], a[180:183], a[172:175], v[64:79]
    ds_read_b64_tr_b16 a[200:201], v215 offset:16640
    ds_read_b64_tr_b16 a[202:203], v215 offset:18688
    s_waitcnt lgkmcnt(6)
    v_mfma_f32_32x32x16_bf16 v[80:95], a[184:187], a[168:171], v[80:95]
    ds_read_b64_tr_b16 a[204:205], v215 offset:24832
    ds_read_b64_tr_b16 a[206:207], v215 offset:26880
    v_mfma_f32_32x32x16_bf16 v[80:95], a[188:191], a[172:175], v[80:95]
    ds_read_b128 a[176:179], v232 offset:32768
    s_waitcnt lgkmcnt(5)
    v_mfma_f32_32x32x16_bf16 v[96:111], a[192:195], a[168:171], v[96:111]
    ds_read_b128 a[180:183], v233 offset:32768
    v_mfma_f32_32x32x16_bf16 v[96:111], a[196:199], a[172:175], v[96:111]
    ds_read_b128 a[184:187], v234 offset:32768
    s_waitcnt lgkmcnt(3)
    v_mfma_f32_32x32x16_bf16 v[112:127], a[200:203], a[168:171], v[112:127]
    ds_read_b128 a[188:191], v235 offset:32768
    v_mfma_f32_32x32x16_bf16 v[112:127], a[204:207], a[172:175], v[112:127]
    v_cvt_pk_bf16_f32 v220, v0, v1
    v_accvgpr_write_b32 a0, v220
    v_cvt_pk_bf16_f32 v221, v2, v3
    v_accvgpr_write_b32 a1, v221
    v_cvt_pk_bf16_f32 v220, v4, v5
    v_accvgpr_write_b32 a2, v220
    v_cvt_pk_bf16_f32 v221, v6, v7
    v_accvgpr_write_b32 a3, v221
    v_cvt_pk_bf16_f32 v220, v8, v9
    v_accvgpr_write_b32 a4, v220
    v_cvt_pk_bf16_f32 v221, v10, v11
    v_accvgpr_write_b32 a5, v221
    v_cvt_pk_bf16_f32 v220, v12, v13
    v_accvgpr_write_b32 a6, v220
    v_cvt_pk_bf16_f32 v221, v14, v15
    v_accvgpr_write_b32 a7, v221
    v_cvt_pk_bf16_f32 v220, v16, v17
    v_accvgpr_write_b32 a8, v220
    v_cvt_pk_bf16_f32 v221, v18, v19
    v_accvgpr_write_b32 a9, v221
    v_cvt_pk_bf16_f32 v220, v20, v21
    v_accvgpr_write_b32 a10, v220
    v_cvt_pk_bf16_f32 v221, v22, v23
    v_accvgpr_write_b32 a11, v221
    v_cvt_pk_bf16_f32 v220, v24, v25
    v_accvgpr_write_b32 a12, v220
    v_cvt_pk_bf16_f32 v221, v26, v27
    v_accvgpr_write_b32 a13, v221
    v_cvt_pk_bf16_f32 v220, v28, v29
    v_accvgpr_write_b32 a14, v220
    v_cvt_pk_bf16_f32 v221, v30, v31
    v_accvgpr_write_b32 a15, v221
    v_cvt_pk_bf16_f32 v220, v32, v33
    v_accvgpr_write_b32 a16, v220
    v_cvt_pk_bf16_f32 v221, v34, v35
    v_accvgpr_write_b32 a17, v221
    v_cvt_pk_bf16_f32 v220, v36, v37
    v_accvgpr_write_b32 a18, v220
    v_cvt_pk_bf16_f32 v221, v38, v39
    v_accvgpr_write_b32 a19, v221
    v_cvt_pk_bf16_f32 v220, v40, v41
    v_accvgpr_write_b32 a20, v220
    v_cvt_pk_bf16_f32 v221, v42, v43
    v_accvgpr_write_b32 a21, v221
    v_cvt_pk_bf16_f32 v220, v44, v45
    v_accvgpr_write_b32 a22, v220
    v_cvt_pk_bf16_f32 v221, v46, v47
    v_accvgpr_write_b32 a23, v221
    v_cvt_pk_bf16_f32 v220, v48, v49
    v_accvgpr_write_b32 a24, v220
    v_cvt_pk_bf16_f32 v221, v50, v51
    v_accvgpr_write_b32 a25, v221
    v_cvt_pk_bf16_f32 v220, v52, v53
    v_accvgpr_write_b32 a26, v220
    v_cvt_pk_bf16_f32 v221, v54, v55
    v_accvgpr_write_b32 a27, v221
    v_cvt_pk_bf16_f32 v220, v56, v57
    v_accvgpr_write_b32 a28, v220
    v_cvt_pk_bf16_f32 v221, v58, v59
    v_accvgpr_write_b32 a29, v221
    v_cvt_pk_bf16_f32 v220, v60, v61
    v_accvgpr_write_b32 a30, v220
    v_cvt_pk_bf16_f32 v221, v62, v63
    v_accvgpr_write_b32 a31, v221
    v_cvt_pk_bf16_f32 v220, v64, v65
    v_accvgpr_write_b32 a32, v220
    v_cvt_pk_bf16_f32 v221, v66, v67
    v_accvgpr_write_b32 a33, v221
    v_cvt_pk_bf16_f32 v220, v68, v69
    v_accvgpr_write_b32 a34, v220
    v_cvt_pk_bf16_f32 v221, v70, v71
    v_accvgpr_write_b32 a35, v221
    v_cvt_pk_bf16_f32 v220, v72, v73
    v_accvgpr_write_b32 a36, v220
    v_cvt_pk_bf16_f32 v221, v74, v75
    v_accvgpr_write_b32 a37, v221
    v_cvt_pk_bf16_f32 v220, v76, v77
    v_accvgpr_write_b32 a38, v220
    v_cvt_pk_bf16_f32 v221, v78, v79
    v_accvgpr_write_b32 a39, v221
    v_cvt_pk_bf16_f32 v220, v80, v81
    v_accvgpr_write_b32 a40, v220
    v_cvt_pk_bf16_f32 v221, v82, v83
    v_accvgpr_write_b32 a41, v221
    v_cvt_pk_bf16_f32 v220, v84, v85
    v_accvgpr_write_b32 a42, v220
    v_cvt_pk_bf16_f32 v221, v86, v87
    v_accvgpr_write_b32 a43, v221
    v_cvt_pk_bf16_f32 v220, v88, v89
    v_accvgpr_write_b32 a44, v220
    v_cvt_pk_bf16_f32 v221, v90, v91
    v_accvgpr_write_b32 a45, v221
    v_cvt_pk_bf16_f32 v220, v92, v93
    v_accvgpr_write_b32 a46, v220
    v_cvt_pk_bf16_f32 v221, v94, v95
    v_accvgpr_write_b32 a47, v221
    v_cvt_pk_bf16_f32 v220, v96, v97
    v_accvgpr_write_b32 a48, v220
    v_cvt_pk_bf16_f32 v221, v98, v99
    v_accvgpr_write_b32 a49, v221
    v_cvt_pk_bf16_f32 v220, v100, v101
    v_accvgpr_write_b32 a50, v220
    v_cvt_pk_bf16_f32 v221, v102, v103
    v_accvgpr_write_b32 a51, v221
    v_cvt_pk_bf16_f32 v220, v104, v105
    v_accvgpr_write_b32 a52, v220
    v_cvt_pk_bf16_f32 v221, v106, v107
    v_accvgpr_write_b32 a53, v221
    v_cvt_pk_bf16_f32 v220, v108, v109
    v_accvgpr_write_b32 a54, v220
    v_cvt_pk_bf16_f32 v221, v110, v111
    v_accvgpr_write_b32 a55, v221
    v_cvt_pk_bf16_f32 v220, v112, v113
    v_accvgpr_write_b32 a56, v220
    v_cvt_pk_bf16_f32 v221, v114, v115
    v_accvgpr_write_b32 a57, v221
    v_cvt_pk_bf16_f32 v220, v116, v117
    v_accvgpr_write_b32 a58, v220
    v_cvt_pk_bf16_f32 v221, v118, v119
    v_accvgpr_write_b32 a59, v221
    v_cvt_pk_bf16_f32 v220, v120, v121
    v_accvgpr_write_b32 a60, v220
    v_cvt_pk_bf16_f32 v221, v122, v123
    v_accvgpr_write_b32 a61, v221
    v_cvt_pk_bf16_f32 v220, v124, v125
    v_accvgpr_write_b32 a62, v220
    v_cvt_pk_bf16_f32 v221, v126, v127
    v_accvgpr_write_b32 a63, v221
    v_mov_b32 v0, 0
    v_mov_b32 v1, 0
    v_mov_b32 v2, 0
    v_mov_b32 v3, 0
    v_mov_b32 v4, 0
    v_mov_b32 v5, 0
    v_mov_b32 v6, 0
    v_mov_b32 v7, 0
    v_mov_b32 v8, 0
    v_mov_b32 v9, 0
    v_mov_b32 v10, 0
    v_mov_b32 v11, 0
    v_mov_b32 v12, 0
    v_mov_b32 v13, 0
    v_mov_b32 v14, 0
    v_mov_b32 v15, 0
    v_mov_b32 v16, 0
    v_mov_b32 v17, 0
    v_mov_b32 v18, 0
    v_mov_b32 v19, 0
    v_mov_b32 v20, 0
    v_mov_b32 v21, 0
    v_mov_b32 v22, 0
    v_mov_b32 v23, 0
    v_mov_b32 v24, 0
    v_mov_b32 v25, 0
    v_mov_b32 v26, 0
    v_mov_b32 v27, 0
    v_mov_b32 v28, 0
    v_mov_b32 v29, 0
    v_mov_b32 v30, 0
    v_mov_b32 v31, 0
    v_mov_b32 v32, 0
    v_mov_b32 v33, 0
    v_mov_b32 v34, 0
    v_mov_b32 v35, 0
    v_mov_b32 v36, 0
    v_mov_b32 v37, 0
    v_mov_b32 v38, 0
    v_mov_b32 v39, 0
    v_mov_b32 v40, 0
    v_mov_b32 v41, 0
    v_mov_b32 v42, 0
    v_mov_b32 v43, 0
    v_mov_b32 v44, 0
    v_mov_b32 v45, 0
    v_mov_b32 v46, 0
    v_mov_b32 v47, 0
    v_mov_b32 v48, 0
    v_mov_b32 v49, 0
    v_mov_b32 v50, 0
    v_mov_b32 v51, 0
    v_mov_b32 v52, 0
    v_mov_b32 v53, 0
    v_mov_b32 v54, 0
    v_mov_b32 v55, 0
    v_mov_b32 v56, 0
    v_mov_b32 v57, 0
    v_mov_b32 v58, 0
    v_mov_b32 v59, 0
    v_mov_b32 v60, 0
    v_mov_b32 v61, 0
    v_mov_b32 v62, 0
    v_mov_b32 v63, 0
    v_mov_b32 v64, 0
    v_mov_b32 v65, 0
    v_mov_b32 v66, 0
    v_mov_b32 v67, 0
    v_mov_b32 v68, 0
    v_mov_b32 v69, 0
    v_mov_b32 v70, 0
    v_mov_b32 v71, 0
    v_mov_b32 v72, 0
    v_mov_b32 v73, 0
    v_mov_b32 v74, 0
    v_mov_b32 v75, 0
    v_mov_b32 v76, 0
    v_mov_b32 v77, 0
    v_mov_b32 v78, 0
    v_mov_b32 v79, 0
    v_mov_b32 v80, 0
    v_mov_b32 v81, 0
    v_mov_b32 v82, 0
    v_mov_b32 v83, 0
    v_mov_b32 v84, 0
    v_mov_b32 v85, 0
    v_mov_b32 v86, 0
    v_mov_b32 v87, 0
    v_mov_b32 v88, 0
    v_mov_b32 v89, 0
    v_mov_b32 v90, 0
    v_mov_b32 v91, 0
    v_mov_b32 v92, 0
    v_mov_b32 v93, 0
    v_mov_b32 v94, 0
    v_mov_b32 v95, 0
    v_mov_b32 v96, 0
    v_mov_b32 v97, 0
    v_mov_b32 v98, 0
    v_mov_b32 v99, 0
    v_mov_b32 v100, 0
    v_mov_b32 v101, 0
    v_mov_b32 v102, 0
    v_mov_b32 v103, 0
    v_mov_b32 v104, 0
    v_mov_b32 v105, 0
    v_mov_b32 v106, 0
    v_mov_b32 v107, 0
    v_mov_b32 v108, 0
    v_mov_b32 v109, 0
    v_mov_b32 v110, 0
    v_mov_b32 v111, 0
    v_mov_b32 v112, 0
    v_mov_b32 v113, 0
    v_mov_b32 v114, 0
    v_mov_b32 v115, 0
    v_mov_b32 v116, 0
    v_mov_b32 v117, 0
    v_mov_b32 v118, 0
    v_mov_b32 v119, 0
    v_mov_b32 v120, 0
    v_mov_b32 v121, 0
    v_mov_b32 v122, 0
    v_mov_b32 v123, 0
    v_mov_b32 v124, 0
    v_mov_b32 v125, 0
    v_mov_b32 v126, 0
    v_mov_b32 v127, 0
    s_barrier
    ds_read_b128 a[192:195], v236 offset:32768
    s_waitcnt lgkmcnt(3)
    v_mfma_f32_32x32x16_bf16 v[128:143], a[176:179], a[0:3], 0
    ds_read_b128 a[196:199], v237 offset:32768
    v_mfma_f32_32x32x16_bf16 v[128:143], a[180:183], a[4:7], v[128:143]
    ds_read_b128 a[200:203], v238 offset:32768
    s_waitcnt lgkmcnt(3)
    v_mfma_f32_32x32x16_bf16 v[128:143], a[184:187], a[8:11], v[128:143]
    ds_read_b128 a[204:207], v239 offset:32768
    v_mfma_f32_32x32x16_bf16 v[128:143], a[188:191], a[12:15], v[128:143]
    ds_read_b128 a[176:179], v232 offset:33024
    s_waitcnt lgkmcnt(3)
    v_mfma_f32_32x32x16_bf16 v[128:143], a[192:195], a[16:19], v[128:143]
    ds_read_b128 a[180:183], v233 offset:33024
    v_mfma_f32_32x32x16_bf16 v[128:143], a[196:199], a[20:23], v[128:143]
    ds_read_b128 a[184:187], v234 offset:33024
    s_waitcnt lgkmcnt(3)
    v_mfma_f32_32x32x16_bf16 v[128:143], a[200:203], a[24:27], v[128:143]
    ds_read_b128 a[188:191], v235 offset:33024
    v_mfma_f32_32x32x16_bf16 v[128:143], a[204:207], a[28:31], v[128:143]
    ds_read_b128 a[192:195], v236 offset:33024
    s_waitcnt lgkmcnt(3)
    v_mfma_f32_32x32x16_bf16 v[128:143], a[176:179], a[32:35], v[128:143]
    ds_read_b128 a[196:199], v237 offset:33024
    v_mfma_f32_32x32x16_bf16 v[128:143], a[180:183], a[36:39], v[128:143]
    ds_read_b128 a[200:203], v238 offset:33024
    s_waitcnt lgkmcnt(3)
    v_mfma_f32_32x32x16_bf16 v[128:143], a[184:187], a[40:43], v[128:143]
    ds_read_b128 a[204:207], v239 offset:33024
    v_mfma_f32_32x32x16_bf16 v[128:143], a[188:191], a[44:47], v[128:143]
    ds_read_b128 a[176:179], v232 offset:49152
    s_waitcnt lgkmcnt(3)
    v_mfma_f32_32x32x16_bf16 v[128:143], a[192:195], a[48:51], v[128:143]
    ds_read_b128 a[180:183], v233 offset:49152
    v_mfma_f32_32x32x16_bf16 v[128:143], a[196:199], a[52:55], v[128:143]
    ds_read_b128 a[184:187], v234 offset:49152
    s_waitcnt lgkmcnt(3)
    v_mfma_f32_32x32x16_bf16 v[128:143], a[200:203], a[56:59], v[128:143]
    ds_read_b128 a[188:191], v235 offset:49152
    v_mfma_f32_32x32x16_bf16 v[128:143], a[204:207], a[60:63], v[128:143]
    s_barrier
    ds_read_b128 a[192:195], v236 offset:49152
    s_waitcnt lgkmcnt(3)
    v_mfma_f32_32x32x16_bf16 v[144:159], a[176:179], a[0:3], 0
    s_nop 7
    v_max3_f32 v220, v128, v129, v130
    v_max3_f32 v221, v131, v132, v133
    v_max3_f32 v222, v134, v135, v136
    v_max3_f32 v220, v220, v137, v138
    ds_read_b128 a[196:199], v237 offset:49152
    v_mfma_f32_32x32x16_bf16 v[144:159], a[180:183], a[4:7], v[144:159]
    v_max3_f32 v221, v221, v139, v140
    v_max3_f32 v222, v222, v141, v142
    v_max_f32 v220, v220, v143
    ds_read_b128 a[200:203], v238 offset:49152
    s_waitcnt lgkmcnt(3)
    v_mfma_f32_32x32x16_bf16 v[144:159], a[184:187], a[8:11], v[144:159]
    v_mov_b32 v229, 1.0
    v_max3_f32 v220, v220, v221, v222
    v_mov_b32 v221, v220
    s_nop 1
    v_permlane32_swap_b32 v220, v221
    v_max_f32 v220, v220, v221
    v_cmp_gt_f32 vcc, v220, v218
    s_mov_b32 s46, 0
    s_cbranch_vccz attn_kernel_skip0
    v_max_f32 v221, v216, v220
    v_sub_f32 v222, v216, v221
    v_mul_f32 v222, s30, v222
    v_exp_f32 v229, v222
    v_mov_b32 v216, v221
    v_mul_f32 v217, s30, v221
    v_add_f32 v218, s31, v221
    s_mov_b32 s46, 1
    s_nop 0
attn_kernel_skip0:
    ds_read_b128 a[204:207], v239 offset:49152
    v_mfma_f32_32x32x16_bf16 v[144:159], a[188:191], a[12:15], v[144:159]
    v_fma_f32 v128, v128, s30, -v217
    v_fma_f32 v129, v129, s30, -v217
    v_fma_f32 v130, v130, s30, -v217
    ds_read_b128 a[176:179], v232 offset:49408
    s_waitcnt lgkmcnt(3)
    v_mfma_f32_32x32x16_bf16 v[144:159], a[192:195], a[16:19], v[144:159]
    v_exp_f32 v128, v128
    v_fma_f32 v131, v131, s30, -v217
    v_exp_f32 v129, v129
    ds_read_b128 a[180:183], v233 offset:49408
    v_mfma_f32_32x32x16_bf16 v[144:159], a[196:199], a[20:23], v[144:159]
    v_fma_f32 v132, v132, s30, -v217
    v_exp_f32 v130, v130
    v_fma_f32 v133, v133, s30, -v217
    ds_read_b128 a[184:187], v234 offset:49408
    s_waitcnt lgkmcnt(3)
    v_mfma_f32_32x32x16_bf16 v[144:159], a[200:203], a[24:27], v[144:159]
    v_cvt_pk_bf16_f32 v160, v128, v129
    v_exp_f32 v131, v131
    v_fma_f32 v134, v134, s30, -v217
    ds_read_b128 a[188:191], v235 offset:49408
    v_mfma_f32_32x32x16_bf16 v[144:159], a[204:207], a[28:31], v[144:159]
    v_exp_f32 v132, v132
    v_fma_f32 v135, v135, s30, -v217
    v_cvt_pk_bf16_f32 v161, v130, v131
    ds_read_b128 a[192:195], v236 offset:49408
    s_waitcnt lgkmcnt(3)
    v_mfma_f32_32x32x16_bf16 v[144:159], a[176:179], a[32:35], v[144:159]
    v_exp_f32 v133, v133
    v_fma_f32 v136, v136, s30, -v217
    v_exp_f32 v134, v134
    v_fma_f32 v137, v137, s30, -v217
    ds_read_b128 a[196:199], v237 offset:49408
    v_mfma_f32_32x32x16_bf16 v[144:159], a[180:183], a[36:39], v[144:159]
    v_cvt_pk_bf16_f32 v162, v132, v133
    v_exp_f32 v135, v135
    v_fma_f32 v138, v138, s30, -v217
    ds_read_b128 a[200:203], v238 offset:49408
    s_waitcnt lgkmcnt(3)
    v_mfma_f32_32x32x16_bf16 v[144:159], a[184:187], a[40:43], v[144:159]
    v_exp_f32 v136, v136
    v_fma_f32 v139, v139, s30, -v217
    v_cvt_pk_bf16_f32 v163, v134, v135
    ds_read_b128 a[204:207], v239 offset:49408
    v_mfma_f32_32x32x16_bf16 v[144:159], a[188:191], a[44:47], v[144:159]
    v_exp_f32 v137, v137
    v_fma_f32 v140, v140, s30, -v217
    v_exp_f32 v138, v138
    ds_read_b64_tr_b16 a[176:177], v208
    ds_read_b64_tr_b16 a[178:179], v208 offset:2048
    s_waitcnt lgkmcnt(4)
    v_mfma_f32_32x32x16_bf16 v[144:159], a[192:195], a[48:51], v[144:159]
    v_fma_f32 v141, v141, s30, -v217
    v_cvt_pk_bf16_f32 v164, v136, v137
    v_exp_f32 v139, v139
    ds_read_b64_tr_b16 a[180:181], v208 offset:8192
    ds_read_b64_tr_b16 a[182:183], v208 offset:10240
    v_mfma_f32_32x32x16_bf16 v[144:159], a[196:199], a[52:55], v[144:159]
    v_fma_f32 v142, v142, s30, -v217
    v_exp_f32 v140, v140
    v_fma_f32 v143, v143, s30, -v217
    ds_read_b64_tr_b16 a[184:185], v209
    ds_read_b64_tr_b16 a[186:187], v209 offset:2048
    s_waitcnt lgkmcnt(6)
    v_mfma_f32_32x32x16_bf16 v[144:159], a[200:203], a[56:59], v[144:159]
    v_cvt_pk_bf16_f32 v165, v138, v139
    v_exp_f32 v141, v141
    v_exp_f32 v142, v142
    ds_read_b64_tr_b16 a[188:189], v209 offset:8192
    ds_read_b64_tr_b16 a[190:191], v209 offset:10240
    v_mfma_f32_32x32x16_bf16 v[144:159], a[204:207], a[60:63], v[144:159]
    v_cvt_pk_bf16_f32 v166, v140, v141
    v_exp_f32 v143, v143
    s_nop 0
    v_cvt_pk_bf16_f32 v167, v142, v143
    s_barrier
    s_cmp_eq_u32 s46, 0
    s_cbranch_scc1 attn_kernel_nors1
    v_mul_f32 v0, v0, v229
    v_mul_f32 v1, v1, v229
    v_mul_f32 v2, v2, v229
    v_mul_f32 v3, v3, v229
    v_mul_f32 v4, v4, v229
    v_mul_f32 v5, v5, v229
    v_mul_f32 v6, v6, v229
    v_mul_f32 v7, v7, v229
    v_mul_f32 v8, v8, v229
    v_mul_f32 v9, v9, v229
    v_mul_f32 v10, v10, v229
    v_mul_f32 v11, v11, v229
    v_mul_f32 v12, v12, v229
    v_mul_f32 v13, v13, v229
    v_mul_f32 v14, v14, v229
    v_mul_f32 v15, v15, v229
    v_mul_f32 v16, v16, v229
    v_mul_f32 v17, v17, v229
    v_mul_f32 v18, v18, v229
    v_mul_f32 v19, v19, v229
    v_mul_f32 v20, v20, v229
    v_mul_f32 v21, v21, v229
    v_mul_f32 v22, v22, v229
    v_mul_f32 v23, v23, v229
    v_mul_f32 v24, v24, v229
    v_mul_f32 v25, v25, v229
    v_mul_f32 v26, v26, v229
    v_mul_f32 v27, v27, v229
    v_mul_f32 v28, v28, v229
    v_mul_f32 v29, v29, v229
    v_mul_f32 v30, v30, v229
    v_mul_f32 v31, v31, v229
    v_mul_f32 v32, v32, v229
    v_mul_f32 v33, v33, v229
    v_mul_f32 v34, v34, v229
    v_mul_f32 v35, v35, v229
    v_mul_f32 v36, v36, v229
    v_mul_f32 v37, v37, v229
    v_mul_f32 v38, v38, v229
    v_mul_f32 v39, v39, v229
    v_mul_f32 v40, v40, v229
    v_mul_f32 v41, v41, v229
    v_mul_f32 v42, v42, v229
    v_mul_f32 v43, v43, v229
    v_mul_f32 v44, v44, v229
    v_mul_f32 v45, v45, v229
    v_mul_f32 v46, v46, v229
    v_mul_f32 v47, v47, v229
    v_mul_f32 v48, v48, v229
    v_mul_f32 v49, v49, v229
    v_mul_f32 v50, v50, v229
    v_mul_f32 v51, v51, v229
    v_mul_f32 v52, v52, v229
    v_mul_f32 v53, v53, v229
    v_mul_f32 v54, v54, v229
    v_mul_f32 v55, v55, v229
    v_mul_f32 v56, v56, v229
    v_mul_f32 v57, v57, v229
    v_mul_f32 v58, v58, v229
    v_mul_f32 v59, v59, v229
    v_mul_f32 v60, v60, v229
    v_mul_f32 v61, v61, v229
    v_mul_f32 v62, v62, v229
    v_mul_f32 v63, v63, v229
    v_mul_f32 v64, v64, v229
    v_mul_f32 v65, v65, v229
    v_mul_f32 v66, v66, v229
    v_mul_f32 v67, v67, v229
    v_mul_f32 v68, v68, v229
    v_mul_f32 v69, v69, v229
    v_mul_f32 v70, v70, v229
    v_mul_f32 v71, v71, v229
    v_mul_f32 v72, v72, v229
    v_mul_f32 v73, v73, v229
    v_mul_f32 v74, v74, v229
    v_mul_f32 v75, v75, v229
    v_mul_f32 v76, v76, v229
    v_mul_f32 v77, v77, v229
    v_mul_f32 v78, v78, v229
    v_mul_f32 v79, v79, v229
    v_mul_f32 v80, v80, v229
    v_mul_f32 v81, v81, v229
    v_mul_f32 v82, v82, v229
    v_mul_f32 v83, v83, v229
    v_mul_f32 v84, v84, v229
    v_mul_f32 v85, v85, v229
    v_mul_f32 v86, v86, v229
    v_mul_f32 v87, v87, v229
    v_mul_f32 v88, v88, v229
    v_mul_f32 v89, v89, v229
    v_mul_f32 v90, v90, v229
    v_mul_f32 v91, v91, v229
    v_mul_f32 v92, v92, v229
    v_mul_f32 v93, v93, v229
    v_mul_f32 v94, v94, v229
    v_mul_f32 v95, v95, v229
    v_mul_f32 v96, v96, v229
    v_mul_f32 v97, v97, v229
    v_mul_f32 v98, v98, v229
    v_mul_f32 v99, v99, v229
    v_mul_f32 v100, v100, v229
    v_mul_f32 v101, v101, v229
    v_mul_f32 v102, v102, v229
    v_mul_f32 v103, v103, v229
    v_mul_f32 v104, v104, v229
    v_mul_f32 v105, v105, v229
    v_mul_f32 v106, v106, v229
    v_mul_f32 v107, v107, v229
    v_mul_f32 v108, v108, v229
    v_mul_f32 v109, v109, v229
    v_mul_f32 v110, v110, v229
    v_mul_f32 v111, v111, v229
    v_mul_f32 v112, v112, v229
    v_mul_f32 v113, v113, v229
    v_mul_f32 v114, v114, v229
    v_mul_f32 v115, v115, v229
    v_mul_f32 v116, v116, v229
    v_mul_f32 v117, v117, v229
    v_mul_f32 v118, v118, v229
    v_mul_f32 v119, v119, v229
    v_mul_f32 v120, v120, v229
    v_mul_f32 v121, v121, v229
    v_mul_f32 v122, v122, v229
    v_mul_f32 v123, v123, v229
    v_mul_f32 v124, v124, v229
    v_mul_f32 v125, v125, v229
    v_mul_f32 v126, v126, v229
    v_mul_f32 v127, v127, v229
    v_mul_f32 v176, v176, v229
    s_nop 1
attn_kernel_nors1:
    ds_read_b64_tr_b16 a[192:193], v210
    ds_read_b64_tr_b16 a[194:195], v210 offset:2048
    s_waitcnt lgkmcnt(6)
    v_mfma_f32_32x32x16_bf16 v[0:15], a[176:179], v[160:163], v[0:15]
    s_nop 0
    v_max3_f32 v220, v144, v145, v146
    v_max3_f32 v221, v147, v148, v149
    ds_read_b64_tr_b16 a[196:197], v210 offset:8192
    ds_read_b64_tr_b16 a[198:199], v210 offset:10240
    v_mfma_f32_32x32x16_bf16 v[0:15], a[180:183], v[164:167], v[0:15]
    v_max3_f32 v222, v150, v151, v152
    v_max3_f32 v220, v220, v153, v154
    ds_read_b64_tr_b16 a[200:201], v211
    ds_read_b64_tr_b16 a[202:203], v211 offset:2048
    s_waitcnt lgkmcnt(6)
    v_mfma_f32_32x32x16_bf16 v[16:31], a[184:187], v[160:163], v[16:31]
    v_max3_f32 v221, v221, v155, v156
    v_max3_f32 v222, v222, v157, v158
    ds_read_b64_tr_b16 a[204:205], v211 offset:8192
    ds_read_b64_tr_b16 a[206:207], v211 offset:10240
    v_mfma_f32_32x32x16_bf16 v[16:31], a[188:191], v[164:167], v[16:31]
    v_max_f32 v220, v220, v159
    v_mov_b32 v229, 1.0
    ds_read_b64_tr_b16 a[176:177], v208 offset:256
    ds_read_b64_tr_b16 a[178:179], v208 offset:2304
    s_waitcnt lgkmcnt(6)
    v_mfma_f32_32x32x16_bf16 v[32:47], a[192:195], v[160:163], v[32:47]
    v_max3_f32 v220, v220, v221, v222
    v_mov_b32 v221, v220
    s_nop 1
    v_permlane32_swap_b32 v220, v221
    v_max_f32 v220, v220, v221
    v_cmp_gt_f32 vcc, v220, v218
    s_mov_b32 s46, 0
    s_cbranch_vccz attn_kernel_skip2
    v_max_f32 v221, v216, v220
    v_sub_f32 v222, v216, v221
    v_mul_f32 v222, s30, v222
    v_exp_f32 v229, v222
    v_mov_b32 v216, v221
    v_mul_f32 v217, s30, v221
    v_add_f32 v218, s31, v221
    s_mov_b32 s46, 1
    s_nop 0
attn_kernel_skip2:
    ds_read_b64_tr_b16 a[180:181], v208 offset:8448
    ds_read_b64_tr_b16 a[182:183], v208 offset:10496
    v_mfma_f32_32x32x16_bf16 v[32:47], a[196:199], v[164:167], v[32:47]
    v_mfma_f32_32x32x16_bf16 v[176:191], v[192:195], v[160:163], v[176:191]
    v_fma_f32 v144, v144, s30, -v217
    v_fma_f32 v145, v145, s30, -v217
    ds_read_b64_tr_b16 a[184:185], v209 offset:256
    ds_read_b64_tr_b16 a[186:187], v209 offset:2304
    s_waitcnt lgkmcnt(6)
    v_mfma_f32_32x32x16_bf16 v[48:63], a[200:203], v[160:163], v[48:63]
    v_fma_f32 v146, v146, s30, -v217
    v_exp_f32 v144, v144
    ds_read_b64_tr_b16 a[188:189], v209 offset:8448
    ds_read_b64_tr_b16 a[190:191], v209 offset:10496
    v_mfma_f32_32x32x16_bf16 v[48:63], a[204:207], v[164:167], v[48:63]
    v_fma_f32 v147, v147, s30, -v217
    ds_read_b64_tr_b16 a[192:193], v210 offset:256
    ds_read_b64_tr_b16 a[194:195], v210 offset:2304
    s_waitcnt lgkmcnt(6)
    v_mfma_f32_32x32x16_bf16 v[64:79], a[176:179], v[160:163], v[64:79]
    v_exp_f32 v145, v145
    v_fma_f32 v148, v148, s30, -v217
    ds_read_b64_tr_b16 a[196:197], v210 offset:8448
    ds_read_b64_tr_b16 a[198:199], v210 offset:10496
    v_mfma_f32_32x32x16_bf16 v[64:79], a[180:183], v[164:167], v[64:79]
    v_exp_f32 v146, v146
    v_fma_f32 v149, v149, s30, -v217
    ds_read_b64_tr_b16 a[200:201], v211 offset:256
    ds_read_b64_tr_b16 a[202:203], v211 offset:2304
    s_waitcnt lgkmcnt(6)
    v_mfma_f32_32x32x16_bf16 v[80:95], a[184:187], v[160:163], v[80:95]
    v_mfma_f32_32x32x16_bf16 v[176:191], v[192:195], v[164:167], v[176:191]
    v_cvt_pk_bf16_f32 v168, v144, v145
    v_exp_f32 v147, v147
    ds_read_b64_tr_b16 a[204:205], v211 offset:8448
    ds_read_b64_tr_b16 a[206:207], v211 offset:10496
    v_mfma_f32_32x32x16_bf16 v[80:95], a[188:191], v[164:167], v[80:95]
    v_fma_f32 v150, v150, s30, -v217
    v_exp_f32 v148, v148
    ds_read_b128 a[176:179], v200 offset:16384
    s_waitcnt lgkmcnt(5)
    v_mfma_f32_32x32x16_bf16 v[96:111], a[192:195], v[160:163], v[96:111]
    v_fma_f32 v151, v151, s30, -v217
    v_cvt_pk_bf16_f32 v169, v146, v147
    ds_read_b128 a[180:183], v201 offset:16384
    v_mfma_f32_32x32x16_bf16 v[96:111], a[196:199], v[164:167], v[96:111]
    v_exp_f32 v149, v149
    v_fma_f32 v152, v152, s30, -v217
    ds_read_b128 a[184:187], v202 offset:16384
    s_waitcnt lgkmcnt(3)
    v_mfma_f32_32x32x16_bf16 v[112:127], a[200:203], v[160:163], v[112:127]
    v_exp_f32 v150, v150
    v_fma_f32 v153, v153, s30, -v217
    ds_read_b128 a[188:191], v203 offset:16384
    v_mfma_f32_32x32x16_bf16 v[112:127], a[204:207], v[164:167], v[112:127]
    v_cvt_pk_bf16_f32 v170, v148, v149
    s_barrier
    ds_read_b128 a[192:195], v204 offset:16384
    s_waitcnt lgkmcnt(3)
    v_mfma_f32_32x32x16_bf16 v[128:143], a[176:179], a[0:3], 0
    v_exp_f32 v151, v151
    v_fma_f32 v154, v154, s30, -v217
    ds_read_b128 a[196:199], v205 offset:16384
    v_mfma_f32_32x32x16_bf16 v[128:143], a[180:183], a[4:7], v[128:143]
    v_exp_f32 v152, v152
    ds_read_b128 a[200:203], v206 offset:16384
    s_waitcnt lgkmcnt(3)
    v_mfma_f32_32x32x16_bf16 v[128:143], a[184:187], a[8:11], v[128:143]
    v_fma_f32 v155, v155, s30, -v217
    ds_read_b128 a[204:207], v207 offset:16384
    v_mfma_f32_32x32x16_bf16 v[128:143], a[188:191], a[12:15], v[128:143]
    v_cvt_pk_bf16_f32 v171, v150, v151
    ds_read_b128 a[176:179], v200 offset:16640
    s_waitcnt lgkmcnt(3)
    v_mfma_f32_32x32x16_bf16 v[128:143], a[192:195], a[16:19], v[128:143]
    v_exp_f32 v153, v153
    v_fma_f32 v156, v156, s30, -v217
    ds_read_b128 a[180:183], v201 offset:16640
    v_mfma_f32_32x32x16_bf16 v[128:143], a[196:199], a[20:23], v[128:143]
    v_exp_f32 v154, v154
    ds_read_b128 a[184:187], v202 offset:16640
    s_waitcnt lgkmcnt(3)
    v_mfma_f32_32x32x16_bf16 v[128:143], a[200:203], a[24:27], v[128:143]
    v_fma_f32 v157, v157, s30, -v217
    ds_read_b128 a[188:191], v203 offset:16640
    v_mfma_f32_32x32x16_bf16 v[128:143], a[204:207], a[28:31], v[128:143]
    v_cvt_pk_bf16_f32 v172, v152, v153
    ds_read_b128 a[192:195], v204 offset:16640
    s_waitcnt lgkmcnt(3)
    v_mfma_f32_32x32x16_bf16 v[128:143], a[176:179], a[32:35], v[128:143]
    v_exp_f32 v155, v155
    v_fma_f32 v158, v158, s30, -v217
    ds_read_b128 a[196:199], v205 offset:16640
    v_mfma_f32_32x32x16_bf16 v[128:143], a[180:183], a[36:39], v[128:143]
    v_exp_f32 v156, v156
    ds_read_b128 a[200:203], v206 offset:16640
    s_waitcnt lgkmcnt(3)
    v_mfma_f32_32x32x16_bf16 v[128:143], a[184:187], a[40:43], v[128:143]
    v_fma_f32 v159, v159, s30, -v217
    ds_read_b128 a[204:207], v207 offset:16640
    v_mfma_f32_32x32x16_bf16 v[128:143], a[188:191], a[44:47], v[128:143]
    v_cvt_pk_bf16_f32 v173, v154, v155
    ds_read_b64_tr_b16 a[176:177], v208 offset:32768
    ds_read_b64_tr_b16 a[178:179], v208 offset:34816
    s_waitcnt lgkmcnt(4)
    v_mfma_f32_32x32x16_bf16 v[128:143], a[192:195], a[48:51], v[128:143]
    v_exp_f32 v157, v157
    v_exp_f32 v158, v158
    ds_read_b64_tr_b16 a[180:181], v208 offset:40960
    ds_read_b64_tr_b16 a[182:183], v208 offset:43008
    v_mfma_f32_32x32x16_bf16 v[128:143], a[196:199], a[52:55], v[128:143]
    v_cvt_pk_bf16_f32 v174, v156, v157
    ds_read_b64_tr_b16 a[184:185], v209 offset:32768
    ds_read_b64_tr_b16 a[186:187], v209 offset:34816
    s_waitcnt lgkmcnt(6)
    v_mfma_f32_32x32x16_bf16 v[128:143], a[200:203], a[56:59], v[128:143]
    v_exp_f32 v159, v159
    ds_read_b64_tr_b16 a[188:189], v209 offset:40960
    ds_read_b64_tr_b16 a[190:191], v209 offset:43008
    v_mfma_f32_32x32x16_bf16 v[128:143], a[204:207], a[60:63], v[128:143]
    v_cvt_pk_bf16_f32 v175, v158, v159
    s_barrier
    s_cmp_eq_u32 s46, 0
    s_cbranch_scc1 attn_kernel_nors3
    v_mul_f32 v0, v0, v229
    v_mul_f32 v1, v1, v229
    v_mul_f32 v2, v2, v229
    v_mul_f32 v3, v3, v229
    v_mul_f32 v4, v4, v229
    v_mul_f32 v5, v5, v229
    v_mul_f32 v6, v6, v229
    v_mul_f32 v7, v7, v229
    v_mul_f32 v8, v8, v229
    v_mul_f32 v9, v9, v229
    v_mul_f32 v10, v10, v229
    v_mul_f32 v11, v11, v229
    v_mul_f32 v12, v12, v229
    v_mul_f32 v13, v13, v229
    v_mul_f32 v14, v14, v229
    v_mul_f32 v15, v15, v229
    v_mul_f32 v16, v16, v229
    v_mul_f32 v17, v17, v229
    v_mul_f32 v18, v18, v229
    v_mul_f32 v19, v19, v229
    v_mul_f32 v20, v20, v229
    v_mul_f32 v21, v21, v229
    v_mul_f32 v22, v22, v229
    v_mul_f32 v23, v23, v229
    v_mul_f32 v24, v24, v229
    v_mul_f32 v25, v25, v229
    v_mul_f32 v26, v26, v229
    v_mul_f32 v27, v27, v229
    v_mul_f32 v28, v28, v229
    v_mul_f32 v29, v29, v229
    v_mul_f32 v30, v30, v229
    v_mul_f32 v31, v31, v229
    v_mul_f32 v32, v32, v229
    v_mul_f32 v33, v33, v229
    v_mul_f32 v34, v34, v229
    v_mul_f32 v35, v35, v229
    v_mul_f32 v36, v36, v229
    v_mul_f32 v37, v37, v229
    v_mul_f32 v38, v38, v229
    v_mul_f32 v39, v39, v229
    v_mul_f32 v40, v40, v229
    v_mul_f32 v41, v41, v229
    v_mul_f32 v42, v42, v229
    v_mul_f32 v43, v43, v229
    v_mul_f32 v44, v44, v229
    v_mul_f32 v45, v45, v229
    v_mul_f32 v46, v46, v229
    v_mul_f32 v47, v47, v229
    v_mul_f32 v48, v48, v229
    v_mul_f32 v49, v49, v229
    v_mul_f32 v50, v50, v229
    v_mul_f32 v51, v51, v229
    v_mul_f32 v52, v52, v229
    v_mul_f32 v53, v53, v229
    v_mul_f32 v54, v54, v229
    v_mul_f32 v55, v55, v229
    v_mul_f32 v56, v56, v229
    v_mul_f32 v57, v57, v229
    v_mul_f32 v58, v58, v229
    v_mul_f32 v59, v59, v229
    v_mul_f32 v60, v60, v229
    v_mul_f32 v61, v61, v229
    v_mul_f32 v62, v62, v229
    v_mul_f32 v63, v63, v229
    v_mul_f32 v64, v64, v229
    v_mul_f32 v65, v65, v229
    v_mul_f32 v66, v66, v229
    v_mul_f32 v67, v67, v229
    v_mul_f32 v68, v68, v229
    v_mul_f32 v69, v69, v229
    v_mul_f32 v70, v70, v229
    v_mul_f32 v71, v71, v229
    v_mul_f32 v72, v72, v229
    v_mul_f32 v73, v73, v229
    v_mul_f32 v74, v74, v229
    v_mul_f32 v75, v75, v229
    v_mul_f32 v76, v76, v229
    v_mul_f32 v77, v77, v229
    v_mul_f32 v78, v78, v229
    v_mul_f32 v79, v79, v229
    v_mul_f32 v80, v80, v229
    v_mul_f32 v81, v81, v229
    v_mul_f32 v82, v82, v229
    v_mul_f32 v83, v83, v229
    v_mul_f32 v84, v84, v229
    v_mul_f32 v85, v85, v229
    v_mul_f32 v86, v86, v229
    v_mul_f32 v87, v87, v229
    v_mul_f32 v88, v88, v229
    v_mul_f32 v89, v89, v229
    v_mul_f32 v90, v90, v229
    v_mul_f32 v91, v91, v229
    v_mul_f32 v92, v92, v229
    v_mul_f32 v93, v93, v229
    v_mul_f32 v94, v94, v229
    v_mul_f32 v95, v95, v229
    v_mul_f32 v96, v96, v229
    v_mul_f32 v97, v97, v229
    v_mul_f32 v98, v98, v229
    v_mul_f32 v99, v99, v229
    v_mul_f32 v100, v100, v229
    v_mul_f32 v101, v101, v229
    v_mul_f32 v102, v102, v229
    v_mul_f32 v103, v103, v229
    v_mul_f32 v104, v104, v229
    v_mul_f32 v105, v105, v229
    v_mul_f32 v106, v106, v229
    v_mul_f32 v107, v107, v229
    v_mul_f32 v108, v108, v229
    v_mul_f32 v109, v109, v229
    v_mul_f32 v110, v110, v229
    v_mul_f32 v111, v111, v229
    v_mul_f32 v112, v112, v229
    v_mul_f32 v113, v113, v229
    v_mul_f32 v114, v114, v229
    v_mul_f32 v115, v115, v229
    v_mul_f32 v116, v116, v229
    v_mul_f32 v117, v117, v229
    v_mul_f32 v118, v118, v229
    v_mul_f32 v119, v119, v229
    v_mul_f32 v120, v120, v229
    v_mul_f32 v121, v121, v229
    v_mul_f32 v122, v122, v229
    v_mul_f32 v123, v123, v229
    v_mul_f32 v124, v124, v229
    v_mul_f32 v125, v125, v229
    v_mul_f32 v126, v126, v229
    v_mul_f32 v127, v127, v229
    v_mul_f32 v176, v176, v229
    s_nop 1
attn_kernel_nors3:
    ds_read_b64_tr_b16 a[192:193], v210 offset:32768
    ds_read_b64_tr_b16 a[194:195], v210 offset:34816
    s_waitcnt lgkmcnt(6)
    v_mfma_f32_32x32x16_bf16 v[0:15], a[176:179], v[168:171], v[0:15]
    s_nop 3
    v_max3_f32 v220, v128, v129, v130
    v_max3_f32 v221, v131, v132, v133
    ds_read_b64_tr_b16 a[196:197], v210 offset:40960
    ds_read_b64_tr_b16 a[198:199], v210 offset:43008
    v_mfma_f32_32x32x16_bf16 v[0:15], a[180:183], v[172:175], v[0:15]
    v_max3_f32 v222, v134, v135, v136
    v_max3_f32 v220, v220, v137, v138
    ds_read_b64_tr_b16 a[200:201], v211 offset:32768
    ds_read_b64_tr_b16 a[202:203], v211 offset:34816
    s_waitcnt lgkmcnt(6)
    v_mfma_f32_32x32x16_bf16 v[16:31], a[184:187], v[168:171], v[16:31]
    v_max3_f32 v221, v221, v139, v140
    v_max3_f32 v222, v222, v141, v142
    ds_read_b64_tr_b16 a[204:205], v211 offset:40960
    ds_read_b64_tr_b16 a[206:207], v211 offset:43008
    v_mfma_f32_32x32x16_bf16 v[16:31], a[188:191], v[172:175], v[16:31]
    v_max_f32 v220, v220, v143
    v_mov_b32 v229, 1.0
    ds_read_b64_tr_b16 a[176:177], v208 offset:33024
    ds_read_b64_tr_b16 a[178:179], v208 offset:35072
    s_waitcnt lgkmcnt(6)
    v_mfma_f32_32x32x16_bf16 v[32:47], a[192:195], v[168:171], v[32:47]
    v_max3_f32 v220, v220, v221, v222
    v_mov_b32 v221, v220
    s_nop 1
    v_permlane32_swap_b32 v220, v221
    v_max_f32 v220, v220, v221
    v_cmp_gt_f32 vcc, v220, v218
    s_mov_b32 s46, 0
    s_cbranch_vccz attn_kernel_skip4
    v_max_f32 v221, v216, v220
    v_sub_f32 v222, v216, v221
    v_mul_f32 v222, s30, v222
    v_exp_f32 v229, v222
    v_mov_b32 v216, v221
    v_mul_f32 v217, s30, v221
    v_add_f32 v218, s31, v221
    s_mov_b32 s46, 1
    s_nop 0
attn_kernel_skip4:
    ds_read_b64_tr_b16 a[180:181], v208 offset:41216
    ds_read_b64_tr_b16 a[182:183], v208 offset:43264
    v_mfma_f32_32x32x16_bf16 v[32:47], a[196:199], v[172:175], v[32:47]
    v_mfma_f32_32x32x16_bf16 v[176:191], v[192:195], v[168:171], v[176:191]
    v_fma_f32 v128, v128, s30, -v217
    v_fma_f32 v129, v129, s30, -v217
    ds_read_b64_tr_b16 a[184:185], v209 offset:33024
    ds_read_b64_tr_b16 a[186:187], v209 offset:35072
    s_waitcnt lgkmcnt(6)
    v_mfma_f32_32x32x16_bf16 v[48:63], a[200:203], v[168:171], v[48:63]
    v_fma_f32 v130, v130, s30, -v217
    v_exp_f32 v128, v128
    ds_read_b64_tr_b16 a[188:189], v209 offset:41216
    ds_read_b64_tr_b16 a[190:191], v209 offset:43264
    v_mfma_f32_32x32x16_bf16 v[48:63], a[204:207], v[172:175], v[48:63]
    v_fma_f32 v131, v131, s30, -v217
    ds_read_b64_tr_b16 a[192:193], v210 offset:33024
    ds_read_b64_tr_b16 a[194:195], v210 offset:35072
    s_waitcnt lgkmcnt(6)
    v_mfma_f32_32x32x16_bf16 v[64:79], a[176:179], v[168:171], v[64:79]
    v_exp_f32 v129, v129
    v_fma_f32 v132, v132, s30, -v217
    ds_read_b64_tr_b16 a[196:197], v210 offset:41216
    ds_read_b64_tr_b16 a[198:199], v210 offset:43264
    v_mfma_f32_32x32x16_bf16 v[64:79], a[180:183], v[172:175], v[64:79]
    v_exp_f32 v130, v130
    v_fma_f32 v133, v133, s30, -v217
    ds_read_b64_tr_b16 a[200:201], v211 offset:33024
    ds_read_b64_tr_b16 a[202:203], v211 offset:35072
    s_waitcnt lgkmcnt(6)
    v_mfma_f32_32x32x16_bf16 v[80:95], a[184:187], v[168:171], v[80:95]
    v_mfma_f32_32x32x16_bf16 v[176:191], v[192:195], v[172:175], v[176:191]
    v_cvt_pk_bf16_f32 v160, v128, v129
    v_exp_f32 v131, v131
    ds_read_b64_tr_b16 a[204:205], v211 offset:41216
    ds_read_b64_tr_b16 a[206:207], v211 offset:43264
    v_mfma_f32_32x32x16_bf16 v[80:95], a[188:191], v[172:175], v[80:95]
    v_fma_f32 v134, v134, s30, -v217
    v_exp_f32 v132, v132
    ds_read_b128 a[176:179], v200 offset:49152
    s_waitcnt lgkmcnt(5)
    v_mfma_f32_32x32x16_bf16 v[96:111], a[192:195], v[168:171], v[96:111]
    v_fma_f32 v135, v135, s30, -v217
    v_cvt_pk_bf16_f32 v161, v130, v131
    ds_read_b128 a[180:183], v201 offset:49152
    v_mfma_f32_32x32x16_bf16 v[96:111], a[196:199], v[172:175], v[96:111]
    v_exp_f32 v133, v133
    v_fma_f32 v136, v136, s30, -v217
    ds_read_b128 a[184:187], v202 offset:49152
    s_waitcnt lgkmcnt(3)
    v_mfma_f32_32x32x16_bf16 v[112:127], a[200:203], v[168:171], v[112:127]
    v_exp_f32 v134, v134
    v_fma_f32 v137, v137, s30, -v217
    ds_read_b128 a[188:191], v203 offset:49152
    v_mfma_f32_32x32x16_bf16 v[112:127], a[204:207], v[172:175], v[112:127]
    v_cvt_pk_bf16_f32 v162, v132, v133
    s_barrier
    ds_read_b128 a[192:195], v204 offset:49152
    s_waitcnt lgkmcnt(3)
    v_mfma_f32_32x32x16_bf16 v[144:159], a[176:179], a[0:3], 0
    v_exp_f32 v135, v135
    v_fma_f32 v138, v138, s30, -v217
    ds_read_b128 a[196:199], v205 offset:49152
    v_mfma_f32_32x32x16_bf16 v[144:159], a[180:183], a[4:7], v[144:159]
    v_exp_f32 v136, v136
    ds_read_b128 a[200:203], v206 offset:49152
    s_waitcnt lgkmcnt(3)
    v_mfma_f32_32x32x16_bf16 v[144:159], a[184:187], a[8:11], v[144:159]
    v_fma_f32 v139, v139, s30, -v217
    ds_read_b128 a[204:207], v207 offset:49152
    v_mfma_f32_32x32x16_bf16 v[144:159], a[188:191], a[12:15], v[144:159]
    v_cvt_pk_bf16_f32 v163, v134, v135
    ds_read_b128 a[176:179], v200 offset:49408
    s_waitcnt lgkmcnt(3)
    v_mfma_f32_32x32x16_bf16 v[144:159], a[192:195], a[16:19], v[144:159]
    v_exp_f32 v137, v137
    v_fma_f32 v140, v140, s30, -v217
    ds_read_b128 a[180:183], v201 offset:49408
    v_mfma_f32_32x32x16_bf16 v[144:159], a[196:199], a[20:23], v[144:159]
    v_exp_f32 v138, v138
    ds_read_b128 a[184:187], v202 offset:49408
    s_waitcnt lgkmcnt(3)
    v_mfma_f32_32x32x16_bf16 v[144:159], a[200:203], a[24:27], v[144:159]
    v_fma_f32 v141, v141, s30, -v217
    ds_read_b128 a[188:191], v203 offset:49408
    v_mfma_f32_32x32x16_bf16 v[144:159], a[204:207], a[28:31], v[144:159]
    v_cvt_pk_bf16_f32 v164, v136, v137
    ds_read_b128 a[192:195], v204 offset:49408
    s_waitcnt lgkmcnt(3)
    v_mfma_f32_32x32x16_bf16 v[144:159], a[176:179], a[32:35], v[144:159]
    v_exp_f32 v139, v139
    v_fma_f32 v142, v142, s30, -v217
    ds_read_b128 a[196:199], v205 offset:49408
    v_mfma_f32_32x32x16_bf16 v[144:159], a[180:183], a[36:39], v[144:159]
    v_exp_f32 v140, v140
    ds_read_b128 a[200:203], v206 offset:49408
    s_waitcnt lgkmcnt(3)
    v_mfma_f32_32x32x16_bf16 v[144:159], a[184:187], a[40:43], v[144:159]
    v_fma_f32 v143, v143, s30, -v217
    ds_read_b128 a[204:207], v207 offset:49408
    v_mfma_f32_32x32x16_bf16 v[144:159], a[188:191], a[44:47], v[144:159]
    v_cvt_pk_bf16_f32 v165, v138, v139
    ds_read_b64_tr_b16 a[176:177], v212
    ds_read_b64_tr_b16 a[178:179], v212 offset:2048
    s_waitcnt lgkmcnt(4)
    v_mfma_f32_32x32x16_bf16 v[144:159], a[192:195], a[48:51], v[144:159]
    v_exp_f32 v141, v141
    v_exp_f32 v142, v142
    ds_read_b64_tr_b16 a[180:181], v212 offset:8192
    ds_read_b64_tr_b16 a[182:183], v212 offset:10240
    v_mfma_f32_32x32x16_bf16 v[144:159], a[196:199], a[52:55], v[144:159]
    v_cvt_pk_bf16_f32 v166, v140, v141
    ds_read_b64_tr_b16 a[184:185], v213
    ds_read_b64_tr_b16 a[186:187], v213 offset:2048
    s_waitcnt lgkmcnt(6)
    v_mfma_f32_32x32x16_bf16 v[144:159], a[200:203], a[56:59], v[144:159]
    v_exp_f32 v143, v143
    ds_read_b64_tr_b16 a[188:189], v213 offset:8192
    ds_read_b64_tr_b16 a[190:191], v213 offset:10240
    v_mfma_f32_32x32x16_bf16 v[144:159], a[204:207], a[60:63], v[144:159]
    v_cvt_pk_bf16_f32 v167, v142, v143
    s_barrier
    s_cmp_eq_u32 s46, 0
    s_cbranch_scc1 attn_kernel_nors5
    v_mul_f32 v0, v0, v229
    v_mul_f32 v1, v1, v229
    v_mul_f32 v2, v2, v229
    v_mul_f32 v3, v3, v229
    v_mul_f32 v4, v4, v229
    v_mul_f32 v5, v5, v229
    v_mul_f32 v6, v6, v229
    v_mul_f32 v7, v7, v229
    v_mul_f32 v8, v8, v229
    v_mul_f32 v9, v9, v229
    v_mul_f32 v10, v10, v229
    v_mul_f32 v11, v11, v229
    v_mul_f32 v12, v12, v229
    v_mul_f32 v13, v13, v229
    v_mul_f32 v14, v14, v229
    v_mul_f32 v15, v15, v229
    v_mul_f32 v16, v16, v229
    v_mul_f32 v17, v17, v229
    v_mul_f32 v18, v18, v229
    v_mul_f32 v19, v19, v229
    v_mul_f32 v20, v20, v229
    v_mul_f32 v21, v21, v229
    v_mul_f32 v22, v22, v229
    v_mul_f32 v23, v23, v229
    v_mul_f32 v24, v24, v229
    v_mul_f32 v25, v25, v229
    v_mul_f32 v26, v26, v229
    v_mul_f32 v27, v27, v229
    v_mul_f32 v28, v28, v229
    v_mul_f32 v29, v29, v229
    v_mul_f32 v30, v30, v229
    v_mul_f32 v31, v31, v229
    v_mul_f32 v32, v32, v229
    v_mul_f32 v33, v33, v229
    v_mul_f32 v34, v34, v229
    v_mul_f32 v35, v35, v229
    v_mul_f32 v36, v36, v229
    v_mul_f32 v37, v37, v229
    v_mul_f32 v38, v38, v229
    v_mul_f32 v39, v39, v229
    v_mul_f32 v40, v40, v229
    v_mul_f32 v41, v41, v229
    v_mul_f32 v42, v42, v229
    v_mul_f32 v43, v43, v229
    v_mul_f32 v44, v44, v229
    v_mul_f32 v45, v45, v229
    v_mul_f32 v46, v46, v229
    v_mul_f32 v47, v47, v229
    v_mul_f32 v48, v48, v229
    v_mul_f32 v49, v49, v229
    v_mul_f32 v50, v50, v229
    v_mul_f32 v51, v51, v229
    v_mul_f32 v52, v52, v229
    v_mul_f32 v53, v53, v229
    v_mul_f32 v54, v54, v229
    v_mul_f32 v55, v55, v229
    v_mul_f32 v56, v56, v229
    v_mul_f32 v57, v57, v229
    v_mul_f32 v58, v58, v229
    v_mul_f32 v59, v59, v229
    v_mul_f32 v60, v60, v229
    v_mul_f32 v61, v61, v229
    v_mul_f32 v62, v62, v229
    v_mul_f32 v63, v63, v229
    v_mul_f32 v64, v64, v229
    v_mul_f32 v65, v65, v229
    v_mul_f32 v66, v66, v229
    v_mul_f32 v67, v67, v229
    v_mul_f32 v68, v68, v229
    v_mul_f32 v69, v69, v229
    v_mul_f32 v70, v70, v229
    v_mul_f32 v71, v71, v229
    v_mul_f32 v72, v72, v229
    v_mul_f32 v73, v73, v229
    v_mul_f32 v74, v74, v229
    v_mul_f32 v75, v75, v229
    v_mul_f32 v76, v76, v229
    v_mul_f32 v77, v77, v229
    v_mul_f32 v78, v78, v229
    v_mul_f32 v79, v79, v229
    v_mul_f32 v80, v80, v229
    v_mul_f32 v81, v81, v229
    v_mul_f32 v82, v82, v229
    v_mul_f32 v83, v83, v229
    v_mul_f32 v84, v84, v229
    v_mul_f32 v85, v85, v229
    v_mul_f32 v86, v86, v229
    v_mul_f32 v87, v87, v229
    v_mul_f32 v88, v88, v229
    v_mul_f32 v89, v89, v229
    v_mul_f32 v90, v90, v229
    v_mul_f32 v91, v91, v229
    v_mul_f32 v92, v92, v229
    v_mul_f32 v93, v93, v229
    v_mul_f32 v94, v94, v229
    v_mul_f32 v95, v95, v229
    v_mul_f32 v96, v96, v229
    v_mul_f32 v97, v97, v229
    v_mul_f32 v98, v98, v229
    v_mul_f32 v99, v99, v229
    v_mul_f32 v100, v100, v229
    v_mul_f32 v101, v101, v229
    v_mul_f32 v102, v102, v229
    v_mul_f32 v103, v103, v229
    v_mul_f32 v104, v104, v229
    v_mul_f32 v105, v105, v229
    v_mul_f32 v106, v106, v229
    v_mul_f32 v107, v107, v229
    v_mul_f32 v108, v108, v229
    v_mul_f32 v109, v109, v229
    v_mul_f32 v110, v110, v229
    v_mul_f32 v111, v111, v229
    v_mul_f32 v112, v112, v229
    v_mul_f32 v113, v113, v229
    v_mul_f32 v114, v114, v229
    v_mul_f32 v115, v115, v229
    v_mul_f32 v116, v116, v229
    v_mul_f32 v117, v117, v229
    v_mul_f32 v118, v118, v229
    v_mul_f32 v119, v119, v229
    v_mul_f32 v120, v120, v229
    v_mul_f32 v121, v121, v229
    v_mul_f32 v122, v122, v229
    v_mul_f32 v123, v123, v229
    v_mul_f32 v124, v124, v229
    v_mul_f32 v125, v125, v229
    v_mul_f32 v126, v126, v229
    v_mul_f32 v127, v127, v229
    v_mul_f32 v176, v176, v229
    s_nop 1
attn_kernel_nors5:
    ds_read_b64_tr_b16 a[192:193], v214
    ds_read_b64_tr_b16 a[194:195], v214 offset:2048
    s_waitcnt lgkmcnt(6)
    v_mfma_f32_32x32x16_bf16 v[0:15], a[176:179], v[160:163], v[0:15]
    s_nop 3
    v_max3_f32 v220, v144, v145, v146
    v_max3_f32 v221, v147, v148, v149
    ds_read_b64_tr_b16 a[196:197], v214 offset:8192
    ds_read_b64_tr_b16 a[198:199], v214 offset:10240
    v_mfma_f32_32x32x16_bf16 v[0:15], a[180:183], v[164:167], v[0:15]
    v_max3_f32 v222, v150, v151, v152
    v_max3_f32 v220, v220, v153, v154
    ds_read_b64_tr_b16 a[200:201], v215
    ds_read_b64_tr_b16 a[202:203], v215 offset:2048
    s_waitcnt lgkmcnt(6)
    v_mfma_f32_32x32x16_bf16 v[16:31], a[184:187], v[160:163], v[16:31]
    v_max3_f32 v221, v221, v155, v156
    v_max3_f32 v222, v222, v157, v158
    ds_read_b64_tr_b16 a[204:205], v215 offset:8192
    ds_read_b64_tr_b16 a[206:207], v215 offset:10240
    v_mfma_f32_32x32x16_bf16 v[16:31], a[188:191], v[164:167], v[16:31]
    v_max_f32 v220, v220, v159
    v_mov_b32 v229, 1.0
    ds_read_b64_tr_b16 a[176:177], v212 offset:256
    ds_read_b64_tr_b16 a[178:179], v212 offset:2304
    s_waitcnt lgkmcnt(6)
    v_mfma_f32_32x32x16_bf16 v[32:47], a[192:195], v[160:163], v[32:47]
    v_max3_f32 v220, v220, v221, v222
    v_mov_b32 v221, v220
    s_nop 1
    v_permlane32_swap_b32 v220, v221
    v_max_f32 v220, v220, v221
    v_cmp_gt_f32 vcc, v220, v218
    s_mov_b32 s46, 0
    s_cbranch_vccz attn_kernel_skip6
    v_max_f32 v221, v216, v220
    v_sub_f32 v222, v216, v221
    v_mul_f32 v222, s30, v222
    v_exp_f32 v229, v222
    v_mov_b32 v216, v221
    v_mul_f32 v217, s30, v221
    v_add_f32 v218, s31, v221
    s_mov_b32 s46, 1
    s_nop 0
attn_kernel_skip6:
    ds_read_b64_tr_b16 a[180:181], v212 offset:8448
    ds_read_b64_tr_b16 a[182:183], v212 offset:10496
    v_mfma_f32_32x32x16_bf16 v[32:47], a[196:199], v[164:167], v[32:47]
    v_mfma_f32_32x32x16_bf16 v[176:191], v[192:195], v[160:163], v[176:191]
    v_fma_f32 v144, v144, s30, -v217
    v_fma_f32 v145, v145, s30, -v217
    ds_read_b64_tr_b16 a[184:185], v213 offset:256
    ds_read_b64_tr_b16 a[186:187], v213 offset:2304
    s_waitcnt lgkmcnt(6)
    v_mfma_f32_32x32x16_bf16 v[48:63], a[200:203], v[160:163], v[48:63]
    v_fma_f32 v146, v146, s30, -v217
    v_exp_f32 v144, v144
    ds_read_b64_tr_b16 a[188:189], v213 offset:8448
    ds_read_b64_tr_b16 a[190:191], v213 offset:10496
    v_mfma_f32_32x32x16_bf16 v[48:63], a[204:207], v[164:167], v[48:63]
    v_fma_f32 v147, v147, s30, -v217
    ds_read_b64_tr_b16 a[192:193], v214 offset:256
    ds_read_b64_tr_b16 a[194:195], v214 offset:2304
    s_waitcnt lgkmcnt(6)
    v_mfma_f32_32x32x16_bf16 v[64:79], a[176:179], v[160:163], v[64:79]
    v_exp_f32 v145, v145
    v_fma_f32 v148, v148, s30, -v217
    ds_read_b64_tr_b16 a[196:197], v214 offset:8448
    ds_read_b64_tr_b16 a[198:199], v214 offset:10496
    v_mfma_f32_32x32x16_bf16 v[64:79], a[180:183], v[164:167], v[64:79]
    v_exp_f32 v146, v146
    v_fma_f32 v149, v149, s30, -v217
    ds_read_b64_tr_b16 a[200:201], v215 offset:256
    ds_read_b64_tr_b16 a[202:203], v215 offset:2304
    s_waitcnt lgkmcnt(6)
    v_mfma_f32_32x32x16_bf16 v[80:95], a[184:187], v[160:163], v[80:95]
    v_mfma_f32_32x32x16_bf16 v[176:191], v[192:195], v[164:167], v[176:191]
    v_cvt_pk_bf16_f32 v168, v144, v145
    v_exp_f32 v147, v147
    ds_read_b64_tr_b16 a[204:205], v215 offset:8448
    ds_read_b64_tr_b16 a[206:207], v215 offset:10496
    v_mfma_f32_32x32x16_bf16 v[80:95], a[188:191], v[164:167], v[80:95]
    v_fma_f32 v150, v150, s30, -v217
    v_exp_f32 v148, v148
    ds_read_b128 a[176:179], v232 offset:16384
    s_waitcnt lgkmcnt(5)
    v_mfma_f32_32x32x16_bf16 v[96:111], a[192:195], v[160:163], v[96:111]
    v_fma_f32 v151, v151, s30, -v217
    v_cvt_pk_bf16_f32 v169, v146, v147
    ds_read_b128 a[180:183], v233 offset:16384
    v_mfma_f32_32x32x16_bf16 v[96:111], a[196:199], v[164:167], v[96:111]
    v_exp_f32 v149, v149
    v_fma_f32 v152, v152, s30, -v217
    ds_read_b128 a[184:187], v234 offset:16384
    s_waitcnt lgkmcnt(3)
    v_mfma_f32_32x32x16_bf16 v[112:127], a[200:203], v[160:163], v[112:127]
    v_exp_f32 v150, v150
    v_fma_f32 v153, v153, s30, -v217
    ds_read_b128 a[188:191], v235 offset:16384
    v_mfma_f32_32x32x16_bf16 v[112:127], a[204:207], v[164:167], v[112:127]
    v_cvt_pk_bf16_f32 v170, v148, v149
    s_barrier
    ds_read_b128 a[192:195], v236 offset:16384
    s_waitcnt lgkmcnt(3)
    v_mfma_f32_32x32x16_bf16 v[128:143], a[176:179], a[0:3], 0
    v_exp_f32 v151, v151
    v_fma_f32 v154, v154, s30, -v217
    ds_read_b128 a[196:199], v237 offset:16384
    v_mfma_f32_32x32x16_bf16 v[128:143], a[180:183], a[4:7], v[128:143]
    v_exp_f32 v152, v152
    ds_read_b128 a[200:203], v238 offset:16384
    s_waitcnt lgkmcnt(3)
    v_mfma_f32_32x32x16_bf16 v[128:143], a[184:187], a[8:11], v[128:143]
    v_fma_f32 v155, v155, s30, -v217
    ds_read_b128 a[204:207], v239 offset:16384
    v_mfma_f32_32x32x16_bf16 v[128:143], a[188:191], a[12:15], v[128:143]
    v_cvt_pk_bf16_f32 v171, v150, v151
    ds_read_b128 a[176:179], v232 offset:16640
    s_waitcnt lgkmcnt(3)
    v_mfma_f32_32x32x16_bf16 v[128:143], a[192:195], a[16:19], v[128:143]
    v_exp_f32 v153, v153
    v_fma_f32 v156, v156, s30, -v217
    ds_read_b128 a[180:183], v233 offset:16640
    v_mfma_f32_32x32x16_bf16 v[128:143], a[196:199], a[20:23], v[128:143]
    v_exp_f32 v154, v154
    ds_read_b128 a[184:187], v234 offset:16640
    s_waitcnt lgkmcnt(3)
    v_mfma_f32_32x32x16_bf16 v[128:143], a[200:203], a[24:27], v[128:143]
    v_fma_f32 v157, v157, s30, -v217
    ds_read_b128 a[188:191], v235 offset:16640
    v_mfma_f32_32x32x16_bf16 v[128:143], a[204:207], a[28:31], v[128:143]
    v_cvt_pk_bf16_f32 v172, v152, v153
    ds_read_b128 a[192:195], v236 offset:16640
    s_waitcnt lgkmcnt(3)
    v_mfma_f32_32x32x16_bf16 v[128:143], a[176:179], a[32:35], v[128:143]
    v_exp_f32 v155, v155
    v_fma_f32 v158, v158, s30, -v217
    ds_read_b128 a[196:199], v237 offset:16640
    v_mfma_f32_32x32x16_bf16 v[128:143], a[180:183], a[36:39], v[128:143]
    v_exp_f32 v156, v156
    ds_read_b128 a[200:203], v238 offset:16640
    s_waitcnt lgkmcnt(3)
    v_mfma_f32_32x32x16_bf16 v[128:143], a[184:187], a[40:43], v[128:143]
    v_fma_f32 v159, v159, s30, -v217
    ds_read_b128 a[204:207], v239 offset:16640
    v_mfma_f32_32x32x16_bf16 v[128:143], a[188:191], a[44:47], v[128:143]
    v_cvt_pk_bf16_f32 v173, v154, v155
    ds_read_b64_tr_b16 a[176:177], v212 offset:32768
    ds_read_b64_tr_b16 a[178:179], v212 offset:34816
    s_waitcnt lgkmcnt(4)
    v_mfma_f32_32x32x16_bf16 v[128:143], a[192:195], a[48:51], v[128:143]
    v_exp_f32 v157, v157
    v_exp_f32 v158, v158
    ds_read_b64_tr_b16 a[180:181], v212 offset:40960
    ds_read_b64_tr_b16 a[182:183], v212 offset:43008
    v_mfma_f32_32x32x16_bf16 v[128:143], a[196:199], a[52:55], v[128:143]
    v_cvt_pk_bf16_f32 v174, v156, v157
    ds_read_b64_tr_b16 a[184:185], v213 offset:32768
    ds_read_b64_tr_b16 a[186:187], v213 offset:34816
    s_waitcnt lgkmcnt(6)
    v_mfma_f32_32x32x16_bf16 v[128:143], a[200:203], a[56:59], v[128:143]
    v_exp_f32 v159, v159
    ds_read_b64_tr_b16 a[188:189], v213 offset:40960
    ds_read_b64_tr_b16 a[190:191], v213 offset:43008
    v_mfma_f32_32x32x16_bf16 v[128:143], a[204:207], a[60:63], v[128:143]
    v_cvt_pk_bf16_f32 v175, v158, v159
    s_barrier
    s_cmp_eq_u32 s46, 0
    s_cbranch_scc1 attn_kernel_nors7
    v_mul_f32 v0, v0, v229
    v_mul_f32 v1, v1, v229
    v_mul_f32 v2, v2, v229
    v_mul_f32 v3, v3, v229
    v_mul_f32 v4, v4, v229
    v_mul_f32 v5, v5, v229
    v_mul_f32 v6, v6, v229
    v_mul_f32 v7, v7, v229
    v_mul_f32 v8, v8, v229
    v_mul_f32 v9, v9, v229
    v_mul_f32 v10, v10, v229
    v_mul_f32 v11, v11, v229
    v_mul_f32 v12, v12, v229
    v_mul_f32 v13, v13, v229
    v_mul_f32 v14, v14, v229
    v_mul_f32 v15, v15, v229
    v_mul_f32 v16, v16, v229
    v_mul_f32 v17, v17, v229
    v_mul_f32 v18, v18, v229
    v_mul_f32 v19, v19, v229
    v_mul_f32 v20, v20, v229
    v_mul_f32 v21, v21, v229
    v_mul_f32 v22, v22, v229
    v_mul_f32 v23, v23, v229
    v_mul_f32 v24, v24, v229
    v_mul_f32 v25, v25, v229
    v_mul_f32 v26, v26, v229
    v_mul_f32 v27, v27, v229
    v_mul_f32 v28, v28, v229
    v_mul_f32 v29, v29, v229
    v_mul_f32 v30, v30, v229
    v_mul_f32 v31, v31, v229
    v_mul_f32 v32, v32, v229
    v_mul_f32 v33, v33, v229
    v_mul_f32 v34, v34, v229
    v_mul_f32 v35, v35, v229
    v_mul_f32 v36, v36, v229
    v_mul_f32 v37, v37, v229
    v_mul_f32 v38, v38, v229
    v_mul_f32 v39, v39, v229
    v_mul_f32 v40, v40, v229
    v_mul_f32 v41, v41, v229
    v_mul_f32 v42, v42, v229
    v_mul_f32 v43, v43, v229
    v_mul_f32 v44, v44, v229
    v_mul_f32 v45, v45, v229
    v_mul_f32 v46, v46, v229
    v_mul_f32 v47, v47, v229
    v_mul_f32 v48, v48, v229
    v_mul_f32 v49, v49, v229
    v_mul_f32 v50, v50, v229
    v_mul_f32 v51, v51, v229
    v_mul_f32 v52, v52, v229
    v_mul_f32 v53, v53, v229
    v_mul_f32 v54, v54, v229
    v_mul_f32 v55, v55, v229
    v_mul_f32 v56, v56, v229
    v_mul_f32 v57, v57, v229
    v_mul_f32 v58, v58, v229
    v_mul_f32 v59, v59, v229
    v_mul_f32 v60, v60, v229
    v_mul_f32 v61, v61, v229
    v_mul_f32 v62, v62, v229
    v_mul_f32 v63, v63, v229
    v_mul_f32 v64, v64, v229
    v_mul_f32 v65, v65, v229
    v_mul_f32 v66, v66, v229
    v_mul_f32 v67, v67, v229
    v_mul_f32 v68, v68, v229
    v_mul_f32 v69, v69, v229
    v_mul_f32 v70, v70, v229
    v_mul_f32 v71, v71, v229
    v_mul_f32 v72, v72, v229
    v_mul_f32 v73, v73, v229
    v_mul_f32 v74, v74, v229
    v_mul_f32 v75, v75, v229
    v_mul_f32 v76, v76, v229
    v_mul_f32 v77, v77, v229
    v_mul_f32 v78, v78, v229
    v_mul_f32 v79, v79, v229
    v_mul_f32 v80, v80, v229
    v_mul_f32 v81, v81, v229
    v_mul_f32 v82, v82, v229
    v_mul_f32 v83, v83, v229
    v_mul_f32 v84, v84, v229
    v_mul_f32 v85, v85, v229
    v_mul_f32 v86, v86, v229
    v_mul_f32 v87, v87, v229
    v_mul_f32 v88, v88, v229
    v_mul_f32 v89, v89, v229
    v_mul_f32 v90, v90, v229
    v_mul_f32 v91, v91, v229
    v_mul_f32 v92, v92, v229
    v_mul_f32 v93, v93, v229
    v_mul_f32 v94, v94, v229
    v_mul_f32 v95, v95, v229
    v_mul_f32 v96, v96, v229
    v_mul_f32 v97, v97, v229
    v_mul_f32 v98, v98, v229
    v_mul_f32 v99, v99, v229
    v_mul_f32 v100, v100, v229
    v_mul_f32 v101, v101, v229
    v_mul_f32 v102, v102, v229
    v_mul_f32 v103, v103, v229
    v_mul_f32 v104, v104, v229
    v_mul_f32 v105, v105, v229
    v_mul_f32 v106, v106, v229
    v_mul_f32 v107, v107, v229
    v_mul_f32 v108, v108, v229
    v_mul_f32 v109, v109, v229
    v_mul_f32 v110, v110, v229
    v_mul_f32 v111, v111, v229
    v_mul_f32 v112, v112, v229
    v_mul_f32 v113, v113, v229
    v_mul_f32 v114, v114, v229
    v_mul_f32 v115, v115, v229
    v_mul_f32 v116, v116, v229
    v_mul_f32 v117, v117, v229
    v_mul_f32 v118, v118, v229
    v_mul_f32 v119, v119, v229
    v_mul_f32 v120, v120, v229
    v_mul_f32 v121, v121, v229
    v_mul_f32 v122, v122, v229
    v_mul_f32 v123, v123, v229
    v_mul_f32 v124, v124, v229
    v_mul_f32 v125, v125, v229
    v_mul_f32 v126, v126, v229
    v_mul_f32 v127, v127, v229
    v_mul_f32 v176, v176, v229
    s_nop 1
attn_kernel_nors7:
    ds_read_b64_tr_b16 a[192:193], v214 offset:32768
    ds_read_b64_tr_b16 a[194:195], v214 offset:34816
    s_waitcnt lgkmcnt(6)
    v_mfma_f32_32x32x16_bf16 v[0:15], a[176:179], v[168:171], v[0:15]
    s_nop 3
    v_max3_f32 v220, v128, v129, v130
    v_max3_f32 v221, v131, v132, v133
    ds_read_b64_tr_b16 a[196:197], v214 offset:40960
    ds_read_b64_tr_b16 a[198:199], v214 offset:43008
    v_mfma_f32_32x32x16_bf16 v[0:15], a[180:183], v[172:175], v[0:15]
    v_max3_f32 v222, v134, v135, v136
    v_max3_f32 v220, v220, v137, v138
    ds_read_b64_tr_b16 a[200:201], v215 offset:32768
    ds_read_b64_tr_b16 a[202:203], v215 offset:34816
    s_waitcnt lgkmcnt(6)
    v_mfma_f32_32x32x16_bf16 v[16:31], a[184:187], v[168:171], v[16:31]
    v_max3_f32 v221, v221, v139, v140
    v_max3_f32 v222, v222, v141, v142
    ds_read_b64_tr_b16 a[204:205], v215 offset:40960
    ds_read_b64_tr_b16 a[206:207], v215 offset:43008
    v_mfma_f32_32x32x16_bf16 v[16:31], a[188:191], v[172:175], v[16:31]
    v_max_f32 v220, v220, v143
    v_mov_b32 v229, 1.0
    ds_read_b64_tr_b16 a[176:177], v212 offset:33024
    ds_read_b64_tr_b16 a[178:179], v212 offset:35072
    s_waitcnt lgkmcnt(6)
    v_mfma_f32_32x32x16_bf16 v[32:47], a[192:195], v[168:171], v[32:47]
    v_max3_f32 v220, v220, v221, v222
    v_mov_b32 v221, v220
    s_nop 1
    v_permlane32_swap_b32 v220, v221
    v_max_f32 v220, v220, v221
    v_cmp_gt_f32 vcc, v220, v218
    s_mov_b32 s46, 0
    s_cbranch_vccz attn_kernel_skip8
    v_max_f32 v221, v216, v220
    v_sub_f32 v222, v216, v221
    v_mul_f32 v222, s30, v222
    v_exp_f32 v229, v222
    v_mov_b32 v216, v221
    v_mul_f32 v217, s30, v221
    v_add_f32 v218, s31, v221
    s_mov_b32 s46, 1
    s_nop 0
attn_kernel_skip8:
    ds_read_b64_tr_b16 a[180:181], v212 offset:41216
    ds_read_b64_tr_b16 a[182:183], v212 offset:43264
    v_mfma_f32_32x32x16_bf16 v[32:47], a[196:199], v[172:175], v[32:47]
    v_mfma_f32_32x32x16_bf16 v[176:191], v[192:195], v[168:171], v[176:191]
    v_fma_f32 v128, v128, s30, -v217
    v_fma_f32 v129, v129, s30, -v217
    ds_read_b64_tr_b16 a[184:185], v213 offset:33024
    ds_read_b64_tr_b16 a[186:187], v213 offset:35072
    s_waitcnt lgkmcnt(6)
    v_mfma_f32_32x32x16_bf16 v[48:63], a[200:203], v[168:171], v[48:63]
    v_fma_f32 v130, v130, s30, -v217
    v_exp_f32 v128, v128
    ds_read_b64_tr_b16 a[188:189], v213 offset:41216
    ds_read_b64_tr_b16 a[190:191], v213 offset:43264
    v_mfma_f32_32x32x16_bf16 v[48:63], a[204:207], v[172:175], v[48:63]
    v_fma_f32 v131, v131, s30, -v217
    ds_read_b64_tr_b16 a[192:193], v214 offset:33024
    ds_read_b64_tr_b16 a[194:195], v214 offset:35072
    s_waitcnt lgkmcnt(6)
    v_mfma_f32_32x32x16_bf16 v[64:79], a[176:179], v[168:171], v[64:79]
    v_exp_f32 v129, v129
    v_fma_f32 v132, v132, s30, -v217
    ds_read_b64_tr_b16 a[196:197], v214 offset:41216
    ds_read_b64_tr_b16 a[198:199], v214 offset:43264
    v_mfma_f32_32x32x16_bf16 v[64:79], a[180:183], v[172:175], v[64:79]
    v_exp_f32 v130, v130
    v_fma_f32 v133, v133, s30, -v217
    ds_read_b64_tr_b16 a[200:201], v215 offset:33024
    ds_read_b64_tr_b16 a[202:203], v215 offset:35072
    s_waitcnt lgkmcnt(6)
    v_mfma_f32_32x32x16_bf16 v[80:95], a[184:187], v[168:171], v[80:95]
    v_mfma_f32_32x32x16_bf16 v[176:191], v[192:195], v[172:175], v[176:191]
    v_cvt_pk_bf16_f32 v160, v128, v129
    v_exp_f32 v131, v131
    ds_read_b64_tr_b16 a[204:205], v215 offset:41216
    ds_read_b64_tr_b16 a[206:207], v215 offset:43264
    v_mfma_f32_32x32x16_bf16 v[80:95], a[188:191], v[172:175], v[80:95]
    v_fma_f32 v134, v134, s30, -v217
    v_exp_f32 v132, v132
    ds_read_b128 a[176:179], v232 offset:49152
    s_waitcnt lgkmcnt(5)
    v_mfma_f32_32x32x16_bf16 v[96:111], a[192:195], v[168:171], v[96:111]
    v_fma_f32 v135, v135, s30, -v217
    v_cvt_pk_bf16_f32 v161, v130, v131
    ds_read_b128 a[180:183], v233 offset:49152
    v_mfma_f32_32x32x16_bf16 v[96:111], a[196:199], v[172:175], v[96:111]
    v_exp_f32 v133, v133
    v_fma_f32 v136, v136, s30, -v217
    ds_read_b128 a[184:187], v234 offset:49152
    s_waitcnt lgkmcnt(3)
    v_mfma_f32_32x32x16_bf16 v[112:127], a[200:203], v[168:171], v[112:127]
    v_exp_f32 v134, v134
    v_fma_f32 v137, v137, s30, -v217
    ds_read_b128 a[188:191], v235 offset:49152
    v_mfma_f32_32x32x16_bf16 v[112:127], a[204:207], v[172:175], v[112:127]
    v_cvt_pk_bf16_f32 v162, v132, v133
    s_mov_b32 s34, 0
    s_nop 9
attn_kernel_loop:
    s_barrier
    ds_read_b128 a[192:195], v236 offset:49152
    s_waitcnt lgkmcnt(3)
    v_mfma_f32_32x32x16_bf16 v[144:159], a[176:179], a[0:3], 0
    v_exp_f32 v135, v135
    v_fma_f32 v138, v138, s30, -v217
    ds_read_b128 a[196:199], v237 offset:49152
    v_mfma_f32_32x32x16_bf16 v[144:159], a[180:183], a[4:7], v[144:159]
    v_exp_f32 v136, v136
    ds_read_b128 a[200:203], v238 offset:49152
    s_waitcnt lgkmcnt(3)
    v_mfma_f32_32x32x16_bf16 v[144:159], a[184:187], a[8:11], v[144:159]
    v_fma_f32 v139, v139, s30, -v217
    ds_read_b128 a[204:207], v239 offset:49152
    v_mfma_f32_32x32x16_bf16 v[144:159], a[188:191], a[12:15], v[144:159]
    v_cvt_pk_bf16_f32 v163, v134, v135
    ds_read_b128 a[176:179], v232 offset:49408
    s_waitcnt lgkmcnt(3)
    v_mfma_f32_32x32x16_bf16 v[144:159], a[192:195], a[16:19], v[144:159]
    v_exp_f32 v137, v137
    v_fma_f32 v140, v140, s30, -v217
    ds_read_b128 a[180:183], v233 offset:49408
    v_mfma_f32_32x32x16_bf16 v[144:159], a[196:199], a[20:23], v[144:159]
    v_exp_f32 v138, v138
    ds_read_b128 a[184:187], v234 offset:49408
    s_waitcnt lgkmcnt(3)
    v_mfma_f32_32x32x16_bf16 v[144:159], a[200:203], a[24:27], v[144:159]
    v_fma_f32 v141, v141, s30, -v217
    ds_read_b128 a[188:191], v235 offset:49408
    v_mfma_f32_32x32x16_bf16 v[144:159], a[204:207], a[28:31], v[144:159]
    v_cvt_pk_bf16_f32 v164, v136, v137
    ds_read_b128 a[192:195], v236 offset:49408
    s_waitcnt lgkmcnt(3)
    v_mfma_f32_32x32x16_bf16 v[144:159], a[176:179], a[32:35], v[144:159]
    v_exp_f32 v139, v139
    v_fma_f32 v142, v142, s30, -v217
    ds_read_b128 a[196:199], v237 offset:49408
    v_mfma_f32_32x32x16_bf16 v[144:159], a[180:183], a[36:39], v[144:159]
    v_exp_f32 v140, v140
    ds_read_b128 a[200:203], v238 offset:49408
    s_waitcnt lgkmcnt(3)
    v_mfma_f32_32x32x16_bf16 v[144:159], a[184:187], a[40:43], v[144:159]
    v_fma_f32 v143, v143, s30, -v217
    ds_read_b128 a[204:207], v239 offset:49408
    v_mfma_f32_32x32x16_bf16 v[144:159], a[188:191], a[44:47], v[144:159]
    v_cvt_pk_bf16_f32 v165, v138, v139
    ds_read_b64_tr_b16 a[176:177], v208
    ds_read_b64_tr_b16 a[178:179], v208 offset:2048
    s_waitcnt lgkmcnt(4)
    v_mfma_f32_32x32x16_bf16 v[144:159], a[192:195], a[48:51], v[144:159]
    v_exp_f32 v141, v141
    v_exp_f32 v142, v142
    ds_read_b64_tr_b16 a[180:181], v208 offset:8192
    ds_read_b64_tr_b16 a[182:183], v208 offset:10240
    v_mfma_f32_32x32x16_bf16 v[144:159], a[196:199], a[52:55], v[144:159]
    v_cvt_pk_bf16_f32 v166, v140, v141
    ds_read_b64_tr_b16 a[184:185], v209
    ds_read_b64_tr_b16 a[186:187], v209 offset:2048
    s_waitcnt lgkmcnt(6)
    v_mfma_f32_32x32x16_bf16 v[144:159], a[200:203], a[56:59], v[144:159]
    v_exp_f32 v143, v143
    ds_read_b64_tr_b16 a[188:189], v209 offset:8192
    ds_read_b64_tr_b16 a[190:191], v209 offset:10240
    v_mfma_f32_32x32x16_bf16 v[144:159], a[204:207], a[60:63], v[144:159]
    v_cvt_pk_bf16_f32 v167, v142, v143
    s_barrier
    s_cmp_eq_u32 s46, 0
    s_cbranch_scc1 attn_kernel_nors9
    v_mul_f32 v0, v0, v229
    v_mul_f32 v1, v1, v229
    v_mul_f32 v2, v2, v229
    v_mul_f32 v3, v3, v229
    v_mul_f32 v4, v4, v229
    v_mul_f32 v5, v5, v229
    v_mul_f32 v6, v6, v229
    v_mul_f32 v7, v7, v229
    v_mul_f32 v8, v8, v229
    v_mul_f32 v9, v9, v229
    v_mul_f32 v10, v10, v229
    v_mul_f32 v11, v11, v229
    v_mul_f32 v12, v12, v229
    v_mul_f32 v13, v13, v229
    v_mul_f32 v14, v14, v229
    v_mul_f32 v15, v15, v229
    v_mul_f32 v16, v16, v229
    v_mul_f32 v17, v17, v229
    v_mul_f32 v18, v18, v229
    v_mul_f32 v19, v19, v229
    v_mul_f32 v20, v20, v229
    v_mul_f32 v21, v21, v229
    v_mul_f32 v22, v22, v229
    v_mul_f32 v23, v23, v229
    v_mul_f32 v24, v24, v229
    v_mul_f32 v25, v25, v229
    v_mul_f32 v26, v26, v229
    v_mul_f32 v27, v27, v229
    v_mul_f32 v28, v28, v229
    v_mul_f32 v29, v29, v229
    v_mul_f32 v30, v30, v229
    v_mul_f32 v31, v31, v229
    v_mul_f32 v32, v32, v229
    v_mul_f32 v33, v33, v229
    v_mul_f32 v34, v34, v229
    v_mul_f32 v35, v35, v229
    v_mul_f32 v36, v36, v229
    v_mul_f32 v37, v37, v229
    v_mul_f32 v38, v38, v229
    v_mul_f32 v39, v39, v229
    v_mul_f32 v40, v40, v229
    v_mul_f32 v41, v41, v229
    v_mul_f32 v42, v42, v229
    v_mul_f32 v43, v43, v229
    v_mul_f32 v44, v44, v229
    v_mul_f32 v45, v45, v229
    v_mul_f32 v46, v46, v229
    v_mul_f32 v47, v47, v229
    v_mul_f32 v48, v48, v229
    v_mul_f32 v49, v49, v229
    v_mul_f32 v50, v50, v229
    v_mul_f32 v51, v51, v229
    v_mul_f32 v52, v52, v229
    v_mul_f32 v53, v53, v229
    v_mul_f32 v54, v54, v229
    v_mul_f32 v55, v55, v229
    v_mul_f32 v56, v56, v229
    v_mul_f32 v57, v57, v229
    v_mul_f32 v58, v58, v229
    v_mul_f32 v59, v59, v229
    v_mul_f32 v60, v60, v229
    v_mul_f32 v61, v61, v229
    v_mul_f32 v62, v62, v229
    v_mul_f32 v63, v63, v229
    v_mul_f32 v64, v64, v229
    v_mul_f32 v65, v65, v229
    v_mul_f32 v66, v66, v229
    v_mul_f32 v67, v67, v229
    v_mul_f32 v68, v68, v229
    v_mul_f32 v69, v69, v229
    v_mul_f32 v70, v70, v229
    v_mul_f32 v71, v71, v229
    v_mul_f32 v72, v72, v229
    v_mul_f32 v73, v73, v229
    v_mul_f32 v74, v74, v229
    v_mul_f32 v75, v75, v229
    v_mul_f32 v76, v76, v229
    v_mul_f32 v77, v77, v229
    v_mul_f32 v78, v78, v229
    v_mul_f32 v79, v79, v229
    v_mul_f32 v80, v80, v229
    v_mul_f32 v81, v81, v229
    v_mul_f32 v82, v82, v229
    v_mul_f32 v83, v83, v229
    v_mul_f32 v84, v84, v229
    v_mul_f32 v85, v85, v229
    v_mul_f32 v86, v86, v229
    v_mul_f32 v87, v87, v229
    v_mul_f32 v88, v88, v229
    v_mul_f32 v89, v89, v229
    v_mul_f32 v90, v90, v229
    v_mul_f32 v91, v91, v229
    v_mul_f32 v92, v92, v229
    v_mul_f32 v93, v93, v229
    v_mul_f32 v94, v94, v229
    v_mul_f32 v95, v95, v229
    v_mul_f32 v96, v96, v229
    v_mul_f32 v97, v97, v229
    v_mul_f32 v98, v98, v229
    v_mul_f32 v99, v99, v229
    v_mul_f32 v100, v100, v229
    v_mul_f32 v101, v101, v229
    v_mul_f32 v102, v102, v229
    v_mul_f32 v103, v103, v229
    v_mul_f32 v104, v104, v229
    v_mul_f32 v105, v105, v229
    v_mul_f32 v106, v106, v229
    v_mul_f32 v107, v107, v229
    v_mul_f32 v108, v108, v229
    v_mul_f32 v109, v109, v229
    v_mul_f32 v110, v110, v229
    v_mul_f32 v111, v111, v229
    v_mul_f32 v112, v112, v229
    v_mul_f32 v113, v113, v229
    v_mul_f32 v114, v114, v229
    v_mul_f32 v115, v115, v229
    v_mul_f32 v116, v116, v229
    v_mul_f32 v117, v117, v229
    v_mul_f32 v118, v118, v229
    v_mul_f32 v119, v119, v229
    v_mul_f32 v120, v120, v229
    v_mul_f32 v121, v121, v229
    v_mul_f32 v122, v122, v229
    v_mul_f32 v123, v123, v229
    v_mul_f32 v124, v124, v229
    v_mul_f32 v125, v125, v229
    v_mul_f32 v126, v126, v229
    v_mul_f32 v127, v127, v229
    v_mul_f32 v176, v176, v229
    s_nop 1
attn_kernel_nors9:
    ds_read_b64_tr_b16 a[192:193], v210
    ds_read_b64_tr_b16 a[194:195], v210 offset:2048
    s_waitcnt lgkmcnt(6)
    v_mfma_f32_32x32x16_bf16 v[0:15], a[176:179], v[160:163], v[0:15]
    s_nop 3
    v_max3_f32 v220, v144, v145, v146
    v_max3_f32 v221, v147, v148, v149
    ds_read_b64_tr_b16 a[196:197], v210 offset:8192
    ds_read_b64_tr_b16 a[198:199], v210 offset:10240
    v_mfma_f32_32x32x16_bf16 v[0:15], a[180:183], v[164:167], v[0:15]
    v_max3_f32 v222, v150, v151, v152
    v_max3_f32 v220, v220, v153, v154
    ds_read_b64_tr_b16 a[200:201], v211
    ds_read_b64_tr_b16 a[202:203], v211 offset:2048
    s_waitcnt lgkmcnt(6)
    v_mfma_f32_32x32x16_bf16 v[16:31], a[184:187], v[160:163], v[16:31]
    v_max3_f32 v221, v221, v155, v156
    v_max3_f32 v222, v222, v157, v158
    ds_read_b64_tr_b16 a[204:205], v211 offset:8192
    ds_read_b64_tr_b16 a[206:207], v211 offset:10240
    v_mfma_f32_32x32x16_bf16 v[16:31], a[188:191], v[164:167], v[16:31]
    v_max_f32 v220, v220, v159
    v_mov_b32 v229, 1.0
    ds_read_b64_tr_b16 a[176:177], v208 offset:256
    ds_read_b64_tr_b16 a[178:179], v208 offset:2304
    s_waitcnt lgkmcnt(6)
    v_mfma_f32_32x32x16_bf16 v[32:47], a[192:195], v[160:163], v[32:47]
    v_max3_f32 v220, v220, v221, v222
    v_mov_b32 v221, v220
    s_nop 1
    v_permlane32_swap_b32 v220, v221
    v_max_f32 v220, v220, v221
    v_cmp_gt_f32 vcc, v220, v218
    s_mov_b32 s46, 0
    s_cbranch_vccz attn_kernel_skip10
    v_max_f32 v221, v216, v220
    v_sub_f32 v222, v216, v221
    v_mul_f32 v222, s30, v222
    v_exp_f32 v229, v222
    v_mov_b32 v216, v221
    v_mul_f32 v217, s30, v221
    v_add_f32 v218, s31, v221
    s_mov_b32 s46, 1
    s_nop 0
attn_kernel_skip10:
    ds_read_b64_tr_b16 a[180:181], v208 offset:8448
    ds_read_b64_tr_b16 a[182:183], v208 offset:10496
    v_mfma_f32_32x32x16_bf16 v[32:47], a[196:199], v[164:167], v[32:47]
    v_mfma_f32_32x32x16_bf16 v[176:191], v[192:195], v[160:163], v[176:191]
    v_fma_f32 v144, v144, s30, -v217
    v_fma_f32 v145, v145, s30, -v217
    ds_read_b64_tr_b16 a[184:185], v209 offset:256
    ds_read_b64_tr_b16 a[186:187], v209 offset:2304
    s_waitcnt lgkmcnt(6)
    v_mfma_f32_32x32x16_bf16 v[48:63], a[200:203], v[160:163], v[48:63]
    v_fma_f32 v146, v146, s30, -v217
    v_exp_f32 v144, v144
    ds_read_b64_tr_b16 a[188:189], v209 offset:8448
    ds_read_b64_tr_b16 a[190:191], v209 offset:10496
    v_mfma_f32_32x32x16_bf16 v[48:63], a[204:207], v[164:167], v[48:63]
    v_fma_f32 v147, v147, s30, -v217
    ds_read_b64_tr_b16 a[192:193], v210 offset:256
    ds_read_b64_tr_b16 a[194:195], v210 offset:2304
    s_waitcnt lgkmcnt(6)
    v_mfma_f32_32x32x16_bf16 v[64:79], a[176:179], v[160:163], v[64:79]
    v_exp_f32 v145, v145
    v_fma_f32 v148, v148, s30, -v217
    ds_read_b64_tr_b16 a[196:197], v210 offset:8448
    ds_read_b64_tr_b16 a[198:199], v210 offset:10496
    v_mfma_f32_32x32x16_bf16 v[64:79], a[180:183], v[164:167], v[64:79]
    v_exp_f32 v146, v146
    v_fma_f32 v149, v149, s30, -v217
    ds_read_b64_tr_b16 a[200:201], v211 offset:256
    ds_read_b64_tr_b16 a[202:203], v211 offset:2304
    s_waitcnt lgkmcnt(6)
    v_mfma_f32_32x32x16_bf16 v[80:95], a[184:187], v[160:163], v[80:95]
    v_mfma_f32_32x32x16_bf16 v[176:191], v[192:195], v[164:167], v[176:191]
    v_cvt_pk_bf16_f32 v168, v144, v145
    v_exp_f32 v147, v147
    ds_read_b64_tr_b16 a[204:205], v211 offset:8448
    ds_read_b64_tr_b16 a[206:207], v211 offset:10496
    v_mfma_f32_32x32x16_bf16 v[80:95], a[188:191], v[164:167], v[80:95]
    v_fma_f32 v150, v150, s30, -v217
    v_exp_f32 v148, v148
    ds_read_b128 a[176:179], v200 offset:16384
    s_waitcnt lgkmcnt(5)
    v_mfma_f32_32x32x16_bf16 v[96:111], a[192:195], v[160:163], v[96:111]
    v_fma_f32 v151, v151, s30, -v217
    v_cvt_pk_bf16_f32 v169, v146, v147
    ds_read_b128 a[180:183], v201 offset:16384
    v_mfma_f32_32x32x16_bf16 v[96:111], a[196:199], v[164:167], v[96:111]
    v_exp_f32 v149, v149
    v_fma_f32 v152, v152, s30, -v217
    ds_read_b128 a[184:187], v202 offset:16384
    s_waitcnt lgkmcnt(3)
    v_mfma_f32_32x32x16_bf16 v[112:127], a[200:203], v[160:163], v[112:127]
    v_exp_f32 v150, v150
    v_fma_f32 v153, v153, s30, -v217
    ds_read_b128 a[188:191], v203 offset:16384
    v_mfma_f32_32x32x16_bf16 v[112:127], a[204:207], v[164:167], v[112:127]
    v_cvt_pk_bf16_f32 v170, v148, v149
    s_barrier
    ds_read_b128 a[192:195], v204 offset:16384
    s_waitcnt lgkmcnt(3)
    v_mfma_f32_32x32x16_bf16 v[128:143], a[176:179], a[0:3], 0
    v_exp_f32 v151, v151
    v_fma_f32 v154, v154, s30, -v217
    ds_read_b128 a[196:199], v205 offset:16384
    v_mfma_f32_32x32x16_bf16 v[128:143], a[180:183], a[4:7], v[128:143]
    v_exp_f32 v152, v152
    ds_read_b128 a[200:203], v206 offset:16384
    s_waitcnt lgkmcnt(3)
    v_mfma_f32_32x32x16_bf16 v[128:143], a[184:187], a[8:11], v[128:143]
    v_fma_f32 v155, v155, s30, -v217
    ds_read_b128 a[204:207], v207 offset:16384
    v_mfma_f32_32x32x16_bf16 v[128:143], a[188:191], a[12:15], v[128:143]
    v_cvt_pk_bf16_f32 v171, v150, v151
    ds_read_b128 a[176:179], v200 offset:16640
    s_waitcnt lgkmcnt(3)
    v_mfma_f32_32x32x16_bf16 v[128:143], a[192:195], a[16:19], v[128:143]
    v_exp_f32 v153, v153
    v_fma_f32 v156, v156, s30, -v217
    ds_read_b128 a[180:183], v201 offset:16640
    v_mfma_f32_32x32x16_bf16 v[128:143], a[196:199], a[20:23], v[128:143]
    v_exp_f32 v154, v154
    ds_read_b128 a[184:187], v202 offset:16640
    s_waitcnt lgkmcnt(3)
    v_mfma_f32_32x32x16_bf16 v[128:143], a[200:203], a[24:27], v[128:143]
    v_fma_f32 v157, v157, s30, -v217
    ds_read_b128 a[188:191], v203 offset:16640
    v_mfma_f32_32x32x16_bf16 v[128:143], a[204:207], a[28:31], v[128:143]
    v_cvt_pk_bf16_f32 v172, v152, v153
    ds_read_b128 a[192:195], v204 offset:16640
    s_waitcnt lgkmcnt(3)
    v_mfma_f32_32x32x16_bf16 v[128:143], a[176:179], a[32:35], v[128:143]
    v_exp_f32 v155, v155
    v_fma_f32 v158, v158, s30, -v217
    ds_read_b128 a[196:199], v205 offset:16640
    v_mfma_f32_32x32x16_bf16 v[128:143], a[180:183], a[36:39], v[128:143]
    v_exp_f32 v156, v156
    ds_read_b128 a[200:203], v206 offset:16640
    s_waitcnt lgkmcnt(3)
    v_mfma_f32_32x32x16_bf16 v[128:143], a[184:187], a[40:43], v[128:143]
    v_fma_f32 v159, v159, s30, -v217
    ds_read_b128 a[204:207], v207 offset:16640
    v_mfma_f32_32x32x16_bf16 v[128:143], a[188:191], a[44:47], v[128:143]
    v_cvt_pk_bf16_f32 v173, v154, v155
    ds_read_b64_tr_b16 a[176:177], v208 offset:32768
    ds_read_b64_tr_b16 a[178:179], v208 offset:34816
    s_waitcnt lgkmcnt(4)
    v_mfma_f32_32x32x16_bf16 v[128:143], a[192:195], a[48:51], v[128:143]
    v_exp_f32 v157, v157
    v_exp_f32 v158, v158
    ds_read_b64_tr_b16 a[180:181], v208 offset:40960
    ds_read_b64_tr_b16 a[182:183], v208 offset:43008
    v_mfma_f32_32x32x16_bf16 v[128:143], a[196:199], a[52:55], v[128:143]
    v_cvt_pk_bf16_f32 v174, v156, v157
    ds_read_b64_tr_b16 a[184:185], v209 offset:32768
    ds_read_b64_tr_b16 a[186:187], v209 offset:34816
    s_waitcnt lgkmcnt(6)
    v_mfma_f32_32x32x16_bf16 v[128:143], a[200:203], a[56:59], v[128:143]
    v_exp_f32 v159, v159
    ds_read_b64_tr_b16 a[188:189], v209 offset:40960
    ds_read_b64_tr_b16 a[190:191], v209 offset:43008
    v_mfma_f32_32x32x16_bf16 v[128:143], a[204:207], a[60:63], v[128:143]
    v_cvt_pk_bf16_f32 v175, v158, v159
    s_barrier
    s_cmp_eq_u32 s46, 0
    s_cbranch_scc1 attn_kernel_nors11
    v_mul_f32 v0, v0, v229
    v_mul_f32 v1, v1, v229
    v_mul_f32 v2, v2, v229
    v_mul_f32 v3, v3, v229
    v_mul_f32 v4, v4, v229
    v_mul_f32 v5, v5, v229
    v_mul_f32 v6, v6, v229
    v_mul_f32 v7, v7, v229
    v_mul_f32 v8, v8, v229
    v_mul_f32 v9, v9, v229
    v_mul_f32 v10, v10, v229
    v_mul_f32 v11, v11, v229
    v_mul_f32 v12, v12, v229
    v_mul_f32 v13, v13, v229
    v_mul_f32 v14, v14, v229
    v_mul_f32 v15, v15, v229
    v_mul_f32 v16, v16, v229
    v_mul_f32 v17, v17, v229
    v_mul_f32 v18, v18, v229
    v_mul_f32 v19, v19, v229
    v_mul_f32 v20, v20, v229
    v_mul_f32 v21, v21, v229
    v_mul_f32 v22, v22, v229
    v_mul_f32 v23, v23, v229
    v_mul_f32 v24, v24, v229
    v_mul_f32 v25, v25, v229
    v_mul_f32 v26, v26, v229
    v_mul_f32 v27, v27, v229
    v_mul_f32 v28, v28, v229
    v_mul_f32 v29, v29, v229
    v_mul_f32 v30, v30, v229
    v_mul_f32 v31, v31, v229
    v_mul_f32 v32, v32, v229
    v_mul_f32 v33, v33, v229
    v_mul_f32 v34, v34, v229
    v_mul_f32 v35, v35, v229
    v_mul_f32 v36, v36, v229
    v_mul_f32 v37, v37, v229
    v_mul_f32 v38, v38, v229
    v_mul_f32 v39, v39, v229
    v_mul_f32 v40, v40, v229
    v_mul_f32 v41, v41, v229
    v_mul_f32 v42, v42, v229
    v_mul_f32 v43, v43, v229
    v_mul_f32 v44, v44, v229
    v_mul_f32 v45, v45, v229
    v_mul_f32 v46, v46, v229
    v_mul_f32 v47, v47, v229
    v_mul_f32 v48, v48, v229
    v_mul_f32 v49, v49, v229
    v_mul_f32 v50, v50, v229
    v_mul_f32 v51, v51, v229
    v_mul_f32 v52, v52, v229
    v_mul_f32 v53, v53, v229
    v_mul_f32 v54, v54, v229
    v_mul_f32 v55, v55, v229
    v_mul_f32 v56, v56, v229
    v_mul_f32 v57, v57, v229
    v_mul_f32 v58, v58, v229
    v_mul_f32 v59, v59, v229
    v_mul_f32 v60, v60, v229
    v_mul_f32 v61, v61, v229
    v_mul_f32 v62, v62, v229
    v_mul_f32 v63, v63, v229
    v_mul_f32 v64, v64, v229
    v_mul_f32 v65, v65, v229
    v_mul_f32 v66, v66, v229
    v_mul_f32 v67, v67, v229
    v_mul_f32 v68, v68, v229
    v_mul_f32 v69, v69, v229
    v_mul_f32 v70, v70, v229
    v_mul_f32 v71, v71, v229
    v_mul_f32 v72, v72, v229
    v_mul_f32 v73, v73, v229
    v_mul_f32 v74, v74, v229
    v_mul_f32 v75, v75, v229
    v_mul_f32 v76, v76, v229
    v_mul_f32 v77, v77, v229
    v_mul_f32 v78, v78, v229
    v_mul_f32 v79, v79, v229
    v_mul_f32 v80, v80, v229
    v_mul_f32 v81, v81, v229
    v_mul_f32 v82, v82, v229
    v_mul_f32 v83, v83, v229
    v_mul_f32 v84, v84, v229
    v_mul_f32 v85, v85, v229
    v_mul_f32 v86, v86, v229
    v_mul_f32 v87, v87, v229
    v_mul_f32 v88, v88, v229
    v_mul_f32 v89, v89, v229
    v_mul_f32 v90, v90, v229
    v_mul_f32 v91, v91, v229
    v_mul_f32 v92, v92, v229
    v_mul_f32 v93, v93, v229
    v_mul_f32 v94, v94, v229
    v_mul_f32 v95, v95, v229
    v_mul_f32 v96, v96, v229
    v_mul_f32 v97, v97, v229
    v_mul_f32 v98, v98, v229
    v_mul_f32 v99, v99, v229
    v_mul_f32 v100, v100, v229
    v_mul_f32 v101, v101, v229
    v_mul_f32 v102, v102, v229
    v_mul_f32 v103, v103, v229
    v_mul_f32 v104, v104, v229
    v_mul_f32 v105, v105, v229
    v_mul_f32 v106, v106, v229
    v_mul_f32 v107, v107, v229
    v_mul_f32 v108, v108, v229
    v_mul_f32 v109, v109, v229
    v_mul_f32 v110, v110, v229
    v_mul_f32 v111, v111, v229
    v_mul_f32 v112, v112, v229
    v_mul_f32 v113, v113, v229
    v_mul_f32 v114, v114, v229
    v_mul_f32 v115, v115, v229
    v_mul_f32 v116, v116, v229
    v_mul_f32 v117, v117, v229
    v_mul_f32 v118, v118, v229
    v_mul_f32 v119, v119, v229
    v_mul_f32 v120, v120, v229
    v_mul_f32 v121, v121, v229
    v_mul_f32 v122, v122, v229
    v_mul_f32 v123, v123, v229
    v_mul_f32 v124, v124, v229
    v_mul_f32 v125, v125, v229
    v_mul_f32 v126, v126, v229
    v_mul_f32 v127, v127, v229
    v_mul_f32 v176, v176, v229
    s_nop 1
attn_kernel_nors11:
    ds_read_b64_tr_b16 a[192:193], v210 offset:32768
    ds_read_b64_tr_b16 a[194:195], v210 offset:34816
    s_waitcnt lgkmcnt(6)
    v_mfma_f32_32x32x16_bf16 v[0:15], a[176:179], v[168:171], v[0:15]
    s_nop 3
    v_max3_f32 v220, v128, v129, v130
    v_max3_f32 v221, v131, v132, v133
    ds_read_b64_tr_b16 a[196:197], v210 offset:40960
    ds_read_b64_tr_b16 a[198:199], v210 offset:43008
    v_mfma_f32_32x32x16_bf16 v[0:15], a[180:183], v[172:175], v[0:15]
    v_max3_f32 v222, v134, v135, v136
    v_max3_f32 v220, v220, v137, v138
    ds_read_b64_tr_b16 a[200:201], v211 offset:32768
    ds_read_b64_tr_b16 a[202:203], v211 offset:34816
    s_waitcnt lgkmcnt(6)
    v_mfma_f32_32x32x16_bf16 v[16:31], a[184:187], v[168:171], v[16:31]
    v_max3_f32 v221, v221, v139, v140
    v_max3_f32 v222, v222, v141, v142
    ds_read_b64_tr_b16 a[204:205], v211 offset:40960
    ds_read_b64_tr_b16 a[206:207], v211 offset:43008
    v_mfma_f32_32x32x16_bf16 v[16:31], a[188:191], v[172:175], v[16:31]
    v_max_f32 v220, v220, v143
    v_mov_b32 v229, 1.0
    ds_read_b64_tr_b16 a[176:177], v208 offset:33024
    ds_read_b64_tr_b16 a[178:179], v208 offset:35072
    s_waitcnt lgkmcnt(6)
    v_mfma_f32_32x32x16_bf16 v[32:47], a[192:195], v[168:171], v[32:47]
    v_max3_f32 v220, v220, v221, v222
    v_mov_b32 v221, v220
    s_nop 1
    v_permlane32_swap_b32 v220, v221
    v_max_f32 v220, v220, v221
    v_cmp_gt_f32 vcc, v220, v218
    s_mov_b32 s46, 0
    s_cbranch_vccz attn_kernel_skip12
    v_max_f32 v221, v216, v220
    v_sub_f32 v222, v216, v221
    v_mul_f32 v222, s30, v222
    v_exp_f32 v229, v222
    v_mov_b32 v216, v221
    v_mul_f32 v217, s30, v221
    v_add_f32 v218, s31, v221
    s_mov_b32 s46, 1
    s_nop 0
attn_kernel_skip12:
    ds_read_b64_tr_b16 a[180:181], v208 offset:41216
    ds_read_b64_tr_b16 a[182:183], v208 offset:43264
    v_mfma_f32_32x32x16_bf16 v[32:47], a[196:199], v[172:175], v[32:47]
    v_mfma_f32_32x32x16_bf16 v[176:191], v[192:195], v[168:171], v[176:191]
    v_fma_f32 v128, v128, s30, -v217
    v_fma_f32 v129, v129, s30, -v217
    ds_read_b64_tr_b16 a[184:185], v209 offset:33024
    ds_read_b64_tr_b16 a[186:187], v209 offset:35072
    s_waitcnt lgkmcnt(6)
    v_mfma_f32_32x32x16_bf16 v[48:63], a[200:203], v[168:171], v[48:63]
    v_fma_f32 v130, v130, s30, -v217
    v_exp_f32 v128, v128
    ds_read_b64_tr_b16 a[188:189], v209 offset:41216
    ds_read_b64_tr_b16 a[190:191], v209 offset:43264
    v_mfma_f32_32x32x16_bf16 v[48:63], a[204:207], v[172:175], v[48:63]
    v_fma_f32 v131, v131, s30, -v217
    ds_read_b64_tr_b16 a[192:193], v210 offset:33024
    ds_read_b64_tr_b16 a[194:195], v210 offset:35072
    s_waitcnt lgkmcnt(6)
    v_mfma_f32_32x32x16_bf16 v[64:79], a[176:179], v[168:171], v[64:79]
    v_exp_f32 v129, v129
    v_fma_f32 v132, v132, s30, -v217
    ds_read_b64_tr_b16 a[196:197], v210 offset:41216
    ds_read_b64_tr_b16 a[198:199], v210 offset:43264
    v_mfma_f32_32x32x16_bf16 v[64:79], a[180:183], v[172:175], v[64:79]
    v_exp_f32 v130, v130
    v_fma_f32 v133, v133, s30, -v217
    ds_read_b64_tr_b16 a[200:201], v211 offset:33024
    ds_read_b64_tr_b16 a[202:203], v211 offset:35072
    s_waitcnt lgkmcnt(6)
    v_mfma_f32_32x32x16_bf16 v[80:95], a[184:187], v[168:171], v[80:95]
    v_mfma_f32_32x32x16_bf16 v[176:191], v[192:195], v[172:175], v[176:191]
    v_cvt_pk_bf16_f32 v160, v128, v129
    v_exp_f32 v131, v131
    ds_read_b64_tr_b16 a[204:205], v211 offset:41216
    ds_read_b64_tr_b16 a[206:207], v211 offset:43264
    v_mfma_f32_32x32x16_bf16 v[80:95], a[188:191], v[172:175], v[80:95]
    v_fma_f32 v134, v134, s30, -v217
    v_exp_f32 v132, v132
    ds_read_b128 a[176:179], v200 offset:49152
    s_waitcnt lgkmcnt(5)
    v_mfma_f32_32x32x16_bf16 v[96:111], a[192:195], v[168:171], v[96:111]
    v_fma_f32 v135, v135, s30, -v217
    v_cvt_pk_bf16_f32 v161, v130, v131
    ds_read_b128 a[180:183], v201 offset:49152
    v_mfma_f32_32x32x16_bf16 v[96:111], a[196:199], v[172:175], v[96:111]
    v_exp_f32 v133, v133
    v_fma_f32 v136, v136, s30, -v217
    ds_read_b128 a[184:187], v202 offset:49152
    s_waitcnt lgkmcnt(3)
    v_mfma_f32_32x32x16_bf16 v[112:127], a[200:203], v[168:171], v[112:127]
    v_exp_f32 v134, v134
    v_fma_f32 v137, v137, s30, -v217
    ds_read_b128 a[188:191], v203 offset:49152
    v_mfma_f32_32x32x16_bf16 v[112:127], a[204:207], v[172:175], v[112:127]
    v_cvt_pk_bf16_f32 v162, v132, v133
    s_barrier
    ds_read_b128 a[192:195], v204 offset:49152
    s_waitcnt lgkmcnt(3)
    v_mfma_f32_32x32x16_bf16 v[144:159], a[176:179], a[0:3], 0
    v_exp_f32 v135, v135
    v_fma_f32 v138, v138, s30, -v217
    ds_read_b128 a[196:199], v205 offset:49152
    v_mfma_f32_32x32x16_bf16 v[144:159], a[180:183], a[4:7], v[144:159]
    v_exp_f32 v136, v136
    ds_read_b128 a[200:203], v206 offset:49152
    s_waitcnt lgkmcnt(3)
    v_mfma_f32_32x32x16_bf16 v[144:159], a[184:187], a[8:11], v[144:159]
    v_fma_f32 v139, v139, s30, -v217
    ds_read_b128 a[204:207], v207 offset:49152
    v_mfma_f32_32x32x16_bf16 v[144:159], a[188:191], a[12:15], v[144:159]
    v_cvt_pk_bf16_f32 v163, v134, v135
    ds_read_b128 a[176:179], v200 offset:49408
    s_waitcnt lgkmcnt(3)
    v_mfma_f32_32x32x16_bf16 v[144:159], a[192:195], a[16:19], v[144:159]
    v_exp_f32 v137, v137
    v_fma_f32 v140, v140, s30, -v217
    ds_read_b128 a[180:183], v201 offset:49408
    v_mfma_f32_32x32x16_bf16 v[144:159], a[196:199], a[20:23], v[144:159]
    v_exp_f32 v138, v138
    ds_read_b128 a[184:187], v202 offset:49408
    s_waitcnt lgkmcnt(3)
    v_mfma_f32_32x32x16_bf16 v[144:159], a[200:203], a[24:27], v[144:159]
    v_fma_f32 v141, v141, s30, -v217
    ds_read_b128 a[188:191], v203 offset:49408
    v_mfma_f32_32x32x16_bf16 v[144:159], a[204:207], a[28:31], v[144:159]
    v_cvt_pk_bf16_f32 v164, v136, v137
    ds_read_b128 a[192:195], v204 offset:49408
    s_waitcnt lgkmcnt(3)
    v_mfma_f32_32x32x16_bf16 v[144:159], a[176:179], a[32:35], v[144:159]
    v_exp_f32 v139, v139
    v_fma_f32 v142, v142, s30, -v217
    ds_read_b128 a[196:199], v205 offset:49408
    v_mfma_f32_32x32x16_bf16 v[144:159], a[180:183], a[36:39], v[144:159]
    v_exp_f32 v140, v140
    ds_read_b128 a[200:203], v206 offset:49408
    s_waitcnt lgkmcnt(3)
    v_mfma_f32_32x32x16_bf16 v[144:159], a[184:187], a[40:43], v[144:159]
    v_fma_f32 v143, v143, s30, -v217
    ds_read_b128 a[204:207], v207 offset:49408
    v_mfma_f32_32x32x16_bf16 v[144:159], a[188:191], a[44:47], v[144:159]
    v_cvt_pk_bf16_f32 v165, v138, v139
    ds_read_b64_tr_b16 a[176:177], v212
    ds_read_b64_tr_b16 a[178:179], v212 offset:2048
    s_waitcnt lgkmcnt(4)
    v_mfma_f32_32x32x16_bf16 v[144:159], a[192:195], a[48:51], v[144:159]
    v_exp_f32 v141, v141
    v_exp_f32 v142, v142
    ds_read_b64_tr_b16 a[180:181], v212 offset:8192
    ds_read_b64_tr_b16 a[182:183], v212 offset:10240
    v_mfma_f32_32x32x16_bf16 v[144:159], a[196:199], a[52:55], v[144:159]
    v_cvt_pk_bf16_f32 v166, v140, v141
    ds_read_b64_tr_b16 a[184:185], v213
    ds_read_b64_tr_b16 a[186:187], v213 offset:2048
    s_waitcnt lgkmcnt(6)
    v_mfma_f32_32x32x16_bf16 v[144:159], a[200:203], a[56:59], v[144:159]
    v_exp_f32 v143, v143
    ds_read_b64_tr_b16 a[188:189], v213 offset:8192
    ds_read_b64_tr_b16 a[190:191], v213 offset:10240
    v_mfma_f32_32x32x16_bf16 v[144:159], a[204:207], a[60:63], v[144:159]
    v_cvt_pk_bf16_f32 v167, v142, v143
    s_barrier
    s_cmp_eq_u32 s46, 0
    s_cbranch_scc1 attn_kernel_nors13
    v_mul_f32 v0, v0, v229
    v_mul_f32 v1, v1, v229
    v_mul_f32 v2, v2, v229
    v_mul_f32 v3, v3, v229
    v_mul_f32 v4, v4, v229
    v_mul_f32 v5, v5, v229
    v_mul_f32 v6, v6, v229
    v_mul_f32 v7, v7, v229
    v_mul_f32 v8, v8, v229
    v_mul_f32 v9, v9, v229
    v_mul_f32 v10, v10, v229
    v_mul_f32 v11, v11, v229
    v_mul_f32 v12, v12, v229
    v_mul_f32 v13, v13, v229
    v_mul_f32 v14, v14, v229
    v_mul_f32 v15, v15, v229
    v_mul_f32 v16, v16, v229
    v_mul_f32 v17, v17, v229
    v_mul_f32 v18, v18, v229
    v_mul_f32 v19, v19, v229
    v_mul_f32 v20, v20, v229
    v_mul_f32 v21, v21, v229
    v_mul_f32 v22, v22, v229
    v_mul_f32 v23, v23, v229
    v_mul_f32 v24, v24, v229
    v_mul_f32 v25, v25, v229
    v_mul_f32 v26, v26, v229
    v_mul_f32 v27, v27, v229
    v_mul_f32 v28, v28, v229
    v_mul_f32 v29, v29, v229
    v_mul_f32 v30, v30, v229
    v_mul_f32 v31, v31, v229
    v_mul_f32 v32, v32, v229
    v_mul_f32 v33, v33, v229
    v_mul_f32 v34, v34, v229
    v_mul_f32 v35, v35, v229
    v_mul_f32 v36, v36, v229
    v_mul_f32 v37, v37, v229
    v_mul_f32 v38, v38, v229
    v_mul_f32 v39, v39, v229
    v_mul_f32 v40, v40, v229
    v_mul_f32 v41, v41, v229
    v_mul_f32 v42, v42, v229
    v_mul_f32 v43, v43, v229
    v_mul_f32 v44, v44, v229
    v_mul_f32 v45, v45, v229
    v_mul_f32 v46, v46, v229
    v_mul_f32 v47, v47, v229
    v_mul_f32 v48, v48, v229
    v_mul_f32 v49, v49, v229
    v_mul_f32 v50, v50, v229
    v_mul_f32 v51, v51, v229
    v_mul_f32 v52, v52, v229
    v_mul_f32 v53, v53, v229
    v_mul_f32 v54, v54, v229
    v_mul_f32 v55, v55, v229
    v_mul_f32 v56, v56, v229
    v_mul_f32 v57, v57, v229
    v_mul_f32 v58, v58, v229
    v_mul_f32 v59, v59, v229
    v_mul_f32 v60, v60, v229
    v_mul_f32 v61, v61, v229
    v_mul_f32 v62, v62, v229
    v_mul_f32 v63, v63, v229
    v_mul_f32 v64, v64, v229
    v_mul_f32 v65, v65, v229
    v_mul_f32 v66, v66, v229
    v_mul_f32 v67, v67, v229
    v_mul_f32 v68, v68, v229
    v_mul_f32 v69, v69, v229
    v_mul_f32 v70, v70, v229
    v_mul_f32 v71, v71, v229
    v_mul_f32 v72, v72, v229
    v_mul_f32 v73, v73, v229
    v_mul_f32 v74, v74, v229
    v_mul_f32 v75, v75, v229
    v_mul_f32 v76, v76, v229
    v_mul_f32 v77, v77, v229
    v_mul_f32 v78, v78, v229
    v_mul_f32 v79, v79, v229
    v_mul_f32 v80, v80, v229
    v_mul_f32 v81, v81, v229
    v_mul_f32 v82, v82, v229
    v_mul_f32 v83, v83, v229
    v_mul_f32 v84, v84, v229
    v_mul_f32 v85, v85, v229
    v_mul_f32 v86, v86, v229
    v_mul_f32 v87, v87, v229
    v_mul_f32 v88, v88, v229
    v_mul_f32 v89, v89, v229
    v_mul_f32 v90, v90, v229
    v_mul_f32 v91, v91, v229
    v_mul_f32 v92, v92, v229
    v_mul_f32 v93, v93, v229
    v_mul_f32 v94, v94, v229
    v_mul_f32 v95, v95, v229
    v_mul_f32 v96, v96, v229
    v_mul_f32 v97, v97, v229
    v_mul_f32 v98, v98, v229
    v_mul_f32 v99, v99, v229
    v_mul_f32 v100, v100, v229
    v_mul_f32 v101, v101, v229
    v_mul_f32 v102, v102, v229
    v_mul_f32 v103, v103, v229
    v_mul_f32 v104, v104, v229
    v_mul_f32 v105, v105, v229
    v_mul_f32 v106, v106, v229
    v_mul_f32 v107, v107, v229
    v_mul_f32 v108, v108, v229
    v_mul_f32 v109, v109, v229
    v_mul_f32 v110, v110, v229
    v_mul_f32 v111, v111, v229
    v_mul_f32 v112, v112, v229
    v_mul_f32 v113, v113, v229
    v_mul_f32 v114, v114, v229
    v_mul_f32 v115, v115, v229
    v_mul_f32 v116, v116, v229
    v_mul_f32 v117, v117, v229
    v_mul_f32 v118, v118, v229
    v_mul_f32 v119, v119, v229
    v_mul_f32 v120, v120, v229
    v_mul_f32 v121, v121, v229
    v_mul_f32 v122, v122, v229
    v_mul_f32 v123, v123, v229
    v_mul_f32 v124, v124, v229
    v_mul_f32 v125, v125, v229
    v_mul_f32 v126, v126, v229
    v_mul_f32 v127, v127, v229
    v_mul_f32 v176, v176, v229
    s_nop 1
attn_kernel_nors13:
    ds_read_b64_tr_b16 a[192:193], v214
    ds_read_b64_tr_b16 a[194:195], v214 offset:2048
    s_waitcnt lgkmcnt(6)
    v_mfma_f32_32x32x16_bf16 v[0:15], a[176:179], v[160:163], v[0:15]
    s_nop 3
    v_max3_f32 v220, v144, v145, v146
    v_max3_f32 v221, v147, v148, v149
    ds_read_b64_tr_b16 a[196:197], v214 offset:8192
    ds_read_b64_tr_b16 a[198:199], v214 offset:10240
    v_mfma_f32_32x32x16_bf16 v[0:15], a[180:183], v[164:167], v[0:15]
    v_max3_f32 v222, v150, v151, v152
    v_max3_f32 v220, v220, v153, v154
    ds_read_b64_tr_b16 a[200:201], v215
    ds_read_b64_tr_b16 a[202:203], v215 offset:2048
    s_waitcnt lgkmcnt(6)
    v_mfma_f32_32x32x16_bf16 v[16:31], a[184:187], v[160:163], v[16:31]
    v_max3_f32 v221, v221, v155, v156
    v_max3_f32 v222, v222, v157, v158
    ds_read_b64_tr_b16 a[204:205], v215 offset:8192
    ds_read_b64_tr_b16 a[206:207], v215 offset:10240
    v_mfma_f32_32x32x16_bf16 v[16:31], a[188:191], v[164:167], v[16:31]
    v_max_f32 v220, v220, v159
    v_mov_b32 v229, 1.0
    ds_read_b64_tr_b16 a[176:177], v212 offset:256
    ds_read_b64_tr_b16 a[178:179], v212 offset:2304
    s_waitcnt lgkmcnt(6)
    v_mfma_f32_32x32x16_bf16 v[32:47], a[192:195], v[160:163], v[32:47]
    v_max3_f32 v220, v220, v221, v222
    v_mov_b32 v221, v220
    s_nop 1
    v_permlane32_swap_b32 v220, v221
    v_max_f32 v220, v220, v221
    v_cmp_gt_f32 vcc, v220, v218
    s_mov_b32 s46, 0
    s_cbranch_vccz attn_kernel_skip14
    v_max_f32 v221, v216, v220
    v_sub_f32 v222, v216, v221
    v_mul_f32 v222, s30, v222
    v_exp_f32 v229, v222
    v_mov_b32 v216, v221
    v_mul_f32 v217, s30, v221
    v_add_f32 v218, s31, v221
    s_mov_b32 s46, 1
    s_nop 0
attn_kernel_skip14:
    ds_read_b64_tr_b16 a[180:181], v212 offset:8448
    ds_read_b64_tr_b16 a[182:183], v212 offset:10496
    v_mfma_f32_32x32x16_bf16 v[32:47], a[196:199], v[164:167], v[32:47]
    v_mfma_f32_32x32x16_bf16 v[176:191], v[192:195], v[160:163], v[176:191]
    v_fma_f32 v144, v144, s30, -v217
    v_fma_f32 v145, v145, s30, -v217
    ds_read_b64_tr_b16 a[184:185], v213 offset:256
    ds_read_b64_tr_b16 a[186:187], v213 offset:2304
    s_waitcnt lgkmcnt(6)
    v_mfma_f32_32x32x16_bf16 v[48:63], a[200:203], v[160:163], v[48:63]
    v_fma_f32 v146, v146, s30, -v217
    v_exp_f32 v144, v144
    ds_read_b64_tr_b16 a[188:189], v213 offset:8448
    ds_read_b64_tr_b16 a[190:191], v213 offset:10496
    v_mfma_f32_32x32x16_bf16 v[48:63], a[204:207], v[164:167], v[48:63]
    v_fma_f32 v147, v147, s30, -v217
    ds_read_b64_tr_b16 a[192:193], v214 offset:256
    ds_read_b64_tr_b16 a[194:195], v214 offset:2304
    s_waitcnt lgkmcnt(6)
    v_mfma_f32_32x32x16_bf16 v[64:79], a[176:179], v[160:163], v[64:79]
    v_exp_f32 v145, v145
    v_fma_f32 v148, v148, s30, -v217
    ds_read_b64_tr_b16 a[196:197], v214 offset:8448
    ds_read_b64_tr_b16 a[198:199], v214 offset:10496
    v_mfma_f32_32x32x16_bf16 v[64:79], a[180:183], v[164:167], v[64:79]
    v_exp_f32 v146, v146
    v_fma_f32 v149, v149, s30, -v217
    ds_read_b64_tr_b16 a[200:201], v215 offset:256
    ds_read_b64_tr_b16 a[202:203], v215 offset:2304
    s_waitcnt lgkmcnt(6)
    v_mfma_f32_32x32x16_bf16 v[80:95], a[184:187], v[160:163], v[80:95]
    v_mfma_f32_32x32x16_bf16 v[176:191], v[192:195], v[164:167], v[176:191]
    v_cvt_pk_bf16_f32 v168, v144, v145
    v_exp_f32 v147, v147
    ds_read_b64_tr_b16 a[204:205], v215 offset:8448
    ds_read_b64_tr_b16 a[206:207], v215 offset:10496
    v_mfma_f32_32x32x16_bf16 v[80:95], a[188:191], v[164:167], v[80:95]
    v_fma_f32 v150, v150, s30, -v217
    v_exp_f32 v148, v148
    ds_read_b128 a[176:179], v232 offset:16384
    s_waitcnt lgkmcnt(5)
    v_mfma_f32_32x32x16_bf16 v[96:111], a[192:195], v[160:163], v[96:111]
    v_fma_f32 v151, v151, s30, -v217
    v_cvt_pk_bf16_f32 v169, v146, v147
    ds_read_b128 a[180:183], v233 offset:16384
    v_mfma_f32_32x32x16_bf16 v[96:111], a[196:199], v[164:167], v[96:111]
    v_exp_f32 v149, v149
    v_fma_f32 v152, v152, s30, -v217
    ds_read_b128 a[184:187], v234 offset:16384
    s_waitcnt lgkmcnt(3)
    v_mfma_f32_32x32x16_bf16 v[112:127], a[200:203], v[160:163], v[112:127]
    v_exp_f32 v150, v150
    v_fma_f32 v153, v153, s30, -v217
    ds_read_b128 a[188:191], v235 offset:16384
    v_mfma_f32_32x32x16_bf16 v[112:127], a[204:207], v[164:167], v[112:127]
    v_cvt_pk_bf16_f32 v170, v148, v149
    s_barrier
    ds_read_b128 a[192:195], v236 offset:16384
    s_waitcnt lgkmcnt(3)
    v_mfma_f32_32x32x16_bf16 v[128:143], a[176:179], a[0:3], 0
    v_exp_f32 v151, v151
    v_fma_f32 v154, v154, s30, -v217
    ds_read_b128 a[196:199], v237 offset:16384
    v_mfma_f32_32x32x16_bf16 v[128:143], a[180:183], a[4:7], v[128:143]
    v_exp_f32 v152, v152
    ds_read_b128 a[200:203], v238 offset:16384
    s_waitcnt lgkmcnt(3)
    v_mfma_f32_32x32x16_bf16 v[128:143], a[184:187], a[8:11], v[128:143]
    v_fma_f32 v155, v155, s30, -v217
    ds_read_b128 a[204:207], v239 offset:16384
    v_mfma_f32_32x32x16_bf16 v[128:143], a[188:191], a[12:15], v[128:143]
    v_cvt_pk_bf16_f32 v171, v150, v151
    ds_read_b128 a[176:179], v232 offset:16640
    s_waitcnt lgkmcnt(3)
    v_mfma_f32_32x32x16_bf16 v[128:143], a[192:195], a[16:19], v[128:143]
    v_exp_f32 v153, v153
    v_fma_f32 v156, v156, s30, -v217
    ds_read_b128 a[180:183], v233 offset:16640
    v_mfma_f32_32x32x16_bf16 v[128:143], a[196:199], a[20:23], v[128:143]
    v_exp_f32 v154, v154
    ds_read_b128 a[184:187], v234 offset:16640
    s_waitcnt lgkmcnt(3)
    v_mfma_f32_32x32x16_bf16 v[128:143], a[200:203], a[24:27], v[128:143]
    v_fma_f32 v157, v157, s30, -v217
    ds_read_b128 a[188:191], v235 offset:16640
    v_mfma_f32_32x32x16_bf16 v[128:143], a[204:207], a[28:31], v[128:143]
    v_cvt_pk_bf16_f32 v172, v152, v153
    ds_read_b128 a[192:195], v236 offset:16640
    s_waitcnt lgkmcnt(3)
    v_mfma_f32_32x32x16_bf16 v[128:143], a[176:179], a[32:35], v[128:143]
    v_exp_f32 v155, v155
    v_fma_f32 v158, v158, s30, -v217
    ds_read_b128 a[196:199], v237 offset:16640
    v_mfma_f32_32x32x16_bf16 v[128:143], a[180:183], a[36:39], v[128:143]
    v_exp_f32 v156, v156
    ds_read_b128 a[200:203], v238 offset:16640
    s_waitcnt lgkmcnt(3)
    v_mfma_f32_32x32x16_bf16 v[128:143], a[184:187], a[40:43], v[128:143]
    v_fma_f32 v159, v159, s30, -v217
    ds_read_b128 a[204:207], v239 offset:16640
    v_mfma_f32_32x32x16_bf16 v[128:143], a[188:191], a[44:47], v[128:143]
    v_cvt_pk_bf16_f32 v173, v154, v155
    ds_read_b64_tr_b16 a[176:177], v212 offset:32768
    ds_read_b64_tr_b16 a[178:179], v212 offset:34816
    s_waitcnt lgkmcnt(4)
    v_mfma_f32_32x32x16_bf16 v[128:143], a[192:195], a[48:51], v[128:143]
    v_exp_f32 v157, v157
    v_exp_f32 v158, v158
    ds_read_b64_tr_b16 a[180:181], v212 offset:40960
    ds_read_b64_tr_b16 a[182:183], v212 offset:43008
    v_mfma_f32_32x32x16_bf16 v[128:143], a[196:199], a[52:55], v[128:143]
    v_cvt_pk_bf16_f32 v174, v156, v157
    ds_read_b64_tr_b16 a[184:185], v213 offset:32768
    ds_read_b64_tr_b16 a[186:187], v213 offset:34816
    s_waitcnt lgkmcnt(6)
    v_mfma_f32_32x32x16_bf16 v[128:143], a[200:203], a[56:59], v[128:143]
    v_exp_f32 v159, v159
    ds_read_b64_tr_b16 a[188:189], v213 offset:40960
    ds_read_b64_tr_b16 a[190:191], v213 offset:43008
    v_mfma_f32_32x32x16_bf16 v[128:143], a[204:207], a[60:63], v[128:143]
    v_cvt_pk_bf16_f32 v175, v158, v159
    s_barrier
    s_cmp_eq_u32 s46, 0
    s_cbranch_scc1 attn_kernel_nors15
    v_mul_f32 v0, v0, v229
    v_mul_f32 v1, v1, v229
    v_mul_f32 v2, v2, v229
    v_mul_f32 v3, v3, v229
    v_mul_f32 v4, v4, v229
    v_mul_f32 v5, v5, v229
    v_mul_f32 v6, v6, v229
    v_mul_f32 v7, v7, v229
    v_mul_f32 v8, v8, v229
    v_mul_f32 v9, v9, v229
    v_mul_f32 v10, v10, v229
    v_mul_f32 v11, v11, v229
    v_mul_f32 v12, v12, v229
    v_mul_f32 v13, v13, v229
    v_mul_f32 v14, v14, v229
    v_mul_f32 v15, v15, v229
    v_mul_f32 v16, v16, v229
    v_mul_f32 v17, v17, v229
    v_mul_f32 v18, v18, v229
    v_mul_f32 v19, v19, v229
    v_mul_f32 v20, v20, v229
    v_mul_f32 v21, v21, v229
    v_mul_f32 v22, v22, v229
    v_mul_f32 v23, v23, v229
    v_mul_f32 v24, v24, v229
    v_mul_f32 v25, v25, v229
    v_mul_f32 v26, v26, v229
    v_mul_f32 v27, v27, v229
    v_mul_f32 v28, v28, v229
    v_mul_f32 v29, v29, v229
    v_mul_f32 v30, v30, v229
    v_mul_f32 v31, v31, v229
    v_mul_f32 v32, v32, v229
    v_mul_f32 v33, v33, v229
    v_mul_f32 v34, v34, v229
    v_mul_f32 v35, v35, v229
    v_mul_f32 v36, v36, v229
    v_mul_f32 v37, v37, v229
    v_mul_f32 v38, v38, v229
    v_mul_f32 v39, v39, v229
    v_mul_f32 v40, v40, v229
    v_mul_f32 v41, v41, v229
    v_mul_f32 v42, v42, v229
    v_mul_f32 v43, v43, v229
    v_mul_f32 v44, v44, v229
    v_mul_f32 v45, v45, v229
    v_mul_f32 v46, v46, v229
    v_mul_f32 v47, v47, v229
    v_mul_f32 v48, v48, v229
    v_mul_f32 v49, v49, v229
    v_mul_f32 v50, v50, v229
    v_mul_f32 v51, v51, v229
    v_mul_f32 v52, v52, v229
    v_mul_f32 v53, v53, v229
    v_mul_f32 v54, v54, v229
    v_mul_f32 v55, v55, v229
    v_mul_f32 v56, v56, v229
    v_mul_f32 v57, v57, v229
    v_mul_f32 v58, v58, v229
    v_mul_f32 v59, v59, v229
    v_mul_f32 v60, v60, v229
    v_mul_f32 v61, v61, v229
    v_mul_f32 v62, v62, v229
    v_mul_f32 v63, v63, v229
    v_mul_f32 v64, v64, v229
    v_mul_f32 v65, v65, v229
    v_mul_f32 v66, v66, v229
    v_mul_f32 v67, v67, v229
    v_mul_f32 v68, v68, v229
    v_mul_f32 v69, v69, v229
    v_mul_f32 v70, v70, v229
    v_mul_f32 v71, v71, v229
    v_mul_f32 v72, v72, v229
    v_mul_f32 v73, v73, v229
    v_mul_f32 v74, v74, v229
    v_mul_f32 v75, v75, v229
    v_mul_f32 v76, v76, v229
    v_mul_f32 v77, v77, v229
    v_mul_f32 v78, v78, v229
    v_mul_f32 v79, v79, v229
    v_mul_f32 v80, v80, v229
    v_mul_f32 v81, v81, v229
    v_mul_f32 v82, v82, v229
    v_mul_f32 v83, v83, v229
    v_mul_f32 v84, v84, v229
    v_mul_f32 v85, v85, v229
    v_mul_f32 v86, v86, v229
    v_mul_f32 v87, v87, v229
    v_mul_f32 v88, v88, v229
    v_mul_f32 v89, v89, v229
    v_mul_f32 v90, v90, v229
    v_mul_f32 v91, v91, v229
    v_mul_f32 v92, v92, v229
    v_mul_f32 v93, v93, v229
    v_mul_f32 v94, v94, v229
    v_mul_f32 v95, v95, v229
    v_mul_f32 v96, v96, v229
    v_mul_f32 v97, v97, v229
    v_mul_f32 v98, v98, v229
    v_mul_f32 v99, v99, v229
    v_mul_f32 v100, v100, v229
    v_mul_f32 v101, v101, v229
    v_mul_f32 v102, v102, v229
    v_mul_f32 v103, v103, v229
    v_mul_f32 v104, v104, v229
    v_mul_f32 v105, v105, v229
    v_mul_f32 v106, v106, v229
    v_mul_f32 v107, v107, v229
    v_mul_f32 v108, v108, v229
    v_mul_f32 v109, v109, v229
    v_mul_f32 v110, v110, v229
    v_mul_f32 v111, v111, v229
    v_mul_f32 v112, v112, v229
    v_mul_f32 v113, v113, v229
    v_mul_f32 v114, v114, v229
    v_mul_f32 v115, v115, v229
    v_mul_f32 v116, v116, v229
    v_mul_f32 v117, v117, v229
    v_mul_f32 v118, v118, v229
    v_mul_f32 v119, v119, v229
    v_mul_f32 v120, v120, v229
    v_mul_f32 v121, v121, v229
    v_mul_f32 v122, v122, v229
    v_mul_f32 v123, v123, v229
    v_mul_f32 v124, v124, v229
    v_mul_f32 v125, v125, v229
    v_mul_f32 v126, v126, v229
    v_mul_f32 v127, v127, v229
    v_mul_f32 v176, v176, v229
    s_nop 1
attn_kernel_nors15:
    ds_read_b64_tr_b16 a[192:193], v214 offset:32768
    ds_read_b64_tr_b16 a[194:195], v214 offset:34816
    s_waitcnt lgkmcnt(6)
    v_mfma_f32_32x32x16_bf16 v[0:15], a[176:179], v[168:171], v[0:15]
    s_nop 3
    v_max3_f32 v220, v128, v129, v130
    v_max3_f32 v221, v131, v132, v133
    ds_read_b64_tr_b16 a[196:197], v214 offset:40960
    ds_read_b64_tr_b16 a[198:199], v214 offset:43008
    v_mfma_f32_32x32x16_bf16 v[0:15], a[180:183], v[172:175], v[0:15]
    v_max3_f32 v222, v134, v135, v136
    v_max3_f32 v220, v220, v137, v138
    ds_read_b64_tr_b16 a[200:201], v215 offset:32768
    ds_read_b64_tr_b16 a[202:203], v215 offset:34816
    s_waitcnt lgkmcnt(6)
    v_mfma_f32_32x32x16_bf16 v[16:31], a[184:187], v[168:171], v[16:31]
    v_max3_f32 v221, v221, v139, v140
    v_max3_f32 v222, v222, v141, v142
    ds_read_b64_tr_b16 a[204:205], v215 offset:40960
    ds_read_b64_tr_b16 a[206:207], v215 offset:43008
    v_mfma_f32_32x32x16_bf16 v[16:31], a[188:191], v[172:175], v[16:31]
    v_max_f32 v220, v220, v143
    v_mov_b32 v229, 1.0
    ds_read_b64_tr_b16 a[176:177], v212 offset:33024
    ds_read_b64_tr_b16 a[178:179], v212 offset:35072
    s_waitcnt lgkmcnt(6)
    v_mfma_f32_32x32x16_bf16 v[32:47], a[192:195], v[168:171], v[32:47]
    v_max3_f32 v220, v220, v221, v222
    v_mov_b32 v221, v220
    s_nop 1
    v_permlane32_swap_b32 v220, v221
    v_max_f32 v220, v220, v221
    v_cmp_gt_f32 vcc, v220, v218
    s_mov_b32 s46, 0
    s_cbranch_vccz attn_kernel_skip16
    v_max_f32 v221, v216, v220
    v_sub_f32 v222, v216, v221
    v_mul_f32 v222, s30, v222
    v_exp_f32 v229, v222
    v_mov_b32 v216, v221
    v_mul_f32 v217, s30, v221
    v_add_f32 v218, s31, v221
    s_mov_b32 s46, 1
    s_nop 0
attn_kernel_skip16:
    ds_read_b64_tr_b16 a[180:181], v212 offset:41216
    ds_read_b64_tr_b16 a[182:183], v212 offset:43264
    v_mfma_f32_32x32x16_bf16 v[32:47], a[196:199], v[172:175], v[32:47]
    v_mfma_f32_32x32x16_bf16 v[176:191], v[192:195], v[168:171], v[176:191]
    v_fma_f32 v128, v128, s30, -v217
    v_fma_f32 v129, v129, s30, -v217
    ds_read_b64_tr_b16 a[184:185], v213 offset:33024
    ds_read_b64_tr_b16 a[186:187], v213 offset:35072
    s_waitcnt lgkmcnt(6)
    v_mfma_f32_32x32x16_bf16 v[48:63], a[200:203], v[168:171], v[48:63]
    v_fma_f32 v130, v130, s30, -v217
    v_exp_f32 v128, v128
    ds_read_b64_tr_b16 a[188:189], v213 offset:41216
    ds_read_b64_tr_b16 a[190:191], v213 offset:43264
    v_mfma_f32_32x32x16_bf16 v[48:63], a[204:207], v[172:175], v[48:63]
    v_fma_f32 v131, v131, s30, -v217
    ds_read_b64_tr_b16 a[192:193], v214 offset:33024
    ds_read_b64_tr_b16 a[194:195], v214 offset:35072
    s_waitcnt lgkmcnt(6)
    v_mfma_f32_32x32x16_bf16 v[64:79], a[176:179], v[168:171], v[64:79]
    v_exp_f32 v129, v129
    v_fma_f32 v132, v132, s30, -v217
    ds_read_b64_tr_b16 a[196:197], v214 offset:41216
    ds_read_b64_tr_b16 a[198:199], v214 offset:43264
    v_mfma_f32_32x32x16_bf16 v[64:79], a[180:183], v[172:175], v[64:79]
    v_exp_f32 v130, v130
    v_fma_f32 v133, v133, s30, -v217
    ds_read_b64_tr_b16 a[200:201], v215 offset:33024
    ds_read_b64_tr_b16 a[202:203], v215 offset:35072
    s_waitcnt lgkmcnt(6)
    v_mfma_f32_32x32x16_bf16 v[80:95], a[184:187], v[168:171], v[80:95]
    v_mfma_f32_32x32x16_bf16 v[176:191], v[192:195], v[172:175], v[176:191]
    v_cvt_pk_bf16_f32 v160, v128, v129
    v_exp_f32 v131, v131
    ds_read_b64_tr_b16 a[204:205], v215 offset:41216
    ds_read_b64_tr_b16 a[206:207], v215 offset:43264
    v_mfma_f32_32x32x16_bf16 v[80:95], a[188:191], v[172:175], v[80:95]
    v_fma_f32 v134, v134, s30, -v217
    v_exp_f32 v132, v132
    ds_read_b128 a[176:179], v232 offset:49152
    s_waitcnt lgkmcnt(5)
    v_mfma_f32_32x32x16_bf16 v[96:111], a[192:195], v[168:171], v[96:111]
    v_fma_f32 v135, v135, s30, -v217
    v_cvt_pk_bf16_f32 v161, v130, v131
    ds_read_b128 a[180:183], v233 offset:49152
    v_mfma_f32_32x32x16_bf16 v[96:111], a[196:199], v[172:175], v[96:111]
    v_exp_f32 v133, v133
    v_fma_f32 v136, v136, s30, -v217
    ds_read_b128 a[184:187], v234 offset:49152
    s_waitcnt lgkmcnt(3)
    v_mfma_f32_32x32x16_bf16 v[112:127], a[200:203], v[168:171], v[112:127]
    v_exp_f32 v134, v134
    v_fma_f32 v137, v137, s30, -v217
    ds_read_b128 a[188:191], v235 offset:49152
    v_mfma_f32_32x32x16_bf16 v[112:127], a[204:207], v[172:175], v[112:127]
    v_cvt_pk_bf16_f32 v162, v132, v133
    s_nop 10
    s_add_u32 s34, s34, 1
    s_cmp_lt_u32 s34, 6
    s_cbranch_scc1 attn_kernel_loop
    s_barrier
    ds_read_b128 a[192:195], v236 offset:49152
    s_waitcnt lgkmcnt(3)
    v_mfma_f32_32x32x16_bf16 v[144:159], a[176:179], a[0:3], 0
    v_exp_f32 v135, v135
    v_fma_f32 v138, v138, s30, -v217
    ds_read_b128 a[196:199], v237 offset:49152
    v_mfma_f32_32x32x16_bf16 v[144:159], a[180:183], a[4:7], v[144:159]
    v_exp_f32 v136, v136
    ds_read_b128 a[200:203], v238 offset:49152
    s_waitcnt lgkmcnt(3)
    v_mfma_f32_32x32x16_bf16 v[144:159], a[184:187], a[8:11], v[144:159]
    v_fma_f32 v139, v139, s30, -v217
    ds_read_b128 a[204:207], v239 offset:49152
    v_mfma_f32_32x32x16_bf16 v[144:159], a[188:191], a[12:15], v[144:159]
    v_cvt_pk_bf16_f32 v163, v134, v135
    ds_read_b128 a[176:179], v232 offset:49408
    s_waitcnt lgkmcnt(3)
    v_mfma_f32_32x32x16_bf16 v[144:159], a[192:195], a[16:19], v[144:159]
    v_exp_f32 v137, v137
    v_fma_f32 v140, v140, s30, -v217
    ds_read_b128 a[180:183], v233 offset:49408
    v_mfma_f32_32x32x16_bf16 v[144:159], a[196:199], a[20:23], v[144:159]
    v_exp_f32 v138, v138
    ds_read_b128 a[184:187], v234 offset:49408
    s_waitcnt lgkmcnt(3)
    v_mfma_f32_32x32x16_bf16 v[144:159], a[200:203], a[24:27], v[144:159]
    v_fma_f32 v141, v141, s30, -v217
    ds_read_b128 a[188:191], v235 offset:49408
    v_mfma_f32_32x32x16_bf16 v[144:159], a[204:207], a[28:31], v[144:159]
    v_cvt_pk_bf16_f32 v164, v136, v137
    ds_read_b128 a[192:195], v236 offset:49408
    s_waitcnt lgkmcnt(3)
    v_mfma_f32_32x32x16_bf16 v[144:159], a[176:179], a[32:35], v[144:159]
    v_exp_f32 v139, v139
    v_fma_f32 v142, v142, s30, -v217
    ds_read_b128 a[196:199], v237 offset:49408
    v_mfma_f32_32x32x16_bf16 v[144:159], a[180:183], a[36:39], v[144:159]
    v_exp_f32 v140, v140
    ds_read_b128 a[200:203], v238 offset:49408
    s_waitcnt lgkmcnt(3)
    v_mfma_f32_32x32x16_bf16 v[144:159], a[184:187], a[40:43], v[144:159]
    v_fma_f32 v143, v143, s30, -v217
    ds_read_b128 a[204:207], v239 offset:49408
    v_mfma_f32_32x32x16_bf16 v[144:159], a[188:191], a[44:47], v[144:159]
    v_cvt_pk_bf16_f32 v165, v138, v139
    ds_read_b64_tr_b16 a[176:177], v208
    ds_read_b64_tr_b16 a[178:179], v208 offset:2048
    s_waitcnt lgkmcnt(4)
    v_mfma_f32_32x32x16_bf16 v[144:159], a[192:195], a[48:51], v[144:159]
    v_exp_f32 v141, v141
    v_exp_f32 v142, v142
    ds_read_b64_tr_b16 a[180:181], v208 offset:8192
    ds_read_b64_tr_b16 a[182:183], v208 offset:10240
    v_mfma_f32_32x32x16_bf16 v[144:159], a[196:199], a[52:55], v[144:159]
    v_cvt_pk_bf16_f32 v166, v140, v141
    ds_read_b64_tr_b16 a[184:185], v209
    ds_read_b64_tr_b16 a[186:187], v209 offset:2048
    s_waitcnt lgkmcnt(6)
    v_mfma_f32_32x32x16_bf16 v[144:159], a[200:203], a[56:59], v[144:159]
    v_exp_f32 v143, v143
    ds_read_b64_tr_b16 a[188:189], v209 offset:8192
    ds_read_b64_tr_b16 a[190:191], v209 offset:10240
    v_mfma_f32_32x32x16_bf16 v[144:159], a[204:207], a[60:63], v[144:159]
    v_cvt_pk_bf16_f32 v167, v142, v143
    s_barrier
    s_cmp_eq_u32 s46, 0
    s_cbranch_scc1 attn_kernel_nors17
    v_mul_f32 v0, v0, v229
    v_mul_f32 v1, v1, v229
    v_mul_f32 v2, v2, v229
    v_mul_f32 v3, v3, v229
    v_mul_f32 v4, v4, v229
    v_mul_f32 v5, v5, v229
    v_mul_f32 v6, v6, v229
    v_mul_f32 v7, v7, v229
    v_mul_f32 v8, v8, v229
    v_mul_f32 v9, v9, v229
    v_mul_f32 v10, v10, v229
    v_mul_f32 v11, v11, v229
    v_mul_f32 v12, v12, v229
    v_mul_f32 v13, v13, v229
    v_mul_f32 v14, v14, v229
    v_mul_f32 v15, v15, v229
    v_mul_f32 v16, v16, v229
    v_mul_f32 v17, v17, v229
    v_mul_f32 v18, v18, v229
    v_mul_f32 v19, v19, v229
    v_mul_f32 v20, v20, v229
    v_mul_f32 v21, v21, v229
    v_mul_f32 v22, v22, v229
    v_mul_f32 v23, v23, v229
    v_mul_f32 v24, v24, v229
    v_mul_f32 v25, v25, v229
    v_mul_f32 v26, v26, v229
    v_mul_f32 v27, v27, v229
    v_mul_f32 v28, v28, v229
    v_mul_f32 v29, v29, v229
    v_mul_f32 v30, v30, v229
    v_mul_f32 v31, v31, v229
    v_mul_f32 v32, v32, v229
    v_mul_f32 v33, v33, v229
    v_mul_f32 v34, v34, v229
    v_mul_f32 v35, v35, v229
    v_mul_f32 v36, v36, v229
    v_mul_f32 v37, v37, v229
    v_mul_f32 v38, v38, v229
    v_mul_f32 v39, v39, v229
    v_mul_f32 v40, v40, v229
    v_mul_f32 v41, v41, v229
    v_mul_f32 v42, v42, v229
    v_mul_f32 v43, v43, v229
    v_mul_f32 v44, v44, v229
    v_mul_f32 v45, v45, v229
    v_mul_f32 v46, v46, v229
    v_mul_f32 v47, v47, v229
    v_mul_f32 v48, v48, v229
    v_mul_f32 v49, v49, v229
    v_mul_f32 v50, v50, v229
    v_mul_f32 v51, v51, v229
    v_mul_f32 v52, v52, v229
    v_mul_f32 v53, v53, v229
    v_mul_f32 v54, v54, v229
    v_mul_f32 v55, v55, v229
    v_mul_f32 v56, v56, v229
    v_mul_f32 v57, v57, v229
    v_mul_f32 v58, v58, v229
    v_mul_f32 v59, v59, v229
    v_mul_f32 v60, v60, v229
    v_mul_f32 v61, v61, v229
    v_mul_f32 v62, v62, v229
    v_mul_f32 v63, v63, v229
    v_mul_f32 v64, v64, v229
    v_mul_f32 v65, v65, v229
    v_mul_f32 v66, v66, v229
    v_mul_f32 v67, v67, v229
    v_mul_f32 v68, v68, v229
    v_mul_f32 v69, v69, v229
    v_mul_f32 v70, v70, v229
    v_mul_f32 v71, v71, v229
    v_mul_f32 v72, v72, v229
    v_mul_f32 v73, v73, v229
    v_mul_f32 v74, v74, v229
    v_mul_f32 v75, v75, v229
    v_mul_f32 v76, v76, v229
    v_mul_f32 v77, v77, v229
    v_mul_f32 v78, v78, v229
    v_mul_f32 v79, v79, v229
    v_mul_f32 v80, v80, v229
    v_mul_f32 v81, v81, v229
    v_mul_f32 v82, v82, v229
    v_mul_f32 v83, v83, v229
    v_mul_f32 v84, v84, v229
    v_mul_f32 v85, v85, v229
    v_mul_f32 v86, v86, v229
    v_mul_f32 v87, v87, v229
    v_mul_f32 v88, v88, v229
    v_mul_f32 v89, v89, v229
    v_mul_f32 v90, v90, v229
    v_mul_f32 v91, v91, v229
    v_mul_f32 v92, v92, v229
    v_mul_f32 v93, v93, v229
    v_mul_f32 v94, v94, v229
    v_mul_f32 v95, v95, v229
    v_mul_f32 v96, v96, v229
    v_mul_f32 v97, v97, v229
    v_mul_f32 v98, v98, v229
    v_mul_f32 v99, v99, v229
    v_mul_f32 v100, v100, v229
    v_mul_f32 v101, v101, v229
    v_mul_f32 v102, v102, v229
    v_mul_f32 v103, v103, v229
    v_mul_f32 v104, v104, v229
    v_mul_f32 v105, v105, v229
    v_mul_f32 v106, v106, v229
    v_mul_f32 v107, v107, v229
    v_mul_f32 v108, v108, v229
    v_mul_f32 v109, v109, v229
    v_mul_f32 v110, v110, v229
    v_mul_f32 v111, v111, v229
    v_mul_f32 v112, v112, v229
    v_mul_f32 v113, v113, v229
    v_mul_f32 v114, v114, v229
    v_mul_f32 v115, v115, v229
    v_mul_f32 v116, v116, v229
    v_mul_f32 v117, v117, v229
    v_mul_f32 v118, v118, v229
    v_mul_f32 v119, v119, v229
    v_mul_f32 v120, v120, v229
    v_mul_f32 v121, v121, v229
    v_mul_f32 v122, v122, v229
    v_mul_f32 v123, v123, v229
    v_mul_f32 v124, v124, v229
    v_mul_f32 v125, v125, v229
    v_mul_f32 v126, v126, v229
    v_mul_f32 v127, v127, v229
    v_mul_f32 v176, v176, v229
    s_nop 1
attn_kernel_nors17:
    ds_read_b64_tr_b16 a[192:193], v210
    ds_read_b64_tr_b16 a[194:195], v210 offset:2048
    s_waitcnt lgkmcnt(6)
    v_mfma_f32_32x32x16_bf16 v[0:15], a[176:179], v[160:163], v[0:15]
    s_nop 3
    v_max3_f32 v220, v144, v145, v146
    v_max3_f32 v221, v147, v148, v149
    ds_read_b64_tr_b16 a[196:197], v210 offset:8192
    ds_read_b64_tr_b16 a[198:199], v210 offset:10240
    v_mfma_f32_32x32x16_bf16 v[0:15], a[180:183], v[164:167], v[0:15]
    v_max3_f32 v222, v150, v151, v152
    v_max3_f32 v220, v220, v153, v154
    ds_read_b64_tr_b16 a[200:201], v211
    ds_read_b64_tr_b16 a[202:203], v211 offset:2048
    s_waitcnt lgkmcnt(6)
    v_mfma_f32_32x32x16_bf16 v[16:31], a[184:187], v[160:163], v[16:31]
    v_max3_f32 v221, v221, v155, v156
    v_max3_f32 v222, v222, v157, v158
    ds_read_b64_tr_b16 a[204:205], v211 offset:8192
    ds_read_b64_tr_b16 a[206:207], v211 offset:10240
    v_mfma_f32_32x32x16_bf16 v[16:31], a[188:191], v[164:167], v[16:31]
    v_max_f32 v220, v220, v159
    v_mov_b32 v229, 1.0
    ds_read_b64_tr_b16 a[176:177], v208 offset:256
    ds_read_b64_tr_b16 a[178:179], v208 offset:2304
    s_waitcnt lgkmcnt(6)
    v_mfma_f32_32x32x16_bf16 v[32:47], a[192:195], v[160:163], v[32:47]
    v_max3_f32 v220, v220, v221, v222
    v_mov_b32 v221, v220
    s_nop 1
    v_permlane32_swap_b32 v220, v221
    v_max_f32 v220, v220, v221
    v_cmp_gt_f32 vcc, v220, v218
    s_mov_b32 s46, 0
    s_cbranch_vccz attn_kernel_skip18
    v_max_f32 v221, v216, v220
    v_sub_f32 v222, v216, v221
    v_mul_f32 v222, s30, v222
    v_exp_f32 v229, v222
    v_mov_b32 v216, v221
    v_mul_f32 v217, s30, v221
    v_add_f32 v218, s31, v221
    s_mov_b32 s46, 1
    s_nop 0
attn_kernel_skip18:
    ds_read_b64_tr_b16 a[180:181], v208 offset:8448
    ds_read_b64_tr_b16 a[182:183], v208 offset:10496
    v_mfma_f32_32x32x16_bf16 v[32:47], a[196:199], v[164:167], v[32:47]
    v_mfma_f32_32x32x16_bf16 v[176:191], v[192:195], v[160:163], v[176:191]
    v_fma_f32 v144, v144, s30, -v217
    v_fma_f32 v145, v145, s30, -v217
    ds_read_b64_tr_b16 a[184:185], v209 offset:256
    ds_read_b64_tr_b16 a[186:187], v209 offset:2304
    s_waitcnt lgkmcnt(6)
    v_mfma_f32_32x32x16_bf16 v[48:63], a[200:203], v[160:163], v[48:63]
    v_fma_f32 v146, v146, s30, -v217
    v_exp_f32 v144, v144
    ds_read_b64_tr_b16 a[188:189], v209 offset:8448
    ds_read_b64_tr_b16 a[190:191], v209 offset:10496
    v_mfma_f32_32x32x16_bf16 v[48:63], a[204:207], v[164:167], v[48:63]
    v_fma_f32 v147, v147, s30, -v217
    ds_read_b64_tr_b16 a[192:193], v210 offset:256
    ds_read_b64_tr_b16 a[194:195], v210 offset:2304
    s_waitcnt lgkmcnt(6)
    v_mfma_f32_32x32x16_bf16 v[64:79], a[176:179], v[160:163], v[64:79]
    v_exp_f32 v145, v145
    v_fma_f32 v148, v148, s30, -v217
    ds_read_b64_tr_b16 a[196:197], v210 offset:8448
    ds_read_b64_tr_b16 a[198:199], v210 offset:10496
    v_mfma_f32_32x32x16_bf16 v[64:79], a[180:183], v[164:167], v[64:79]
    v_exp_f32 v146, v146
    v_fma_f32 v149, v149, s30, -v217
    ds_read_b64_tr_b16 a[200:201], v211 offset:256
    ds_read_b64_tr_b16 a[202:203], v211 offset:2304
    s_waitcnt lgkmcnt(6)
    v_mfma_f32_32x32x16_bf16 v[80:95], a[184:187], v[160:163], v[80:95]
    v_mfma_f32_32x32x16_bf16 v[176:191], v[192:195], v[164:167], v[176:191]
    v_cvt_pk_bf16_f32 v168, v144, v145
    v_exp_f32 v147, v147
    ds_read_b64_tr_b16 a[204:205], v211 offset:8448
    ds_read_b64_tr_b16 a[206:207], v211 offset:10496
    v_mfma_f32_32x32x16_bf16 v[80:95], a[188:191], v[164:167], v[80:95]
    v_fma_f32 v150, v150, s30, -v217
    v_exp_f32 v148, v148
    ds_read_b128 a[176:179], v200 offset:16384
    s_waitcnt lgkmcnt(5)
    v_mfma_f32_32x32x16_bf16 v[96:111], a[192:195], v[160:163], v[96:111]
    v_fma_f32 v151, v151, s30, -v217
    v_cvt_pk_bf16_f32 v169, v146, v147
    ds_read_b128 a[180:183], v201 offset:16384
    v_mfma_f32_32x32x16_bf16 v[96:111], a[196:199], v[164:167], v[96:111]
    v_exp_f32 v149, v149
    v_fma_f32 v152, v152, s30, -v217
    ds_read_b128 a[184:187], v202 offset:16384
    s_waitcnt lgkmcnt(3)
    v_mfma_f32_32x32x16_bf16 v[112:127], a[200:203], v[160:163], v[112:127]
    v_exp_f32 v150, v150
    v_fma_f32 v153, v153, s30, -v217
    ds_read_b128 a[188:191], v203 offset:16384
    v_mfma_f32_32x32x16_bf16 v[112:127], a[204:207], v[164:167], v[112:127]
    v_cvt_pk_bf16_f32 v170, v148, v149
    s_barrier
    ds_read_b128 a[192:195], v204 offset:16384
    s_waitcnt lgkmcnt(3)
    v_mfma_f32_32x32x16_bf16 v[128:143], a[176:179], a[0:3], 0
    v_exp_f32 v151, v151
    v_fma_f32 v154, v154, s30, -v217
    ds_read_b128 a[196:199], v205 offset:16384
    v_mfma_f32_32x32x16_bf16 v[128:143], a[180:183], a[4:7], v[128:143]
    v_exp_f32 v152, v152
    ds_read_b128 a[200:203], v206 offset:16384
    s_waitcnt lgkmcnt(3)
    v_mfma_f32_32x32x16_bf16 v[128:143], a[184:187], a[8:11], v[128:143]
    v_fma_f32 v155, v155, s30, -v217
    ds_read_b128 a[204:207], v207 offset:16384
    v_mfma_f32_32x32x16_bf16 v[128:143], a[188:191], a[12:15], v[128:143]
    v_cvt_pk_bf16_f32 v171, v150, v151
    ds_read_b128 a[176:179], v200 offset:16640
    s_waitcnt lgkmcnt(3)
    v_mfma_f32_32x32x16_bf16 v[128:143], a[192:195], a[16:19], v[128:143]
    v_exp_f32 v153, v153
    v_fma_f32 v156, v156, s30, -v217
    ds_read_b128 a[180:183], v201 offset:16640
    v_mfma_f32_32x32x16_bf16 v[128:143], a[196:199], a[20:23], v[128:143]
    v_exp_f32 v154, v154
    ds_read_b128 a[184:187], v202 offset:16640
    s_waitcnt lgkmcnt(3)
    v_mfma_f32_32x32x16_bf16 v[128:143], a[200:203], a[24:27], v[128:143]
    v_fma_f32 v157, v157, s30, -v217
    ds_read_b128 a[188:191], v203 offset:16640
    v_mfma_f32_32x32x16_bf16 v[128:143], a[204:207], a[28:31], v[128:143]
    v_cvt_pk_bf16_f32 v172, v152, v153
    ds_read_b128 a[192:195], v204 offset:16640
    s_waitcnt lgkmcnt(3)
    v_mfma_f32_32x32x16_bf16 v[128:143], a[176:179], a[32:35], v[128:143]
    v_exp_f32 v155, v155
    v_fma_f32 v158, v158, s30, -v217
    ds_read_b128 a[196:199], v205 offset:16640
    v_mfma_f32_32x32x16_bf16 v[128:143], a[180:183], a[36:39], v[128:143]
    v_exp_f32 v156, v156
    ds_read_b128 a[200:203], v206 offset:16640
    s_waitcnt lgkmcnt(3)
    v_mfma_f32_32x32x16_bf16 v[128:143], a[184:187], a[40:43], v[128:143]
    v_fma_f32 v159, v159, s30, -v217
    ds_read_b128 a[204:207], v207 offset:16640
    v_mfma_f32_32x32x16_bf16 v[128:143], a[188:191], a[44:47], v[128:143]
    v_cvt_pk_bf16_f32 v173, v154, v155
    ds_read_b64_tr_b16 a[176:177], v208 offset:32768
    ds_read_b64_tr_b16 a[178:179], v208 offset:34816
    s_waitcnt lgkmcnt(4)
    v_mfma_f32_32x32x16_bf16 v[128:143], a[192:195], a[48:51], v[128:143]
    v_exp_f32 v157, v157
    v_exp_f32 v158, v158
    ds_read_b64_tr_b16 a[180:181], v208 offset:40960
    ds_read_b64_tr_b16 a[182:183], v208 offset:43008
    v_mfma_f32_32x32x16_bf16 v[128:143], a[196:199], a[52:55], v[128:143]
    v_cvt_pk_bf16_f32 v174, v156, v157
    ds_read_b64_tr_b16 a[184:185], v209 offset:32768
    ds_read_b64_tr_b16 a[186:187], v209 offset:34816
    s_waitcnt lgkmcnt(6)
    v_mfma_f32_32x32x16_bf16 v[128:143], a[200:203], a[56:59], v[128:143]
    v_exp_f32 v159, v159
    ds_read_b64_tr_b16 a[188:189], v209 offset:40960
    ds_read_b64_tr_b16 a[190:191], v209 offset:43008
    v_mfma_f32_32x32x16_bf16 v[128:143], a[204:207], a[60:63], v[128:143]
    v_cvt_pk_bf16_f32 v175, v158, v159
    s_barrier
    s_cmp_eq_u32 s46, 0
    s_cbranch_scc1 attn_kernel_nors19
    v_mul_f32 v0, v0, v229
    v_mul_f32 v1, v1, v229
    v_mul_f32 v2, v2, v229
    v_mul_f32 v3, v3, v229
    v_mul_f32 v4, v4, v229
    v_mul_f32 v5, v5, v229
    v_mul_f32 v6, v6, v229
    v_mul_f32 v7, v7, v229
    v_mul_f32 v8, v8, v229
    v_mul_f32 v9, v9, v229
    v_mul_f32 v10, v10, v229
    v_mul_f32 v11, v11, v229
    v_mul_f32 v12, v12, v229
    v_mul_f32 v13, v13, v229
    v_mul_f32 v14, v14, v229
    v_mul_f32 v15, v15, v229
    v_mul_f32 v16, v16, v229
    v_mul_f32 v17, v17, v229
    v_mul_f32 v18, v18, v229
    v_mul_f32 v19, v19, v229
    v_mul_f32 v20, v20, v229
    v_mul_f32 v21, v21, v229
    v_mul_f32 v22, v22, v229
    v_mul_f32 v23, v23, v229
    v_mul_f32 v24, v24, v229
    v_mul_f32 v25, v25, v229
    v_mul_f32 v26, v26, v229
    v_mul_f32 v27, v27, v229
    v_mul_f32 v28, v28, v229
    v_mul_f32 v29, v29, v229
    v_mul_f32 v30, v30, v229
    v_mul_f32 v31, v31, v229
    v_mul_f32 v32, v32, v229
    v_mul_f32 v33, v33, v229
    v_mul_f32 v34, v34, v229
    v_mul_f32 v35, v35, v229
    v_mul_f32 v36, v36, v229
    v_mul_f32 v37, v37, v229
    v_mul_f32 v38, v38, v229
    v_mul_f32 v39, v39, v229
    v_mul_f32 v40, v40, v229
    v_mul_f32 v41, v41, v229
    v_mul_f32 v42, v42, v229
    v_mul_f32 v43, v43, v229
    v_mul_f32 v44, v44, v229
    v_mul_f32 v45, v45, v229
    v_mul_f32 v46, v46, v229
    v_mul_f32 v47, v47, v229
    v_mul_f32 v48, v48, v229
    v_mul_f32 v49, v49, v229
    v_mul_f32 v50, v50, v229
    v_mul_f32 v51, v51, v229
    v_mul_f32 v52, v52, v229
    v_mul_f32 v53, v53, v229
    v_mul_f32 v54, v54, v229
    v_mul_f32 v55, v55, v229
    v_mul_f32 v56, v56, v229
    v_mul_f32 v57, v57, v229
    v_mul_f32 v58, v58, v229
    v_mul_f32 v59, v59, v229
    v_mul_f32 v60, v60, v229
    v_mul_f32 v61, v61, v229
    v_mul_f32 v62, v62, v229
    v_mul_f32 v63, v63, v229
    v_mul_f32 v64, v64, v229
    v_mul_f32 v65, v65, v229
    v_mul_f32 v66, v66, v229
    v_mul_f32 v67, v67, v229
    v_mul_f32 v68, v68, v229
    v_mul_f32 v69, v69, v229
    v_mul_f32 v70, v70, v229
    v_mul_f32 v71, v71, v229
    v_mul_f32 v72, v72, v229
    v_mul_f32 v73, v73, v229
    v_mul_f32 v74, v74, v229
    v_mul_f32 v75, v75, v229
    v_mul_f32 v76, v76, v229
    v_mul_f32 v77, v77, v229
    v_mul_f32 v78, v78, v229
    v_mul_f32 v79, v79, v229
    v_mul_f32 v80, v80, v229
    v_mul_f32 v81, v81, v229
    v_mul_f32 v82, v82, v229
    v_mul_f32 v83, v83, v229
    v_mul_f32 v84, v84, v229
    v_mul_f32 v85, v85, v229
    v_mul_f32 v86, v86, v229
    v_mul_f32 v87, v87, v229
    v_mul_f32 v88, v88, v229
    v_mul_f32 v89, v89, v229
    v_mul_f32 v90, v90, v229
    v_mul_f32 v91, v91, v229
    v_mul_f32 v92, v92, v229
    v_mul_f32 v93, v93, v229
    v_mul_f32 v94, v94, v229
    v_mul_f32 v95, v95, v229
    v_mul_f32 v96, v96, v229
    v_mul_f32 v97, v97, v229
    v_mul_f32 v98, v98, v229
    v_mul_f32 v99, v99, v229
    v_mul_f32 v100, v100, v229
    v_mul_f32 v101, v101, v229
    v_mul_f32 v102, v102, v229
    v_mul_f32 v103, v103, v229
    v_mul_f32 v104, v104, v229
    v_mul_f32 v105, v105, v229
    v_mul_f32 v106, v106, v229
    v_mul_f32 v107, v107, v229
    v_mul_f32 v108, v108, v229
    v_mul_f32 v109, v109, v229
    v_mul_f32 v110, v110, v229
    v_mul_f32 v111, v111, v229
    v_mul_f32 v112, v112, v229
    v_mul_f32 v113, v113, v229
    v_mul_f32 v114, v114, v229
    v_mul_f32 v115, v115, v229
    v_mul_f32 v116, v116, v229
    v_mul_f32 v117, v117, v229
    v_mul_f32 v118, v118, v229
    v_mul_f32 v119, v119, v229
    v_mul_f32 v120, v120, v229
    v_mul_f32 v121, v121, v229
    v_mul_f32 v122, v122, v229
    v_mul_f32 v123, v123, v229
    v_mul_f32 v124, v124, v229
    v_mul_f32 v125, v125, v229
    v_mul_f32 v126, v126, v229
    v_mul_f32 v127, v127, v229
    v_mul_f32 v176, v176, v229
    s_nop 1
attn_kernel_nors19:
    ds_read_b64_tr_b16 a[192:193], v210 offset:32768
    ds_read_b64_tr_b16 a[194:195], v210 offset:34816
    s_waitcnt lgkmcnt(6)
    v_mfma_f32_32x32x16_bf16 v[0:15], a[176:179], v[168:171], v[0:15]
    s_nop 3
    v_max3_f32 v220, v128, v129, v130
    v_max3_f32 v221, v131, v132, v133
    ds_read_b64_tr_b16 a[196:197], v210 offset:40960
    ds_read_b64_tr_b16 a[198:199], v210 offset:43008
    v_mfma_f32_32x32x16_bf16 v[0:15], a[180:183], v[172:175], v[0:15]
    v_max3_f32 v222, v134, v135, v136
    v_max3_f32 v220, v220, v137, v138
    ds_read_b64_tr_b16 a[200:201], v211 offset:32768
    ds_read_b64_tr_b16 a[202:203], v211 offset:34816
    s_waitcnt lgkmcnt(6)
    v_mfma_f32_32x32x16_bf16 v[16:31], a[184:187], v[168:171], v[16:31]
    v_max3_f32 v221, v221, v139, v140
    v_max3_f32 v222, v222, v141, v142
    ds_read_b64_tr_b16 a[204:205], v211 offset:40960
    ds_read_b64_tr_b16 a[206:207], v211 offset:43008
    v_mfma_f32_32x32x16_bf16 v[16:31], a[188:191], v[172:175], v[16:31]
    v_max_f32 v220, v220, v143
    v_mov_b32 v229, 1.0
    ds_read_b64_tr_b16 a[176:177], v208 offset:33024
    ds_read_b64_tr_b16 a[178:179], v208 offset:35072
    s_waitcnt lgkmcnt(6)
    v_mfma_f32_32x32x16_bf16 v[32:47], a[192:195], v[168:171], v[32:47]
    v_max3_f32 v220, v220, v221, v222
    v_mov_b32 v221, v220
    s_nop 1
    v_permlane32_swap_b32 v220, v221
    v_max_f32 v220, v220, v221
    v_cmp_gt_f32 vcc, v220, v218
    s_mov_b32 s46, 0
    s_cbranch_vccz attn_kernel_skip20
    v_max_f32 v221, v216, v220
    v_sub_f32 v222, v216, v221
    v_mul_f32 v222, s30, v222
    v_exp_f32 v229, v222
    v_mov_b32 v216, v221
    v_mul_f32 v217, s30, v221
    v_add_f32 v218, s31, v221
    s_mov_b32 s46, 1
    s_nop 0
attn_kernel_skip20:
    ds_read_b64_tr_b16 a[180:181], v208 offset:41216
    ds_read_b64_tr_b16 a[182:183], v208 offset:43264
    v_mfma_f32_32x32x16_bf16 v[32:47], a[196:199], v[172:175], v[32:47]
    v_mfma_f32_32x32x16_bf16 v[176:191], v[192:195], v[168:171], v[176:191]
    v_fma_f32 v128, v128, s30, -v217
    v_fma_f32 v129, v129, s30, -v217
    ds_read_b64_tr_b16 a[184:185], v209 offset:33024
    ds_read_b64_tr_b16 a[186:187], v209 offset:35072
    s_waitcnt lgkmcnt(6)
    v_mfma_f32_32x32x16_bf16 v[48:63], a[200:203], v[168:171], v[48:63]
    v_fma_f32 v130, v130, s30, -v217
    v_exp_f32 v128, v128
    ds_read_b64_tr_b16 a[188:189], v209 offset:41216
    ds_read_b64_tr_b16 a[190:191], v209 offset:43264
    v_mfma_f32_32x32x16_bf16 v[48:63], a[204:207], v[172:175], v[48:63]
    v_fma_f32 v131, v131, s30, -v217
    ds_read_b64_tr_b16 a[192:193], v210 offset:33024
    ds_read_b64_tr_b16 a[194:195], v210 offset:35072
    s_waitcnt lgkmcnt(6)
    v_mfma_f32_32x32x16_bf16 v[64:79], a[176:179], v[168:171], v[64:79]
    v_exp_f32 v129, v129
    v_fma_f32 v132, v132, s30, -v217
    ds_read_b64_tr_b16 a[196:197], v210 offset:41216
    ds_read_b64_tr_b16 a[198:199], v210 offset:43264
    v_mfma_f32_32x32x16_bf16 v[64:79], a[180:183], v[172:175], v[64:79]
    v_exp_f32 v130, v130
    v_fma_f32 v133, v133, s30, -v217
    ds_read_b64_tr_b16 a[200:201], v211 offset:33024
    ds_read_b64_tr_b16 a[202:203], v211 offset:35072
    s_waitcnt lgkmcnt(6)
    v_mfma_f32_32x32x16_bf16 v[80:95], a[184:187], v[168:171], v[80:95]
    v_mfma_f32_32x32x16_bf16 v[176:191], v[192:195], v[172:175], v[176:191]
    v_cvt_pk_bf16_f32 v160, v128, v129
    v_exp_f32 v131, v131
    ds_read_b64_tr_b16 a[204:205], v211 offset:41216
    ds_read_b64_tr_b16 a[206:207], v211 offset:43264
    v_mfma_f32_32x32x16_bf16 v[80:95], a[188:191], v[172:175], v[80:95]
    v_fma_f32 v134, v134, s30, -v217
    v_exp_f32 v132, v132
    ds_read_b128 a[176:179], v200 offset:49152
    s_waitcnt lgkmcnt(5)
    v_mfma_f32_32x32x16_bf16 v[96:111], a[192:195], v[168:171], v[96:111]
    v_fma_f32 v135, v135, s30, -v217
    v_cvt_pk_bf16_f32 v161, v130, v131
    ds_read_b128 a[180:183], v201 offset:49152
    v_mfma_f32_32x32x16_bf16 v[96:111], a[196:199], v[172:175], v[96:111]
    v_exp_f32 v133, v133
    v_fma_f32 v136, v136, s30, -v217
    ds_read_b128 a[184:187], v202 offset:49152
    s_waitcnt lgkmcnt(3)
    v_mfma_f32_32x32x16_bf16 v[112:127], a[200:203], v[168:171], v[112:127]
    v_exp_f32 v134, v134
    v_fma_f32 v137, v137, s30, -v217
    ds_read_b128 a[188:191], v203 offset:49152
    v_mfma_f32_32x32x16_bf16 v[112:127], a[204:207], v[172:175], v[112:127]
    v_cvt_pk_bf16_f32 v162, v132, v133
    s_barrier
    ds_read_b128 a[192:195], v204 offset:49152
    s_waitcnt lgkmcnt(3)
    v_mfma_f32_32x32x16_bf16 v[144:159], a[176:179], a[0:3], 0
    v_exp_f32 v135, v135
    v_fma_f32 v138, v138, s30, -v217
    ds_read_b128 a[196:199], v205 offset:49152
    v_mfma_f32_32x32x16_bf16 v[144:159], a[180:183], a[4:7], v[144:159]
    v_exp_f32 v136, v136
    ds_read_b128 a[200:203], v206 offset:49152
    s_waitcnt lgkmcnt(3)
    v_mfma_f32_32x32x16_bf16 v[144:159], a[184:187], a[8:11], v[144:159]
    v_fma_f32 v139, v139, s30, -v217
    ds_read_b128 a[204:207], v207 offset:49152
    v_mfma_f32_32x32x16_bf16 v[144:159], a[188:191], a[12:15], v[144:159]
    v_cvt_pk_bf16_f32 v163, v134, v135
    ds_read_b128 a[176:179], v200 offset:49408
    s_waitcnt lgkmcnt(3)
    v_mfma_f32_32x32x16_bf16 v[144:159], a[192:195], a[16:19], v[144:159]
    v_exp_f32 v137, v137
    v_fma_f32 v140, v140, s30, -v217
    ds_read_b128 a[180:183], v201 offset:49408
    v_mfma_f32_32x32x16_bf16 v[144:159], a[196:199], a[20:23], v[144:159]
    v_exp_f32 v138, v138
    ds_read_b128 a[184:187], v202 offset:49408
    s_waitcnt lgkmcnt(3)
    v_mfma_f32_32x32x16_bf16 v[144:159], a[200:203], a[24:27], v[144:159]
    v_fma_f32 v141, v141, s30, -v217
    ds_read_b128 a[188:191], v203 offset:49408
    v_mfma_f32_32x32x16_bf16 v[144:159], a[204:207], a[28:31], v[144:159]
    v_cvt_pk_bf16_f32 v164, v136, v137
    ds_read_b128 a[192:195], v204 offset:49408
    s_waitcnt lgkmcnt(3)
    v_mfma_f32_32x32x16_bf16 v[144:159], a[176:179], a[32:35], v[144:159]
    v_exp_f32 v139, v139
    v_fma_f32 v142, v142, s30, -v217
    ds_read_b128 a[196:199], v205 offset:49408
    v_mfma_f32_32x32x16_bf16 v[144:159], a[180:183], a[36:39], v[144:159]
    v_exp_f32 v140, v140
    ds_read_b128 a[200:203], v206 offset:49408
    s_waitcnt lgkmcnt(3)
    v_mfma_f32_32x32x16_bf16 v[144:159], a[184:187], a[40:43], v[144:159]
    v_fma_f32 v143, v143, s30, -v217
    ds_read_b128 a[204:207], v207 offset:49408
    v_mfma_f32_32x32x16_bf16 v[144:159], a[188:191], a[44:47], v[144:159]
    v_cvt_pk_bf16_f32 v165, v138, v139
    ds_read_b64_tr_b16 a[176:177], v212
    ds_read_b64_tr_b16 a[178:179], v212 offset:2048
    s_waitcnt lgkmcnt(4)
    v_mfma_f32_32x32x16_bf16 v[144:159], a[192:195], a[48:51], v[144:159]
    v_exp_f32 v141, v141
    v_exp_f32 v142, v142
    ds_read_b64_tr_b16 a[180:181], v212 offset:8192
    ds_read_b64_tr_b16 a[182:183], v212 offset:10240
    v_mfma_f32_32x32x16_bf16 v[144:159], a[196:199], a[52:55], v[144:159]
    v_cvt_pk_bf16_f32 v166, v140, v141
    ds_read_b64_tr_b16 a[184:185], v213
    ds_read_b64_tr_b16 a[186:187], v213 offset:2048
    s_waitcnt lgkmcnt(6)
    v_mfma_f32_32x32x16_bf16 v[144:159], a[200:203], a[56:59], v[144:159]
    v_exp_f32 v143, v143
    ds_read_b64_tr_b16 a[188:189], v213 offset:8192
    ds_read_b64_tr_b16 a[190:191], v213 offset:10240
    v_mfma_f32_32x32x16_bf16 v[144:159], a[204:207], a[60:63], v[144:159]
    v_cvt_pk_bf16_f32 v167, v142, v143
    s_barrier
    s_cmp_eq_u32 s46, 0
    s_cbranch_scc1 attn_kernel_nors21
    v_mul_f32 v0, v0, v229
    v_mul_f32 v1, v1, v229
    v_mul_f32 v2, v2, v229
    v_mul_f32 v3, v3, v229
    v_mul_f32 v4, v4, v229
    v_mul_f32 v5, v5, v229
    v_mul_f32 v6, v6, v229
    v_mul_f32 v7, v7, v229
    v_mul_f32 v8, v8, v229
    v_mul_f32 v9, v9, v229
    v_mul_f32 v10, v10, v229
    v_mul_f32 v11, v11, v229
    v_mul_f32 v12, v12, v229
    v_mul_f32 v13, v13, v229
    v_mul_f32 v14, v14, v229
    v_mul_f32 v15, v15, v229
    v_mul_f32 v16, v16, v229
    v_mul_f32 v17, v17, v229
    v_mul_f32 v18, v18, v229
    v_mul_f32 v19, v19, v229
    v_mul_f32 v20, v20, v229
    v_mul_f32 v21, v21, v229
    v_mul_f32 v22, v22, v229
    v_mul_f32 v23, v23, v229
    v_mul_f32 v24, v24, v229
    v_mul_f32 v25, v25, v229
    v_mul_f32 v26, v26, v229
    v_mul_f32 v27, v27, v229
    v_mul_f32 v28, v28, v229
    v_mul_f32 v29, v29, v229
    v_mul_f32 v30, v30, v229
    v_mul_f32 v31, v31, v229
    v_mul_f32 v32, v32, v229
    v_mul_f32 v33, v33, v229
    v_mul_f32 v34, v34, v229
    v_mul_f32 v35, v35, v229
    v_mul_f32 v36, v36, v229
    v_mul_f32 v37, v37, v229
    v_mul_f32 v38, v38, v229
    v_mul_f32 v39, v39, v229
    v_mul_f32 v40, v40, v229
    v_mul_f32 v41, v41, v229
    v_mul_f32 v42, v42, v229
    v_mul_f32 v43, v43, v229
    v_mul_f32 v44, v44, v229
    v_mul_f32 v45, v45, v229
    v_mul_f32 v46, v46, v229
    v_mul_f32 v47, v47, v229
    v_mul_f32 v48, v48, v229
    v_mul_f32 v49, v49, v229
    v_mul_f32 v50, v50, v229
    v_mul_f32 v51, v51, v229
    v_mul_f32 v52, v52, v229
    v_mul_f32 v53, v53, v229
    v_mul_f32 v54, v54, v229
    v_mul_f32 v55, v55, v229
    v_mul_f32 v56, v56, v229
    v_mul_f32 v57, v57, v229
    v_mul_f32 v58, v58, v229
    v_mul_f32 v59, v59, v229
    v_mul_f32 v60, v60, v229
    v_mul_f32 v61, v61, v229
    v_mul_f32 v62, v62, v229
    v_mul_f32 v63, v63, v229
    v_mul_f32 v64, v64, v229
    v_mul_f32 v65, v65, v229
    v_mul_f32 v66, v66, v229
    v_mul_f32 v67, v67, v229
    v_mul_f32 v68, v68, v229
    v_mul_f32 v69, v69, v229
    v_mul_f32 v70, v70, v229
    v_mul_f32 v71, v71, v229
    v_mul_f32 v72, v72, v229
    v_mul_f32 v73, v73, v229
    v_mul_f32 v74, v74, v229
    v_mul_f32 v75, v75, v229
    v_mul_f32 v76, v76, v229
    v_mul_f32 v77, v77, v229
    v_mul_f32 v78, v78, v229
    v_mul_f32 v79, v79, v229
    v_mul_f32 v80, v80, v229
    v_mul_f32 v81, v81, v229
    v_mul_f32 v82, v82, v229
    v_mul_f32 v83, v83, v229
    v_mul_f32 v84, v84, v229
    v_mul_f32 v85, v85, v229
    v_mul_f32 v86, v86, v229
    v_mul_f32 v87, v87, v229
    v_mul_f32 v88, v88, v229
    v_mul_f32 v89, v89, v229
    v_mul_f32 v90, v90, v229
    v_mul_f32 v91, v91, v229
    v_mul_f32 v92, v92, v229
    v_mul_f32 v93, v93, v229
    v_mul_f32 v94, v94, v229
    v_mul_f32 v95, v95, v229
    v_mul_f32 v96, v96, v229
    v_mul_f32 v97, v97, v229
    v_mul_f32 v98, v98, v229
    v_mul_f32 v99, v99, v229
    v_mul_f32 v100, v100, v229
    v_mul_f32 v101, v101, v229
    v_mul_f32 v102, v102, v229
    v_mul_f32 v103, v103, v229
    v_mul_f32 v104, v104, v229
    v_mul_f32 v105, v105, v229
    v_mul_f32 v106, v106, v229
    v_mul_f32 v107, v107, v229
    v_mul_f32 v108, v108, v229
    v_mul_f32 v109, v109, v229
    v_mul_f32 v110, v110, v229
    v_mul_f32 v111, v111, v229
    v_mul_f32 v112, v112, v229
    v_mul_f32 v113, v113, v229
    v_mul_f32 v114, v114, v229
    v_mul_f32 v115, v115, v229
    v_mul_f32 v116, v116, v229
    v_mul_f32 v117, v117, v229
    v_mul_f32 v118, v118, v229
    v_mul_f32 v119, v119, v229
    v_mul_f32 v120, v120, v229
    v_mul_f32 v121, v121, v229
    v_mul_f32 v122, v122, v229
    v_mul_f32 v123, v123, v229
    v_mul_f32 v124, v124, v229
    v_mul_f32 v125, v125, v229
    v_mul_f32 v126, v126, v229
    v_mul_f32 v127, v127, v229
    v_mul_f32 v176, v176, v229
    s_nop 1
attn_kernel_nors21:
    ds_read_b64_tr_b16 a[192:193], v214
    ds_read_b64_tr_b16 a[194:195], v214 offset:2048
    s_waitcnt lgkmcnt(6)
    v_mfma_f32_32x32x16_bf16 v[0:15], a[176:179], v[160:163], v[0:15]
    s_nop 3
    v_max3_f32 v220, v144, v145, v146
    v_max3_f32 v221, v147, v148, v149
    ds_read_b64_tr_b16 a[196:197], v214 offset:8192
    ds_read_b64_tr_b16 a[198:199], v214 offset:10240
    v_mfma_f32_32x32x16_bf16 v[0:15], a[180:183], v[164:167], v[0:15]
    v_max3_f32 v222, v150, v151, v152
    v_max3_f32 v220, v220, v153, v154
    ds_read_b64_tr_b16 a[200:201], v215
    ds_read_b64_tr_b16 a[202:203], v215 offset:2048
    s_waitcnt lgkmcnt(6)
    v_mfma_f32_32x32x16_bf16 v[16:31], a[184:187], v[160:163], v[16:31]
    v_max3_f32 v221, v221, v155, v156
    v_max3_f32 v222, v222, v157, v158
    ds_read_b64_tr_b16 a[204:205], v215 offset:8192
    ds_read_b64_tr_b16 a[206:207], v215 offset:10240
    v_mfma_f32_32x32x16_bf16 v[16:31], a[188:191], v[164:167], v[16:31]
    v_max_f32 v220, v220, v159
    v_mov_b32 v229, 1.0
    ds_read_b64_tr_b16 a[176:177], v212 offset:256
    ds_read_b64_tr_b16 a[178:179], v212 offset:2304
    s_waitcnt lgkmcnt(6)
    v_mfma_f32_32x32x16_bf16 v[32:47], a[192:195], v[160:163], v[32:47]
    v_max3_f32 v220, v220, v221, v222
    v_mov_b32 v221, v220
    s_nop 1
    v_permlane32_swap_b32 v220, v221
    v_max_f32 v220, v220, v221
    v_cmp_gt_f32 vcc, v220, v218
    s_mov_b32 s46, 0
    s_cbranch_vccz attn_kernel_skip22
    v_max_f32 v221, v216, v220
    v_sub_f32 v222, v216, v221
    v_mul_f32 v222, s30, v222
    v_exp_f32 v229, v222
    v_mov_b32 v216, v221
    v_mul_f32 v217, s30, v221
    v_add_f32 v218, s31, v221
    s_mov_b32 s46, 1
    s_nop 0
attn_kernel_skip22:
    ds_read_b64_tr_b16 a[180:181], v212 offset:8448
    ds_read_b64_tr_b16 a[182:183], v212 offset:10496
    v_mfma_f32_32x32x16_bf16 v[32:47], a[196:199], v[164:167], v[32:47]
    v_mfma_f32_32x32x16_bf16 v[176:191], v[192:195], v[160:163], v[176:191]
    v_fma_f32 v144, v144, s30, -v217
    v_fma_f32 v145, v145, s30, -v217
    ds_read_b64_tr_b16 a[184:185], v213 offset:256
    ds_read_b64_tr_b16 a[186:187], v213 offset:2304
    s_waitcnt lgkmcnt(6)
    v_mfma_f32_32x32x16_bf16 v[48:63], a[200:203], v[160:163], v[48:63]
    v_fma_f32 v146, v146, s30, -v217
    v_exp_f32 v144, v144
    ds_read_b64_tr_b16 a[188:189], v213 offset:8448
    ds_read_b64_tr_b16 a[190:191], v213 offset:10496
    v_mfma_f32_32x32x16_bf16 v[48:63], a[204:207], v[164:167], v[48:63]
    v_fma_f32 v147, v147, s30, -v217
    ds_read_b64_tr_b16 a[192:193], v214 offset:256
    ds_read_b64_tr_b16 a[194:195], v214 offset:2304
    s_waitcnt lgkmcnt(6)
    v_mfma_f32_32x32x16_bf16 v[64:79], a[176:179], v[160:163], v[64:79]
    v_exp_f32 v145, v145
    v_fma_f32 v148, v148, s30, -v217
    ds_read_b64_tr_b16 a[196:197], v214 offset:8448
    ds_read_b64_tr_b16 a[198:199], v214 offset:10496
    v_mfma_f32_32x32x16_bf16 v[64:79], a[180:183], v[164:167], v[64:79]
    v_exp_f32 v146, v146
    v_fma_f32 v149, v149, s30, -v217
    ds_read_b64_tr_b16 a[200:201], v215 offset:256
    ds_read_b64_tr_b16 a[202:203], v215 offset:2304
    s_waitcnt lgkmcnt(6)
    v_mfma_f32_32x32x16_bf16 v[80:95], a[184:187], v[160:163], v[80:95]
    v_mfma_f32_32x32x16_bf16 v[176:191], v[192:195], v[164:167], v[176:191]
    v_cvt_pk_bf16_f32 v168, v144, v145
    v_exp_f32 v147, v147
    ds_read_b64_tr_b16 a[204:205], v215 offset:8448
    ds_read_b64_tr_b16 a[206:207], v215 offset:10496
    v_mfma_f32_32x32x16_bf16 v[80:95], a[188:191], v[164:167], v[80:95]
    v_fma_f32 v150, v150, s30, -v217
    v_exp_f32 v148, v148
    ds_read_b64_tr_b16 a[176:177], v212 offset:16384
    ds_read_b64_tr_b16 a[178:179], v212 offset:18432
    s_waitcnt lgkmcnt(6)
    v_mfma_f32_32x32x16_bf16 v[96:111], a[192:195], v[160:163], v[96:111]
    v_fma_f32 v151, v151, s30, -v217
    v_cvt_pk_bf16_f32 v169, v146, v147
    ds_read_b64_tr_b16 a[180:181], v212 offset:24576
    ds_read_b64_tr_b16 a[182:183], v212 offset:26624
    v_mfma_f32_32x32x16_bf16 v[96:111], a[196:199], v[164:167], v[96:111]
    v_exp_f32 v149, v149
    v_fma_f32 v152, v152, s30, -v217
    ds_read_b64_tr_b16 a[184:185], v213 offset:16384
    ds_read_b64_tr_b16 a[186:187], v213 offset:18432
    s_waitcnt lgkmcnt(6)
    v_mfma_f32_32x32x16_bf16 v[112:127], a[200:203], v[160:163], v[112:127]
    v_exp_f32 v150, v150
    v_fma_f32 v153, v153, s30, -v217
    ds_read_b64_tr_b16 a[188:189], v213 offset:24576
    ds_read_b64_tr_b16 a[190:191], v213 offset:26624
    v_mfma_f32_32x32x16_bf16 v[112:127], a[204:207], v[164:167], v[112:127]
    v_cvt_pk_bf16_f32 v170, v148, v149
    v_exp_f32 v151, v151
    v_fma_f32 v154, v154, s30, -v217
    v_exp_f32 v152, v152
    v_fma_f32 v155, v155, s30, -v217
    v_cvt_pk_bf16_f32 v171, v150, v151
    v_exp_f32 v153, v153
    v_fma_f32 v156, v156, s30, -v217
    v_exp_f32 v154, v154
    v_fma_f32 v157, v157, s30, -v217
    v_cvt_pk_bf16_f32 v172, v152, v153
    v_exp_f32 v155, v155
    v_fma_f32 v158, v158, s30, -v217
    v_exp_f32 v156, v156
    v_fma_f32 v159, v159, s30, -v217
    v_cvt_pk_bf16_f32 v173, v154, v155
    v_exp_f32 v157, v157
    v_exp_f32 v158, v158
    v_cvt_pk_bf16_f32 v174, v156, v157
    v_exp_f32 v159, v159
    s_nop 0
    v_cvt_pk_bf16_f32 v175, v158, v159
    s_barrier
    s_cmp_eq_u32 s46, 0
    s_cbranch_scc1 attn_kernel_nors23
    v_mul_f32 v0, v0, v229
    v_mul_f32 v1, v1, v229
    v_mul_f32 v2, v2, v229
    v_mul_f32 v3, v3, v229
    v_mul_f32 v4, v4, v229
    v_mul_f32 v5, v5, v229
    v_mul_f32 v6, v6, v229
    v_mul_f32 v7, v7, v229
    v_mul_f32 v8, v8, v229
    v_mul_f32 v9, v9, v229
    v_mul_f32 v10, v10, v229
    v_mul_f32 v11, v11, v229
    v_mul_f32 v12, v12, v229
    v_mul_f32 v13, v13, v229
    v_mul_f32 v14, v14, v229
    v_mul_f32 v15, v15, v229
    v_mul_f32 v16, v16, v229
    v_mul_f32 v17, v17, v229
    v_mul_f32 v18, v18, v229
    v_mul_f32 v19, v19, v229
    v_mul_f32 v20, v20, v229
    v_mul_f32 v21, v21, v229
    v_mul_f32 v22, v22, v229
    v_mul_f32 v23, v23, v229
    v_mul_f32 v24, v24, v229
    v_mul_f32 v25, v25, v229
    v_mul_f32 v26, v26, v229
    v_mul_f32 v27, v27, v229
    v_mul_f32 v28, v28, v229
    v_mul_f32 v29, v29, v229
    v_mul_f32 v30, v30, v229
    v_mul_f32 v31, v31, v229
    v_mul_f32 v32, v32, v229
    v_mul_f32 v33, v33, v229
    v_mul_f32 v34, v34, v229
    v_mul_f32 v35, v35, v229
    v_mul_f32 v36, v36, v229
    v_mul_f32 v37, v37, v229
    v_mul_f32 v38, v38, v229
    v_mul_f32 v39, v39, v229
    v_mul_f32 v40, v40, v229
    v_mul_f32 v41, v41, v229
    v_mul_f32 v42, v42, v229
    v_mul_f32 v43, v43, v229
    v_mul_f32 v44, v44, v229
    v_mul_f32 v45, v45, v229
    v_mul_f32 v46, v46, v229
    v_mul_f32 v47, v47, v229
    v_mul_f32 v48, v48, v229
    v_mul_f32 v49, v49, v229
    v_mul_f32 v50, v50, v229
    v_mul_f32 v51, v51, v229
    v_mul_f32 v52, v52, v229
    v_mul_f32 v53, v53, v229
    v_mul_f32 v54, v54, v229
    v_mul_f32 v55, v55, v229
    v_mul_f32 v56, v56, v229
    v_mul_f32 v57, v57, v229
    v_mul_f32 v58, v58, v229
    v_mul_f32 v59, v59, v229
    v_mul_f32 v60, v60, v229
    v_mul_f32 v61, v61, v229
    v_mul_f32 v62, v62, v229
    v_mul_f32 v63, v63, v229
    v_mul_f32 v64, v64, v229
    v_mul_f32 v65, v65, v229
    v_mul_f32 v66, v66, v229
    v_mul_f32 v67, v67, v229
    v_mul_f32 v68, v68, v229
    v_mul_f32 v69, v69, v229
    v_mul_f32 v70, v70, v229
    v_mul_f32 v71, v71, v229
    v_mul_f32 v72, v72, v229
    v_mul_f32 v73, v73, v229
    v_mul_f32 v74, v74, v229
    v_mul_f32 v75, v75, v229
    v_mul_f32 v76, v76, v229
    v_mul_f32 v77, v77, v229
    v_mul_f32 v78, v78, v229
    v_mul_f32 v79, v79, v229
    v_mul_f32 v80, v80, v229
    v_mul_f32 v81, v81, v229
    v_mul_f32 v82, v82, v229
    v_mul_f32 v83, v83, v229
    v_mul_f32 v84, v84, v229
    v_mul_f32 v85, v85, v229
    v_mul_f32 v86, v86, v229
    v_mul_f32 v87, v87, v229
    v_mul_f32 v88, v88, v229
    v_mul_f32 v89, v89, v229
    v_mul_f32 v90, v90, v229
    v_mul_f32 v91, v91, v229
    v_mul_f32 v92, v92, v229
    v_mul_f32 v93, v93, v229
    v_mul_f32 v94, v94, v229
    v_mul_f32 v95, v95, v229
    v_mul_f32 v96, v96, v229
    v_mul_f32 v97, v97, v229
    v_mul_f32 v98, v98, v229
    v_mul_f32 v99, v99, v229
    v_mul_f32 v100, v100, v229
    v_mul_f32 v101, v101, v229
    v_mul_f32 v102, v102, v229
    v_mul_f32 v103, v103, v229
    v_mul_f32 v104, v104, v229
    v_mul_f32 v105, v105, v229
    v_mul_f32 v106, v106, v229
    v_mul_f32 v107, v107, v229
    v_mul_f32 v108, v108, v229
    v_mul_f32 v109, v109, v229
    v_mul_f32 v110, v110, v229
    v_mul_f32 v111, v111, v229
    v_mul_f32 v112, v112, v229
    v_mul_f32 v113, v113, v229
    v_mul_f32 v114, v114, v229
    v_mul_f32 v115, v115, v229
    v_mul_f32 v116, v116, v229
    v_mul_f32 v117, v117, v229
    v_mul_f32 v118, v118, v229
    v_mul_f32 v119, v119, v229
    v_mul_f32 v120, v120, v229
    v_mul_f32 v121, v121, v229
    v_mul_f32 v122, v122, v229
    v_mul_f32 v123, v123, v229
    v_mul_f32 v124, v124, v229
    v_mul_f32 v125, v125, v229
    v_mul_f32 v126, v126, v229
    v_mul_f32 v127, v127, v229
    v_mul_f32 v176, v176, v229
    s_nop 1
attn_kernel_nors23:
    ds_read_b64_tr_b16 a[192:193], v214 offset:16384
    ds_read_b64_tr_b16 a[194:195], v214 offset:18432
    s_waitcnt lgkmcnt(6)
    v_mfma_f32_32x32x16_bf16 v[0:15], a[176:179], v[168:171], v[0:15]
    ds_read_b64_tr_b16 a[196:197], v214 offset:24576
    ds_read_b64_tr_b16 a[198:199], v214 offset:26624
    v_mfma_f32_32x32x16_bf16 v[0:15], a[180:183], v[172:175], v[0:15]
    ds_read_b64_tr_b16 a[200:201], v215 offset:16384
    ds_read_b64_tr_b16 a[202:203], v215 offset:18432
    s_waitcnt lgkmcnt(6)
    v_mfma_f32_32x32x16_bf16 v[16:31], a[184:187], v[168:171], v[16:31]
    ds_read_b64_tr_b16 a[204:205], v215 offset:24576
    ds_read_b64_tr_b16 a[206:207], v215 offset:26624
    v_mfma_f32_32x32x16_bf16 v[16:31], a[188:191], v[172:175], v[16:31]
    ds_read_b64_tr_b16 a[176:177], v212 offset:16640
    ds_read_b64_tr_b16 a[178:179], v212 offset:18688
    s_waitcnt lgkmcnt(6)
    v_mfma_f32_32x32x16_bf16 v[32:47], a[192:195], v[168:171], v[32:47]
    ds_read_b64_tr_b16 a[180:181], v212 offset:24832
    ds_read_b64_tr_b16 a[182:183], v212 offset:26880
    v_mfma_f32_32x32x16_bf16 v[32:47], a[196:199], v[172:175], v[32:47]
    v_mfma_f32_32x32x16_bf16 v[176:191], v[192:195], v[168:171], v[176:191]
    ds_read_b64_tr_b16 a[184:185], v213 offset:16640
    ds_read_b64_tr_b16 a[186:187], v213 offset:18688
    s_waitcnt lgkmcnt(6)
    v_mfma_f32_32x32x16_bf16 v[48:63], a[200:203], v[168:171], v[48:63]
    ds_read_b64_tr_b16 a[188:189], v213 offset:24832
    ds_read_b64_tr_b16 a[190:191], v213 offset:26880
    v_mfma_f32_32x32x16_bf16 v[48:63], a[204:207], v[172:175], v[48:63]
    ds_read_b64_tr_b16 a[192:193], v214 offset:16640
    ds_read_b64_tr_b16 a[194:195], v214 offset:18688
    s_waitcnt lgkmcnt(6)
    v_mfma_f32_32x32x16_bf16 v[64:79], a[176:179], v[168:171], v[64:79]
    ds_read_b64_tr_b16 a[196:197], v214 offset:24832
    ds_read_b64_tr_b16 a[198:199], v214 offset:26880
    v_mfma_f32_32x32x16_bf16 v[64:79], a[180:183], v[172:175], v[64:79]
    ds_read_b64_tr_b16 a[200:201], v215 offset:16640
    ds_read_b64_tr_b16 a[202:203], v215 offset:18688
    s_waitcnt lgkmcnt(6)
    v_mfma_f32_32x32x16_bf16 v[80:95], a[184:187], v[168:171], v[80:95]
    v_mfma_f32_32x32x16_bf16 v[176:191], v[192:195], v[172:175], v[176:191]
    ds_read_b64_tr_b16 a[204:205], v215 offset:24832
    ds_read_b64_tr_b16 a[206:207], v215 offset:26880
    v_mfma_f32_32x32x16_bf16 v[80:95], a[188:191], v[172:175], v[80:95]
    ds_read_b64_tr_b16 a[176:177], v212 offset:32768
    ds_read_b64_tr_b16 a[178:179], v212 offset:34816
    s_waitcnt lgkmcnt(6)
    v_mfma_f32_32x32x16_bf16 v[96:111], a[192:195], v[168:171], v[96:111]
    ds_read_b64_tr_b16 a[180:181], v212 offset:40960
    ds_read_b64_tr_b16 a[182:183], v212 offset:43008
    v_mfma_f32_32x32x16_bf16 v[96:111], a[196:199], v[172:175], v[96:111]
    ds_read_b64_tr_b16 a[184:185], v213 offset:32768
    ds_read_b64_tr_b16 a[186:187], v213 offset:34816
    s_waitcnt lgkmcnt(6)
    v_mfma_f32_32x32x16_bf16 v[112:127], a[200:203], v[168:171], v[112:127]
    ds_read_b64_tr_b16 a[188:189], v213 offset:40960
    ds_read_b64_tr_b16 a[190:191], v213 offset:43008
    v_mfma_f32_32x32x16_bf16 v[112:127], a[204:207], v[172:175], v[112:127]
    v_rcp_f32 v222, v176
    s_nop 0
    v_mul_f32 v0, v0, v222
    v_mul_f32 v1, v1, v222
    v_cvt_pk_bf16_f32 v220, v0, v1
    v_accvgpr_write_b32 a0, v220
    v_mul_f32 v2, v2, v222
    v_mul_f32 v3, v3, v222
    v_cvt_pk_bf16_f32 v221, v2, v3
    v_accvgpr_write_b32 a1, v221
    v_mul_f32 v4, v4, v222
    v_mul_f32 v5, v5, v222
    v_cvt_pk_bf16_f32 v220, v4, v5
    v_accvgpr_write_b32 a2, v220
    v_mul_f32 v6, v6, v222
    v_mul_f32 v7, v7, v222
    v_cvt_pk_bf16_f32 v221, v6, v7
    v_accvgpr_write_b32 a3, v221
    v_mul_f32 v8, v8, v222
    v_mul_f32 v9, v9, v222
    v_cvt_pk_bf16_f32 v220, v8, v9
    v_accvgpr_write_b32 a4, v220
    v_mul_f32 v10, v10, v222
    v_mul_f32 v11, v11, v222
    v_cvt_pk_bf16_f32 v221, v10, v11
    v_accvgpr_write_b32 a5, v221
    v_mul_f32 v12, v12, v222
    v_mul_f32 v13, v13, v222
    v_cvt_pk_bf16_f32 v220, v12, v13
    v_accvgpr_write_b32 a6, v220
    v_mul_f32 v14, v14, v222
    v_mul_f32 v15, v15, v222
    v_cvt_pk_bf16_f32 v221, v14, v15
    v_accvgpr_write_b32 a7, v221
    v_mul_f32 v16, v16, v222
    v_mul_f32 v17, v17, v222
    v_cvt_pk_bf16_f32 v220, v16, v17
    v_accvgpr_write_b32 a8, v220
    v_mul_f32 v18, v18, v222
    v_mul_f32 v19, v19, v222
    v_cvt_pk_bf16_f32 v221, v18, v19
    v_accvgpr_write_b32 a9, v221
    v_mul_f32 v20, v20, v222
    v_mul_f32 v21, v21, v222
    v_cvt_pk_bf16_f32 v220, v20, v21
    v_accvgpr_write_b32 a10, v220
    v_mul_f32 v22, v22, v222
    v_mul_f32 v23, v23, v222
    v_cvt_pk_bf16_f32 v221, v22, v23
    v_accvgpr_write_b32 a11, v221
    v_mul_f32 v24, v24, v222
    v_mul_f32 v25, v25, v222
    v_cvt_pk_bf16_f32 v220, v24, v25
    v_accvgpr_write_b32 a12, v220
    v_mul_f32 v26, v26, v222
    v_mul_f32 v27, v27, v222
    v_cvt_pk_bf16_f32 v221, v26, v27
    v_accvgpr_write_b32 a13, v221
    v_mul_f32 v28, v28, v222
    v_mul_f32 v29, v29, v222
    v_cvt_pk_bf16_f32 v220, v28, v29
    v_accvgpr_write_b32 a14, v220
    v_mul_f32 v30, v30, v222
    v_mul_f32 v31, v31, v222
    v_cvt_pk_bf16_f32 v221, v30, v31
    v_accvgpr_write_b32 a15, v221
    v_mul_f32 v32, v32, v222
    v_mul_f32 v33, v33, v222
    v_cvt_pk_bf16_f32 v220, v32, v33
    v_accvgpr_write_b32 a16, v220
    v_mul_f32 v34, v34, v222
    v_mul_f32 v35, v35, v222
    v_cvt_pk_bf16_f32 v221, v34, v35
    v_accvgpr_write_b32 a17, v221
    v_mul_f32 v36, v36, v222
    v_mul_f32 v37, v37, v222
    v_cvt_pk_bf16_f32 v220, v36, v37
    v_accvgpr_write_b32 a18, v220
    v_mul_f32 v38, v38, v222
    v_mul_f32 v39, v39, v222
    v_cvt_pk_bf16_f32 v221, v38, v39
    v_accvgpr_write_b32 a19, v221
    v_mul_f32 v40, v40, v222
    v_mul_f32 v41, v41, v222
    v_cvt_pk_bf16_f32 v220, v40, v41
    v_accvgpr_write_b32 a20, v220
    v_mul_f32 v42, v42, v222
    v_mul_f32 v43, v43, v222
    v_cvt_pk_bf16_f32 v221, v42, v43
    v_accvgpr_write_b32 a21, v221
    v_mul_f32 v44, v44, v222
    v_mul_f32 v45, v45, v222
    v_cvt_pk_bf16_f32 v220, v44, v45
    v_accvgpr_write_b32 a22, v220
    v_mul_f32 v46, v46, v222
    v_mul_f32 v47, v47, v222
    v_cvt_pk_bf16_f32 v221, v46, v47
    v_accvgpr_write_b32 a23, v221
    v_mul_f32 v48, v48, v222
    v_mul_f32 v49, v49, v222
    v_cvt_pk_bf16_f32 v220, v48, v49
    v_accvgpr_write_b32 a24, v220
    v_mul_f32 v50, v50, v222
    v_mul_f32 v51, v51, v222
    v_cvt_pk_bf16_f32 v221, v50, v51
    v_accvgpr_write_b32 a25, v221
    v_mul_f32 v52, v52, v222
    v_mul_f32 v53, v53, v222
    v_cvt_pk_bf16_f32 v220, v52, v53
    v_accvgpr_write_b32 a26, v220
    v_mul_f32 v54, v54, v222
    v_mul_f32 v55, v55, v222
    v_cvt_pk_bf16_f32 v221, v54, v55
    v_accvgpr_write_b32 a27, v221
    v_mul_f32 v56, v56, v222
    v_mul_f32 v57, v57, v222
    v_cvt_pk_bf16_f32 v220, v56, v57
    v_accvgpr_write_b32 a28, v220
    v_mul_f32 v58, v58, v222
    v_mul_f32 v59, v59, v222
    v_cvt_pk_bf16_f32 v221, v58, v59
    v_accvgpr_write_b32 a29, v221
    v_mul_f32 v60, v60, v222
    v_mul_f32 v61, v61, v222
    v_cvt_pk_bf16_f32 v220, v60, v61
    v_accvgpr_write_b32 a30, v220
    v_mul_f32 v62, v62, v222
    v_mul_f32 v63, v63, v222
    v_cvt_pk_bf16_f32 v221, v62, v63
    v_accvgpr_write_b32 a31, v221
    v_mul_f32 v64, v64, v222
    v_mul_f32 v65, v65, v222
    v_cvt_pk_bf16_f32 v220, v64, v65
    v_accvgpr_write_b32 a32, v220
    v_mul_f32 v66, v66, v222
    v_mul_f32 v67, v67, v222
    v_cvt_pk_bf16_f32 v221, v66, v67
    v_accvgpr_write_b32 a33, v221
    v_mul_f32 v68, v68, v222
    v_mul_f32 v69, v69, v222
    v_cvt_pk_bf16_f32 v220, v68, v69
    v_accvgpr_write_b32 a34, v220
    v_mul_f32 v70, v70, v222
    v_mul_f32 v71, v71, v222
    v_cvt_pk_bf16_f32 v221, v70, v71
    v_accvgpr_write_b32 a35, v221
    v_mul_f32 v72, v72, v222
    v_mul_f32 v73, v73, v222
    v_cvt_pk_bf16_f32 v220, v72, v73
    v_accvgpr_write_b32 a36, v220
    v_mul_f32 v74, v74, v222
    v_mul_f32 v75, v75, v222
    v_cvt_pk_bf16_f32 v221, v74, v75
    v_accvgpr_write_b32 a37, v221
    v_mul_f32 v76, v76, v222
    v_mul_f32 v77, v77, v222
    v_cvt_pk_bf16_f32 v220, v76, v77
    v_accvgpr_write_b32 a38, v220
    v_mul_f32 v78, v78, v222
    v_mul_f32 v79, v79, v222
    v_cvt_pk_bf16_f32 v221, v78, v79
    v_accvgpr_write_b32 a39, v221
    v_mul_f32 v80, v80, v222
    v_mul_f32 v81, v81, v222
    v_cvt_pk_bf16_f32 v220, v80, v81
    v_accvgpr_write_b32 a40, v220
    v_mul_f32 v82, v82, v222
    v_mul_f32 v83, v83, v222
    v_cvt_pk_bf16_f32 v221, v82, v83
    v_accvgpr_write_b32 a41, v221
    v_mul_f32 v84, v84, v222
    v_mul_f32 v85, v85, v222
    v_cvt_pk_bf16_f32 v220, v84, v85
    v_accvgpr_write_b32 a42, v220
    v_mul_f32 v86, v86, v222
    v_mul_f32 v87, v87, v222
    v_cvt_pk_bf16_f32 v221, v86, v87
    v_accvgpr_write_b32 a43, v221
    v_mul_f32 v88, v88, v222
    v_mul_f32 v89, v89, v222
    v_cvt_pk_bf16_f32 v220, v88, v89
    v_accvgpr_write_b32 a44, v220
    v_mul_f32 v90, v90, v222
    v_mul_f32 v91, v91, v222
    v_cvt_pk_bf16_f32 v221, v90, v91
    v_accvgpr_write_b32 a45, v221
    v_mul_f32 v92, v92, v222
    v_mul_f32 v93, v93, v222
    v_cvt_pk_bf16_f32 v220, v92, v93
    v_accvgpr_write_b32 a46, v220
    v_mul_f32 v94, v94, v222
    v_mul_f32 v95, v95, v222
    v_cvt_pk_bf16_f32 v221, v94, v95
    v_accvgpr_write_b32 a47, v221
    v_mul_f32 v96, v96, v222
    v_mul_f32 v97, v97, v222
    v_cvt_pk_bf16_f32 v220, v96, v97
    v_accvgpr_write_b32 a48, v220
    v_mul_f32 v98, v98, v222
    v_mul_f32 v99, v99, v222
    v_cvt_pk_bf16_f32 v221, v98, v99
    v_accvgpr_write_b32 a49, v221
    v_mul_f32 v100, v100, v222
    v_mul_f32 v101, v101, v222
    v_cvt_pk_bf16_f32 v220, v100, v101
    v_accvgpr_write_b32 a50, v220
    v_mul_f32 v102, v102, v222
    v_mul_f32 v103, v103, v222
    v_cvt_pk_bf16_f32 v221, v102, v103
    v_accvgpr_write_b32 a51, v221
    v_mul_f32 v104, v104, v222
    v_mul_f32 v105, v105, v222
    v_cvt_pk_bf16_f32 v220, v104, v105
    v_accvgpr_write_b32 a52, v220
    v_mul_f32 v106, v106, v222
    v_mul_f32 v107, v107, v222
    v_cvt_pk_bf16_f32 v221, v106, v107
    v_accvgpr_write_b32 a53, v221
    v_mul_f32 v108, v108, v222
    v_mul_f32 v109, v109, v222
    v_cvt_pk_bf16_f32 v220, v108, v109
    v_accvgpr_write_b32 a54, v220
    v_mul_f32 v110, v110, v222
    v_mul_f32 v111, v111, v222
    v_cvt_pk_bf16_f32 v221, v110, v111
    v_accvgpr_write_b32 a55, v221
    v_mul_f32 v112, v112, v222
    v_mul_f32 v113, v113, v222
    v_cvt_pk_bf16_f32 v220, v112, v113
    v_accvgpr_write_b32 a56, v220
    v_mul_f32 v114, v114, v222
    v_mul_f32 v115, v115, v222
    v_cvt_pk_bf16_f32 v221, v114, v115
    v_accvgpr_write_b32 a57, v221
    v_mul_f32 v116, v116, v222
    v_mul_f32 v117, v117, v222
    v_cvt_pk_bf16_f32 v220, v116, v117
    v_accvgpr_write_b32 a58, v220
    v_mul_f32 v118, v118, v222
    v_mul_f32 v119, v119, v222
    v_cvt_pk_bf16_f32 v221, v118, v119
    v_accvgpr_write_b32 a59, v221
    v_mul_f32 v120, v120, v222
    v_mul_f32 v121, v121, v222
    v_cvt_pk_bf16_f32 v220, v120, v121
    v_accvgpr_write_b32 a60, v220
    v_mul_f32 v122, v122, v222
    v_mul_f32 v123, v123, v222
    v_cvt_pk_bf16_f32 v221, v122, v123
    v_accvgpr_write_b32 a61, v221
    v_mul_f32 v124, v124, v222
    v_mul_f32 v125, v125, v222
    v_cvt_pk_bf16_f32 v220, v124, v125
    v_accvgpr_write_b32 a62, v220
    v_mul_f32 v126, v126, v222
    v_mul_f32 v127, v127, v222
    v_cvt_pk_bf16_f32 v221, v126, v127
    v_accvgpr_write_b32 a63, v221
    s_barrier
    ds_read_b64_tr_b16 a[192:193], v214 offset:32768
    ds_read_b64_tr_b16 a[194:195], v214 offset:34816
    s_waitcnt lgkmcnt(6)
    v_mfma_f32_32x32x16_bf16 v[0:15], a[176:179], a[0:3], 0
    ds_read_b64_tr_b16 a[196:197], v214 offset:40960
    ds_read_b64_tr_b16 a[198:199], v214 offset:43008
    v_mfma_f32_32x32x16_bf16 v[0:15], a[180:183], a[4:7], v[0:15]
    ds_read_b64_tr_b16 a[200:201], v215 offset:32768
    ds_read_b64_tr_b16 a[202:203], v215 offset:34816
    s_waitcnt lgkmcnt(6)
    v_mfma_f32_32x32x16_bf16 v[16:31], a[184:187], a[0:3], 0
    ds_read_b64_tr_b16 a[204:205], v215 offset:40960
    ds_read_b64_tr_b16 a[206:207], v215 offset:43008
    v_mfma_f32_32x32x16_bf16 v[16:31], a[188:191], a[4:7], v[16:31]
    ds_read_b64_tr_b16 a[176:177], v212 offset:33024
    ds_read_b64_tr_b16 a[178:179], v212 offset:35072
    s_waitcnt lgkmcnt(6)
    v_mfma_f32_32x32x16_bf16 v[32:47], a[192:195], a[0:3], 0
    ds_read_b64_tr_b16 a[180:181], v212 offset:41216
    ds_read_b64_tr_b16 a[182:183], v212 offset:43264
    v_mfma_f32_32x32x16_bf16 v[32:47], a[196:199], a[4:7], v[32:47]
    ds_read_b64_tr_b16 a[184:185], v213 offset:33024
    ds_read_b64_tr_b16 a[186:187], v213 offset:35072
    s_waitcnt lgkmcnt(6)
    v_mfma_f32_32x32x16_bf16 v[48:63], a[200:203], a[0:3], 0
    ds_read_b64_tr_b16 a[188:189], v213 offset:41216
    ds_read_b64_tr_b16 a[190:191], v213 offset:43264
    v_mfma_f32_32x32x16_bf16 v[48:63], a[204:207], a[4:7], v[48:63]
    ds_read_b64_tr_b16 a[192:193], v214 offset:33024
    ds_read_b64_tr_b16 a[194:195], v214 offset:35072
    s_waitcnt lgkmcnt(6)
    v_mfma_f32_32x32x16_bf16 v[64:79], a[176:179], a[0:3], 0
    ds_read_b64_tr_b16 a[196:197], v214 offset:41216
    ds_read_b64_tr_b16 a[198:199], v214 offset:43264
    v_mfma_f32_32x32x16_bf16 v[64:79], a[180:183], a[4:7], v[64:79]
    ds_read_b64_tr_b16 a[200:201], v212 offset:49152
    ds_read_b64_tr_b16 a[202:203], v212 offset:51200
    s_waitcnt lgkmcnt(6)
    v_mfma_f32_32x32x16_bf16 v[80:95], a[184:187], a[0:3], 0
    ds_read_b64_tr_b16 a[204:205], v212 offset:57344
    ds_read_b64_tr_b16 a[206:207], v212 offset:59392
    v_mfma_f32_32x32x16_bf16 v[80:95], a[188:191], a[4:7], v[80:95]
    ds_read_b64_tr_b16 a[176:177], v213 offset:49152
    ds_read_b64_tr_b16 a[178:179], v213 offset:51200
    s_waitcnt lgkmcnt(6)
    v_mfma_f32_32x32x16_bf16 v[96:111], a[192:195], a[0:3], 0
    ds_read_b64_tr_b16 a[180:181], v213 offset:57344
    ds_read_b64_tr_b16 a[182:183], v213 offset:59392
    v_mfma_f32_32x32x16_bf16 v[96:111], a[196:199], a[4:7], v[96:111]
    s_barrier
    ds_read_b64_tr_b16 a[184:185], v214 offset:49152
    ds_read_b64_tr_b16 a[186:187], v214 offset:51200
    s_waitcnt lgkmcnt(6)
    v_mfma_f32_32x32x16_bf16 v[0:15], a[200:203], a[8:11], v[0:15]
    ds_read_b64_tr_b16 a[188:189], v214 offset:57344
    ds_read_b64_tr_b16 a[190:191], v214 offset:59392
    v_mfma_f32_32x32x16_bf16 v[0:15], a[204:207], a[12:15], v[0:15]
    ds_read_b64_tr_b16 a[192:193], v215 offset:49152
    ds_read_b64_tr_b16 a[194:195], v215 offset:51200
    s_waitcnt lgkmcnt(6)
    v_mfma_f32_32x32x16_bf16 v[16:31], a[176:179], a[8:11], v[16:31]
    ds_read_b64_tr_b16 a[196:197], v215 offset:57344
    ds_read_b64_tr_b16 a[198:199], v215 offset:59392
    v_mfma_f32_32x32x16_bf16 v[16:31], a[180:183], a[12:15], v[16:31]
    ds_read_b64_tr_b16 a[200:201], v212 offset:49408
    ds_read_b64_tr_b16 a[202:203], v212 offset:51456
    s_waitcnt lgkmcnt(6)
    v_mfma_f32_32x32x16_bf16 v[32:47], a[184:187], a[8:11], v[32:47]
    ds_read_b64_tr_b16 a[204:205], v212 offset:57600
    ds_read_b64_tr_b16 a[206:207], v212 offset:59648
    v_mfma_f32_32x32x16_bf16 v[32:47], a[188:191], a[12:15], v[32:47]
    ds_read_b64_tr_b16 a[176:177], v213 offset:49408
    ds_read_b64_tr_b16 a[178:179], v213 offset:51456
    s_waitcnt lgkmcnt(6)
    v_mfma_f32_32x32x16_bf16 v[48:63], a[192:195], a[8:11], v[48:63]
    ds_read_b64_tr_b16 a[180:181], v213 offset:57600
    ds_read_b64_tr_b16 a[182:183], v213 offset:59648
    v_mfma_f32_32x32x16_bf16 v[48:63], a[196:199], a[12:15], v[48:63]
    ds_read_b64_tr_b16 a[184:185], v214 offset:49408
    ds_read_b64_tr_b16 a[186:187], v214 offset:51456
    s_waitcnt lgkmcnt(6)
    v_mfma_f32_32x32x16_bf16 v[64:79], a[200:203], a[8:11], v[64:79]
    ds_read_b64_tr_b16 a[188:189], v214 offset:57600
    ds_read_b64_tr_b16 a[190:191], v214 offset:59648
    v_mfma_f32_32x32x16_bf16 v[64:79], a[204:207], a[12:15], v[64:79]
    ds_read_b64_tr_b16 a[192:193], v208
    ds_read_b64_tr_b16 a[194:195], v208 offset:2048
    s_waitcnt lgkmcnt(6)
    v_mfma_f32_32x32x16_bf16 v[80:95], a[176:179], a[8:11], v[80:95]
    ds_read_b64_tr_b16 a[196:197], v208 offset:8192
    ds_read_b64_tr_b16 a[198:199], v208 offset:10240
    v_mfma_f32_32x32x16_bf16 v[80:95], a[180:183], a[12:15], v[80:95]
    ds_read_b64_tr_b16 a[200:201], v209
    ds_read_b64_tr_b16 a[202:203], v209 offset:2048
    s_waitcnt lgkmcnt(6)
    v_mfma_f32_32x32x16_bf16 v[96:111], a[184:187], a[8:11], v[96:111]
    ds_read_b64_tr_b16 a[204:205], v209 offset:8192
    ds_read_b64_tr_b16 a[206:207], v209 offset:10240
    v_mfma_f32_32x32x16_bf16 v[96:111], a[188:191], a[12:15], v[96:111]
    s_barrier
    ds_read_b64_tr_b16 a[176:177], v210
    ds_read_b64_tr_b16 a[178:179], v210 offset:2048
    s_waitcnt lgkmcnt(6)
    v_mfma_f32_32x32x16_bf16 v[0:15], a[192:195], a[16:19], v[0:15]
    ds_read_b64_tr_b16 a[180:181], v210 offset:8192
    ds_read_b64_tr_b16 a[182:183], v210 offset:10240
    v_mfma_f32_32x32x16_bf16 v[0:15], a[196:199], a[20:23], v[0:15]
    ds_read_b64_tr_b16 a[184:185], v211
    ds_read_b64_tr_b16 a[186:187], v211 offset:2048
    s_waitcnt lgkmcnt(6)
    v_mfma_f32_32x32x16_bf16 v[16:31], a[200:203], a[16:19], v[16:31]
    ds_read_b64_tr_b16 a[188:189], v211 offset:8192
    ds_read_b64_tr_b16 a[190:191], v211 offset:10240
    v_mfma_f32_32x32x16_bf16 v[16:31], a[204:207], a[20:23], v[16:31]
    ds_read_b64_tr_b16 a[192:193], v208 offset:256
    ds_read_b64_tr_b16 a[194:195], v208 offset:2304
    s_waitcnt lgkmcnt(6)
    v_mfma_f32_32x32x16_bf16 v[32:47], a[176:179], a[16:19], v[32:47]
    ds_read_b64_tr_b16 a[196:197], v208 offset:8448
    ds_read_b64_tr_b16 a[198:199], v208 offset:10496
    v_mfma_f32_32x32x16_bf16 v[32:47], a[180:183], a[20:23], v[32:47]
    ds_read_b64_tr_b16 a[200:201], v209 offset:256
    ds_read_b64_tr_b16 a[202:203], v209 offset:2304
    s_waitcnt lgkmcnt(6)
    v_mfma_f32_32x32x16_bf16 v[48:63], a[184:187], a[16:19], v[48:63]
    ds_read_b64_tr_b16 a[204:205], v209 offset:8448
    ds_read_b64_tr_b16 a[206:207], v209 offset:10496
    v_mfma_f32_32x32x16_bf16 v[48:63], a[188:191], a[20:23], v[48:63]
    ds_read_b64_tr_b16 a[176:177], v210 offset:256
    ds_read_b64_tr_b16 a[178:179], v210 offset:2304
    s_waitcnt lgkmcnt(6)
    v_mfma_f32_32x32x16_bf16 v[64:79], a[192:195], a[16:19], v[64:79]
    ds_read_b64_tr_b16 a[180:181], v210 offset:8448
    ds_read_b64_tr_b16 a[182:183], v210 offset:10496
    v_mfma_f32_32x32x16_bf16 v[64:79], a[196:199], a[20:23], v[64:79]
    ds_read_b64_tr_b16 a[184:185], v208 offset:16384
    ds_read_b64_tr_b16 a[186:187], v208 offset:18432
    s_waitcnt lgkmcnt(6)
    v_mfma_f32_32x32x16_bf16 v[80:95], a[200:203], a[16:19], v[80:95]
    ds_read_b64_tr_b16 a[188:189], v208 offset:24576
    ds_read_b64_tr_b16 a[190:191], v208 offset:26624
    v_mfma_f32_32x32x16_bf16 v[80:95], a[204:207], a[20:23], v[80:95]
    ds_read_b64_tr_b16 a[192:193], v209 offset:16384
    ds_read_b64_tr_b16 a[194:195], v209 offset:18432
    s_waitcnt lgkmcnt(6)
    v_mfma_f32_32x32x16_bf16 v[96:111], a[176:179], a[16:19], v[96:111]
    ds_read_b64_tr_b16 a[196:197], v209 offset:24576
    ds_read_b64_tr_b16 a[198:199], v209 offset:26624
    v_mfma_f32_32x32x16_bf16 v[96:111], a[180:183], a[20:23], v[96:111]
    s_barrier
    ds_read_b64_tr_b16 a[200:201], v210 offset:16384
    ds_read_b64_tr_b16 a[202:203], v210 offset:18432
    s_waitcnt lgkmcnt(6)
    v_mfma_f32_32x32x16_bf16 v[0:15], a[184:187], a[24:27], v[0:15]
    ds_read_b64_tr_b16 a[204:205], v210 offset:24576
    ds_read_b64_tr_b16 a[206:207], v210 offset:26624
    v_mfma_f32_32x32x16_bf16 v[0:15], a[188:191], a[28:31], v[0:15]
    ds_read_b64_tr_b16 a[176:177], v211 offset:16384
    ds_read_b64_tr_b16 a[178:179], v211 offset:18432
    s_waitcnt lgkmcnt(6)
    v_mfma_f32_32x32x16_bf16 v[16:31], a[192:195], a[24:27], v[16:31]
    ds_read_b64_tr_b16 a[180:181], v211 offset:24576
    ds_read_b64_tr_b16 a[182:183], v211 offset:26624
    v_mfma_f32_32x32x16_bf16 v[16:31], a[196:199], a[28:31], v[16:31]
    ds_read_b64_tr_b16 a[184:185], v208 offset:16640
    ds_read_b64_tr_b16 a[186:187], v208 offset:18688
    s_waitcnt lgkmcnt(6)
    v_mfma_f32_32x32x16_bf16 v[32:47], a[200:203], a[24:27], v[32:47]
    ds_read_b64_tr_b16 a[188:189], v208 offset:24832
    ds_read_b64_tr_b16 a[190:191], v208 offset:26880
    v_mfma_f32_32x32x16_bf16 v[32:47], a[204:207], a[28:31], v[32:47]
    ds_read_b64_tr_b16 a[192:193], v209 offset:16640
    ds_read_b64_tr_b16 a[194:195], v209 offset:18688
    s_waitcnt lgkmcnt(6)
    v_mfma_f32_32x32x16_bf16 v[48:63], a[176:179], a[24:27], v[48:63]
    ds_read_b64_tr_b16 a[196:197], v209 offset:24832
    ds_read_b64_tr_b16 a[198:199], v209 offset:26880
    v_mfma_f32_32x32x16_bf16 v[48:63], a[180:183], a[28:31], v[48:63]
    ds_read_b64_tr_b16 a[200:201], v210 offset:16640
    ds_read_b64_tr_b16 a[202:203], v210 offset:18688
    s_waitcnt lgkmcnt(6)
    v_mfma_f32_32x32x16_bf16 v[64:79], a[184:187], a[24:27], v[64:79]
    ds_read_b64_tr_b16 a[204:205], v210 offset:24832
    ds_read_b64_tr_b16 a[206:207], v210 offset:26880
    v_mfma_f32_32x32x16_bf16 v[64:79], a[188:191], a[28:31], v[64:79]
    ds_read_b64_tr_b16 a[176:177], v208 offset:32768
    ds_read_b64_tr_b16 a[178:179], v208 offset:34816
    s_waitcnt lgkmcnt(6)
    v_mfma_f32_32x32x16_bf16 v[80:95], a[192:195], a[24:27], v[80:95]
    ds_read_b64_tr_b16 a[180:181], v208 offset:40960
    ds_read_b64_tr_b16 a[182:183], v208 offset:43008
    v_mfma_f32_32x32x16_bf16 v[80:95], a[196:199], a[28:31], v[80:95]
    ds_read_b64_tr_b16 a[184:185], v209 offset:32768
    ds_read_b64_tr_b16 a[186:187], v209 offset:34816
    s_waitcnt lgkmcnt(6)
    v_mfma_f32_32x32x16_bf16 v[96:111], a[200:203], a[24:27], v[96:111]
    ds_read_b64_tr_b16 a[188:189], v209 offset:40960
    ds_read_b64_tr_b16 a[190:191], v209 offset:43008
    v_mfma_f32_32x32x16_bf16 v[96:111], a[204:207], a[28:31], v[96:111]
    s_barrier
    ds_read_b64_tr_b16 a[192:193], v210 offset:32768
    ds_read_b64_tr_b16 a[194:195], v210 offset:34816
    s_waitcnt lgkmcnt(6)
    v_mfma_f32_32x32x16_bf16 v[0:15], a[176:179], a[32:35], v[0:15]
    ds_read_b64_tr_b16 a[196:197], v210 offset:40960
    ds_read_b64_tr_b16 a[198:199], v210 offset:43008
    v_mfma_f32_32x32x16_bf16 v[0:15], a[180:183], a[36:39], v[0:15]
    ds_read_b64_tr_b16 a[200:201], v211 offset:32768
    ds_read_b64_tr_b16 a[202:203], v211 offset:34816
    s_waitcnt lgkmcnt(6)
    v_mfma_f32_32x32x16_bf16 v[16:31], a[184:187], a[32:35], v[16:31]
    ds_read_b64_tr_b16 a[204:205], v211 offset:40960
    ds_read_b64_tr_b16 a[206:207], v211 offset:43008
    v_mfma_f32_32x32x16_bf16 v[16:31], a[188:191], a[36:39], v[16:31]
    ds_read_b64_tr_b16 a[176:177], v208 offset:33024
    ds_read_b64_tr_b16 a[178:179], v208 offset:35072
    s_waitcnt lgkmcnt(6)
    v_mfma_f32_32x32x16_bf16 v[32:47], a[192:195], a[32:35], v[32:47]
    ds_read_b64_tr_b16 a[180:181], v208 offset:41216
    ds_read_b64_tr_b16 a[182:183], v208 offset:43264
    v_mfma_f32_32x32x16_bf16 v[32:47], a[196:199], a[36:39], v[32:47]
    ds_read_b64_tr_b16 a[184:185], v209 offset:33024
    ds_read_b64_tr_b16 a[186:187], v209 offset:35072
    s_waitcnt lgkmcnt(6)
    v_mfma_f32_32x32x16_bf16 v[48:63], a[200:203], a[32:35], v[48:63]
    ds_read_b64_tr_b16 a[188:189], v209 offset:41216
    ds_read_b64_tr_b16 a[190:191], v209 offset:43264
    v_mfma_f32_32x32x16_bf16 v[48:63], a[204:207], a[36:39], v[48:63]
    ds_read_b64_tr_b16 a[192:193], v210 offset:33024
    ds_read_b64_tr_b16 a[194:195], v210 offset:35072
    s_waitcnt lgkmcnt(6)
    v_mfma_f32_32x32x16_bf16 v[64:79], a[176:179], a[32:35], v[64:79]
    ds_read_b64_tr_b16 a[196:197], v210 offset:41216
    ds_read_b64_tr_b16 a[198:199], v210 offset:43264
    v_mfma_f32_32x32x16_bf16 v[64:79], a[180:183], a[36:39], v[64:79]
    ds_read_b64_tr_b16 a[200:201], v208 offset:49152
    ds_read_b64_tr_b16 a[202:203], v208 offset:51200
    s_waitcnt lgkmcnt(6)
    v_mfma_f32_32x32x16_bf16 v[80:95], a[184:187], a[32:35], v[80:95]
    ds_read_b64_tr_b16 a[204:205], v208 offset:57344
    ds_read_b64_tr_b16 a[206:207], v208 offset:59392
    v_mfma_f32_32x32x16_bf16 v[80:95], a[188:191], a[36:39], v[80:95]
    ds_read_b64_tr_b16 a[176:177], v209 offset:49152
    ds_read_b64_tr_b16 a[178:179], v209 offset:51200
    s_waitcnt lgkmcnt(6)
    v_mfma_f32_32x32x16_bf16 v[96:111], a[192:195], a[32:35], v[96:111]
    ds_read_b64_tr_b16 a[180:181], v209 offset:57344
    ds_read_b64_tr_b16 a[182:183], v209 offset:59392
    v_mfma_f32_32x32x16_bf16 v[96:111], a[196:199], a[36:39], v[96:111]
    s_barrier
    ds_read_b64_tr_b16 a[184:185], v210 offset:49152
    ds_read_b64_tr_b16 a[186:187], v210 offset:51200
    s_waitcnt lgkmcnt(6)
    v_mfma_f32_32x32x16_bf16 v[0:15], a[200:203], a[40:43], v[0:15]
    ds_read_b64_tr_b16 a[188:189], v210 offset:57344
    ds_read_b64_tr_b16 a[190:191], v210 offset:59392
    v_mfma_f32_32x32x16_bf16 v[0:15], a[204:207], a[44:47], v[0:15]
    ds_read_b64_tr_b16 a[192:193], v211 offset:49152
    ds_read_b64_tr_b16 a[194:195], v211 offset:51200
    s_waitcnt lgkmcnt(6)
    v_mfma_f32_32x32x16_bf16 v[16:31], a[176:179], a[40:43], v[16:31]
    ds_read_b64_tr_b16 a[196:197], v211 offset:57344
    ds_read_b64_tr_b16 a[198:199], v211 offset:59392
    v_mfma_f32_32x32x16_bf16 v[16:31], a[180:183], a[44:47], v[16:31]
    ds_read_b64_tr_b16 a[200:201], v208 offset:49408
    ds_read_b64_tr_b16 a[202:203], v208 offset:51456
    s_waitcnt lgkmcnt(6)
    v_mfma_f32_32x32x16_bf16 v[32:47], a[184:187], a[40:43], v[32:47]
    ds_read_b64_tr_b16 a[204:205], v208 offset:57600
    ds_read_b64_tr_b16 a[206:207], v208 offset:59648
    v_mfma_f32_32x32x16_bf16 v[32:47], a[188:191], a[44:47], v[32:47]
    ds_read_b64_tr_b16 a[176:177], v209 offset:49408
    ds_read_b64_tr_b16 a[178:179], v209 offset:51456
    s_waitcnt lgkmcnt(6)
    v_mfma_f32_32x32x16_bf16 v[48:63], a[192:195], a[40:43], v[48:63]
    ds_read_b64_tr_b16 a[180:181], v209 offset:57600
    ds_read_b64_tr_b16 a[182:183], v209 offset:59648
    v_mfma_f32_32x32x16_bf16 v[48:63], a[196:199], a[44:47], v[48:63]
    ds_read_b64_tr_b16 a[184:185], v210 offset:49408
    ds_read_b64_tr_b16 a[186:187], v210 offset:51456
    s_waitcnt lgkmcnt(6)
    v_mfma_f32_32x32x16_bf16 v[64:79], a[200:203], a[40:43], v[64:79]
    ds_read_b64_tr_b16 a[188:189], v210 offset:57600
    ds_read_b64_tr_b16 a[190:191], v210 offset:59648
    v_mfma_f32_32x32x16_bf16 v[64:79], a[204:207], a[44:47], v[64:79]
    ds_read_b64_tr_b16 a[192:193], v212
    ds_read_b64_tr_b16 a[194:195], v212 offset:2048
    s_waitcnt lgkmcnt(6)
    v_mfma_f32_32x32x16_bf16 v[80:95], a[176:179], a[40:43], v[80:95]
    ds_read_b64_tr_b16 a[196:197], v212 offset:8192
    ds_read_b64_tr_b16 a[198:199], v212 offset:10240
    v_mfma_f32_32x32x16_bf16 v[80:95], a[180:183], a[44:47], v[80:95]
    ds_read_b64_tr_b16 a[200:201], v213
    ds_read_b64_tr_b16 a[202:203], v213 offset:2048
    s_waitcnt lgkmcnt(6)
    v_mfma_f32_32x32x16_bf16 v[96:111], a[184:187], a[40:43], v[96:111]
    ds_read_b64_tr_b16 a[204:205], v213 offset:8192
    ds_read_b64_tr_b16 a[206:207], v213 offset:10240
    v_mfma_f32_32x32x16_bf16 v[96:111], a[188:191], a[44:47], v[96:111]
    s_barrier
    ds_read_b64_tr_b16 a[176:177], v214
    ds_read_b64_tr_b16 a[178:179], v214 offset:2048
    s_waitcnt lgkmcnt(6)
    v_mfma_f32_32x32x16_bf16 v[0:15], a[192:195], a[48:51], v[0:15]
    ds_read_b64_tr_b16 a[180:181], v214 offset:8192
    ds_read_b64_tr_b16 a[182:183], v214 offset:10240
    v_mfma_f32_32x32x16_bf16 v[0:15], a[196:199], a[52:55], v[0:15]
    ds_read_b64_tr_b16 a[184:185], v215
    ds_read_b64_tr_b16 a[186:187], v215 offset:2048
    s_waitcnt lgkmcnt(6)
    v_mfma_f32_32x32x16_bf16 v[16:31], a[200:203], a[48:51], v[16:31]
    ds_read_b64_tr_b16 a[188:189], v215 offset:8192
    ds_read_b64_tr_b16 a[190:191], v215 offset:10240
    v_mfma_f32_32x32x16_bf16 v[16:31], a[204:207], a[52:55], v[16:31]
    ds_read_b64_tr_b16 a[192:193], v212 offset:256
    ds_read_b64_tr_b16 a[194:195], v212 offset:2304
    s_waitcnt lgkmcnt(6)
    v_mfma_f32_32x32x16_bf16 v[32:47], a[176:179], a[48:51], v[32:47]
    ds_read_b64_tr_b16 a[196:197], v212 offset:8448
    ds_read_b64_tr_b16 a[198:199], v212 offset:10496
    v_mfma_f32_32x32x16_bf16 v[32:47], a[180:183], a[52:55], v[32:47]
    ds_read_b64_tr_b16 a[200:201], v213 offset:256
    ds_read_b64_tr_b16 a[202:203], v213 offset:2304
    s_waitcnt lgkmcnt(6)
    v_mfma_f32_32x32x16_bf16 v[48:63], a[184:187], a[48:51], v[48:63]
    ds_read_b64_tr_b16 a[204:205], v213 offset:8448
    ds_read_b64_tr_b16 a[206:207], v213 offset:10496
    v_mfma_f32_32x32x16_bf16 v[48:63], a[188:191], a[52:55], v[48:63]
    ds_read_b64_tr_b16 a[176:177], v214 offset:256
    ds_read_b64_tr_b16 a[178:179], v214 offset:2304
    s_waitcnt lgkmcnt(6)
    v_mfma_f32_32x32x16_bf16 v[64:79], a[192:195], a[48:51], v[64:79]
    ds_read_b64_tr_b16 a[180:181], v214 offset:8448
    ds_read_b64_tr_b16 a[182:183], v214 offset:10496
    v_mfma_f32_32x32x16_bf16 v[64:79], a[196:199], a[52:55], v[64:79]
    ds_read_b64_tr_b16 a[184:185], v212 offset:16384
    ds_read_b64_tr_b16 a[186:187], v212 offset:18432
    s_waitcnt lgkmcnt(6)
    v_mfma_f32_32x32x16_bf16 v[80:95], a[200:203], a[48:51], v[80:95]
    ds_read_b64_tr_b16 a[188:189], v212 offset:24576
    ds_read_b64_tr_b16 a[190:191], v212 offset:26624
    v_mfma_f32_32x32x16_bf16 v[80:95], a[204:207], a[52:55], v[80:95]
    ds_read_b64_tr_b16 a[192:193], v213 offset:16384
    ds_read_b64_tr_b16 a[194:195], v213 offset:18432
    s_waitcnt lgkmcnt(6)
    v_mfma_f32_32x32x16_bf16 v[96:111], a[176:179], a[48:51], v[96:111]
    ds_read_b64_tr_b16 a[196:197], v213 offset:24576
    ds_read_b64_tr_b16 a[198:199], v213 offset:26624
    v_mfma_f32_32x32x16_bf16 v[96:111], a[180:183], a[52:55], v[96:111]
    s_barrier
    ds_read_b64_tr_b16 a[200:201], v214 offset:16384
    ds_read_b64_tr_b16 a[202:203], v214 offset:18432
    s_waitcnt lgkmcnt(6)
    v_mfma_f32_32x32x16_bf16 v[0:15], a[184:187], a[56:59], v[0:15]
    ds_read_b64_tr_b16 a[204:205], v214 offset:24576
    ds_read_b64_tr_b16 a[206:207], v214 offset:26624
    v_mfma_f32_32x32x16_bf16 v[0:15], a[188:191], a[60:63], v[0:15]
    ds_read_b64_tr_b16 a[176:177], v215 offset:16384
    ds_read_b64_tr_b16 a[178:179], v215 offset:18432
    s_waitcnt lgkmcnt(6)
    v_mfma_f32_32x32x16_bf16 v[16:31], a[192:195], a[56:59], v[16:31]
    ds_read_b64_tr_b16 a[180:181], v215 offset:24576
    ds_read_b64_tr_b16 a[182:183], v215 offset:26624
    v_mfma_f32_32x32x16_bf16 v[16:31], a[196:199], a[60:63], v[16:31]
    ds_read_b64_tr_b16 a[184:185], v212 offset:16640
    ds_read_b64_tr_b16 a[186:187], v212 offset:18688
    s_waitcnt lgkmcnt(6)
    v_mfma_f32_32x32x16_bf16 v[32:47], a[200:203], a[56:59], v[32:47]
    ds_read_b64_tr_b16 a[188:189], v212 offset:24832
    ds_read_b64_tr_b16 a[190:191], v212 offset:26880
    v_mfma_f32_32x32x16_bf16 v[32:47], a[204:207], a[60:63], v[32:47]
    ds_read_b64_tr_b16 a[192:193], v213 offset:16640
    ds_read_b64_tr_b16 a[194:195], v213 offset:18688
    s_waitcnt lgkmcnt(6)
    v_mfma_f32_32x32x16_bf16 v[48:63], a[176:179], a[56:59], v[48:63]
    ds_read_b64_tr_b16 a[196:197], v213 offset:24832
    ds_read_b64_tr_b16 a[198:199], v213 offset:26880
    v_mfma_f32_32x32x16_bf16 v[48:63], a[180:183], a[60:63], v[48:63]
    ds_read_b64_tr_b16 a[200:201], v214 offset:16640
    ds_read_b64_tr_b16 a[202:203], v214 offset:18688
    s_waitcnt lgkmcnt(6)
    v_mfma_f32_32x32x16_bf16 v[64:79], a[184:187], a[56:59], v[64:79]
    ds_read_b64_tr_b16 a[204:205], v214 offset:24832
    ds_read_b64_tr_b16 a[206:207], v214 offset:26880
    v_mfma_f32_32x32x16_bf16 v[64:79], a[188:191], a[60:63], v[64:79]
    ds_read_b64_tr_b16 a[176:177], v212 offset:32768
    ds_read_b64_tr_b16 a[178:179], v212 offset:34816
    s_waitcnt lgkmcnt(6)
    v_mfma_f32_32x32x16_bf16 v[80:95], a[192:195], a[56:59], v[80:95]
    ds_read_b64_tr_b16 a[180:181], v212 offset:40960
    ds_read_b64_tr_b16 a[182:183], v212 offset:43008
    v_mfma_f32_32x32x16_bf16 v[80:95], a[196:199], a[60:63], v[80:95]
    ds_read_b64_tr_b16 a[184:185], v213 offset:32768
    ds_read_b64_tr_b16 a[186:187], v213 offset:34816
    s_waitcnt lgkmcnt(6)
    v_mfma_f32_32x32x16_bf16 v[96:111], a[200:203], a[56:59], v[96:111]
    ds_read_b64_tr_b16 a[188:189], v213 offset:40960
    ds_read_b64_tr_b16 a[190:191], v213 offset:43008
    v_mfma_f32_32x32x16_bf16 v[96:111], a[204:207], a[60:63], v[96:111]
    v_cvt_pk_bf16_f32 v128, v0, v1
    v_cvt_pk_bf16_f32 v129, v2, v3
    v_cvt_pk_bf16_f32 v130, v4, v5
    v_cvt_pk_bf16_f32 v131, v6, v7
    s_add_u32 s38, s47, 0
    buffer_store_dwordx4 v[128:131], v225, s[20:23], s38 offen
    v_cvt_pk_bf16_f32 v132, v8, v9
    v_cvt_pk_bf16_f32 v133, v10, v11
    v_cvt_pk_bf16_f32 v134, v12, v13
    v_cvt_pk_bf16_f32 v135, v14, v15
    s_add_u32 s38, s47, 1024
    buffer_store_dwordx4 v[132:135], v225, s[20:23], s38 offen
    v_cvt_pk_bf16_f32 v136, v16, v17
    v_cvt_pk_bf16_f32 v137, v18, v19
    v_cvt_pk_bf16_f32 v138, v20, v21
    v_cvt_pk_bf16_f32 v139, v22, v23
    s_add_u32 s38, s47, 2048
    buffer_store_dwordx4 v[136:139], v225, s[20:23], s38 offen
    v_cvt_pk_bf16_f32 v140, v24, v25
    v_cvt_pk_bf16_f32 v141, v26, v27
    v_cvt_pk_bf16_f32 v142, v28, v29
    v_cvt_pk_bf16_f32 v143, v30, v31
    s_add_u32 s38, s47, 3072
    buffer_store_dwordx4 v[140:143], v225, s[20:23], s38 offen
    v_cvt_pk_bf16_f32 v144, v32, v33
    v_cvt_pk_bf16_f32 v145, v34, v35
    v_cvt_pk_bf16_f32 v146, v36, v37
    v_cvt_pk_bf16_f32 v147, v38, v39
    s_add_u32 s38, s47, 4096
    buffer_store_dwordx4 v[144:147], v225, s[20:23], s38 offen
    v_cvt_pk_bf16_f32 v148, v40, v41
    v_cvt_pk_bf16_f32 v149, v42, v43
    v_cvt_pk_bf16_f32 v150, v44, v45
    v_cvt_pk_bf16_f32 v151, v46, v47
    s_add_u32 s38, s47, 5120
    buffer_store_dwordx4 v[148:151], v225, s[20:23], s38 offen
    v_cvt_pk_bf16_f32 v152, v48, v49
    v_cvt_pk_bf16_f32 v153, v50, v51
    v_cvt_pk_bf16_f32 v154, v52, v53
    v_cvt_pk_bf16_f32 v155, v54, v55
    s_add_u32 s38, s47, 6144
    buffer_store_dwordx4 v[152:155], v225, s[20:23], s38 offen
    v_cvt_pk_bf16_f32 v156, v56, v57
    v_cvt_pk_bf16_f32 v157, v58, v59
    v_cvt_pk_bf16_f32 v158, v60, v61
    v_cvt_pk_bf16_f32 v159, v62, v63
    s_add_u32 s38, s47, 7168
    buffer_store_dwordx4 v[156:159], v225, s[20:23], s38 offen
    v_cvt_pk_bf16_f32 v128, v64, v65
    v_cvt_pk_bf16_f32 v129, v66, v67
    v_cvt_pk_bf16_f32 v130, v68, v69
    v_cvt_pk_bf16_f32 v131, v70, v71
    s_add_u32 s38, s47, 8192
    buffer_store_dwordx4 v[128:131], v225, s[20:23], s38 offen
    v_cvt_pk_bf16_f32 v132, v72, v73
    v_cvt_pk_bf16_f32 v133, v74, v75
    v_cvt_pk_bf16_f32 v134, v76, v77
    v_cvt_pk_bf16_f32 v135, v78, v79
    s_add_u32 s38, s47, 9216
    buffer_store_dwordx4 v[132:135], v225, s[20:23], s38 offen
    v_cvt_pk_bf16_f32 v136, v80, v81
    v_cvt_pk_bf16_f32 v137, v82, v83
    v_cvt_pk_bf16_f32 v138, v84, v85
    v_cvt_pk_bf16_f32 v139, v86, v87
    s_add_u32 s38, s47, 10240
    buffer_store_dwordx4 v[136:139], v225, s[20:23], s38 offen
    v_cvt_pk_bf16_f32 v140, v88, v89
    v_cvt_pk_bf16_f32 v141, v90, v91
    v_cvt_pk_bf16_f32 v142, v92, v93
    v_cvt_pk_bf16_f32 v143, v94, v95
    s_add_u32 s38, s47, 11264
    buffer_store_dwordx4 v[140:143], v225, s[20:23], s38 offen
    v_cvt_pk_bf16_f32 v144, v96, v97
    v_cvt_pk_bf16_f32 v145, v98, v99
    v_cvt_pk_bf16_f32 v146, v100, v101
    v_cvt_pk_bf16_f32 v147, v102, v103
    s_add_u32 s38, s47, 12288
    buffer_store_dwordx4 v[144:147], v225, s[20:23], s38 offen
    v_cvt_pk_bf16_f32 v148, v104, v105
    v_cvt_pk_bf16_f32 v149, v106, v107
    v_cvt_pk_bf16_f32 v150, v108, v109
    v_cvt_pk_bf16_f32 v151, v110, v111
    s_add_u32 s38, s47, 13312
    buffer_store_dwordx4 v[148:151], v225, s[20:23], s38 offen
    s_barrier
    ds_read_b64_tr_b16 a[192:193], v214 offset:32768
    ds_read_b64_tr_b16 a[194:195], v214 offset:34816
    s_waitcnt lgkmcnt(6)
    v_mfma_f32_32x32x16_bf16 v[0:15], a[176:179], a[0:3], 0
    ds_read_b64_tr_b16 a[196:197], v214 offset:40960
    ds_read_b64_tr_b16 a[198:199], v214 offset:43008
    v_mfma_f32_32x32x16_bf16 v[0:15], a[180:183], a[4:7], v[0:15]
    ds_read_b64_tr_b16 a[200:201], v215 offset:32768
    ds_read_b64_tr_b16 a[202:203], v215 offset:34816
    s_waitcnt lgkmcnt(6)
    v_mfma_f32_32x32x16_bf16 v[16:31], a[184:187], a[0:3], 0
    ds_read_b64_tr_b16 a[204:205], v215 offset:40960
    ds_read_b64_tr_b16 a[206:207], v215 offset:43008
    v_mfma_f32_32x32x16_bf16 v[16:31], a[188:191], a[4:7], v[16:31]
    ds_read_b64_tr_b16 a[176:177], v212 offset:33024
    ds_read_b64_tr_b16 a[178:179], v212 offset:35072
    s_waitcnt lgkmcnt(6)
    v_mfma_f32_32x32x16_bf16 v[32:47], a[192:195], a[0:3], 0
    ds_read_b64_tr_b16 a[180:181], v212 offset:41216
    ds_read_b64_tr_b16 a[182:183], v212 offset:43264
    v_mfma_f32_32x32x16_bf16 v[32:47], a[196:199], a[4:7], v[32:47]
    ds_read_b64_tr_b16 a[184:185], v213 offset:33024
    ds_read_b64_tr_b16 a[186:187], v213 offset:35072
    s_waitcnt lgkmcnt(6)
    v_mfma_f32_32x32x16_bf16 v[48:63], a[200:203], a[0:3], 0
    ds_read_b64_tr_b16 a[188:189], v213 offset:41216
    ds_read_b64_tr_b16 a[190:191], v213 offset:43264
    v_mfma_f32_32x32x16_bf16 v[48:63], a[204:207], a[4:7], v[48:63]
    ds_read_b64_tr_b16 a[192:193], v214 offset:33024
    ds_read_b64_tr_b16 a[194:195], v214 offset:35072
    s_waitcnt lgkmcnt(6)
    v_mfma_f32_32x32x16_bf16 v[64:79], a[176:179], a[0:3], 0
    ds_read_b64_tr_b16 a[196:197], v214 offset:41216
    ds_read_b64_tr_b16 a[198:199], v214 offset:43264
    v_mfma_f32_32x32x16_bf16 v[64:79], a[180:183], a[4:7], v[64:79]
    ds_read_b64_tr_b16 a[200:201], v212 offset:49152
    ds_read_b64_tr_b16 a[202:203], v212 offset:51200
    s_waitcnt lgkmcnt(6)
    v_mfma_f32_32x32x16_bf16 v[80:95], a[184:187], a[0:3], 0
    ds_read_b64_tr_b16 a[204:205], v212 offset:57344
    ds_read_b64_tr_b16 a[206:207], v212 offset:59392
    v_mfma_f32_32x32x16_bf16 v[80:95], a[188:191], a[4:7], v[80:95]
    ds_read_b64_tr_b16 a[176:177], v213 offset:49152
    ds_read_b64_tr_b16 a[178:179], v213 offset:51200
    s_waitcnt lgkmcnt(6)
    v_mfma_f32_32x32x16_bf16 v[96:111], a[192:195], a[0:3], 0
    ds_read_b64_tr_b16 a[180:181], v213 offset:57344
    ds_read_b64_tr_b16 a[182:183], v213 offset:59392
    v_mfma_f32_32x32x16_bf16 v[96:111], a[196:199], a[4:7], v[96:111]
    s_barrier
    ds_read_b64_tr_b16 a[184:185], v214 offset:49152
    ds_read_b64_tr_b16 a[186:187], v214 offset:51200
    s_waitcnt lgkmcnt(6)
    v_mfma_f32_32x32x16_bf16 v[0:15], a[200:203], a[8:11], v[0:15]
    ds_read_b64_tr_b16 a[188:189], v214 offset:57344
    ds_read_b64_tr_b16 a[190:191], v214 offset:59392
    v_mfma_f32_32x32x16_bf16 v[0:15], a[204:207], a[12:15], v[0:15]
    ds_read_b64_tr_b16 a[192:193], v215 offset:49152
    ds_read_b64_tr_b16 a[194:195], v215 offset:51200
    s_waitcnt lgkmcnt(6)
    v_mfma_f32_32x32x16_bf16 v[16:31], a[176:179], a[8:11], v[16:31]
    ds_read_b64_tr_b16 a[196:197], v215 offset:57344
    ds_read_b64_tr_b16 a[198:199], v215 offset:59392
    v_mfma_f32_32x32x16_bf16 v[16:31], a[180:183], a[12:15], v[16:31]
    ds_read_b64_tr_b16 a[200:201], v212 offset:49408
    ds_read_b64_tr_b16 a[202:203], v212 offset:51456
    s_waitcnt lgkmcnt(6)
    v_mfma_f32_32x32x16_bf16 v[32:47], a[184:187], a[8:11], v[32:47]
    ds_read_b64_tr_b16 a[204:205], v212 offset:57600
    ds_read_b64_tr_b16 a[206:207], v212 offset:59648
    v_mfma_f32_32x32x16_bf16 v[32:47], a[188:191], a[12:15], v[32:47]
    ds_read_b64_tr_b16 a[176:177], v213 offset:49408
    ds_read_b64_tr_b16 a[178:179], v213 offset:51456
    s_waitcnt lgkmcnt(6)
    v_mfma_f32_32x32x16_bf16 v[48:63], a[192:195], a[8:11], v[48:63]
    ds_read_b64_tr_b16 a[180:181], v213 offset:57600
    ds_read_b64_tr_b16 a[182:183], v213 offset:59648
    v_mfma_f32_32x32x16_bf16 v[48:63], a[196:199], a[12:15], v[48:63]
    ds_read_b64_tr_b16 a[184:185], v214 offset:49408
    ds_read_b64_tr_b16 a[186:187], v214 offset:51456
    s_waitcnt lgkmcnt(6)
    v_mfma_f32_32x32x16_bf16 v[64:79], a[200:203], a[8:11], v[64:79]
    ds_read_b64_tr_b16 a[188:189], v214 offset:57600
    ds_read_b64_tr_b16 a[190:191], v214 offset:59648
    v_mfma_f32_32x32x16_bf16 v[64:79], a[204:207], a[12:15], v[64:79]
    ds_read_b64_tr_b16 a[192:193], v208
    ds_read_b64_tr_b16 a[194:195], v208 offset:2048
    s_waitcnt lgkmcnt(6)
    v_mfma_f32_32x32x16_bf16 v[80:95], a[176:179], a[8:11], v[80:95]
    ds_read_b64_tr_b16 a[196:197], v208 offset:8192
    ds_read_b64_tr_b16 a[198:199], v208 offset:10240
    v_mfma_f32_32x32x16_bf16 v[80:95], a[180:183], a[12:15], v[80:95]
    ds_read_b64_tr_b16 a[200:201], v209
    ds_read_b64_tr_b16 a[202:203], v209 offset:2048
    s_waitcnt lgkmcnt(6)
    v_mfma_f32_32x32x16_bf16 v[96:111], a[184:187], a[8:11], v[96:111]
    ds_read_b64_tr_b16 a[204:205], v209 offset:8192
    ds_read_b64_tr_b16 a[206:207], v209 offset:10240
    v_mfma_f32_32x32x16_bf16 v[96:111], a[188:191], a[12:15], v[96:111]
    s_barrier
    ds_read_b64_tr_b16 a[176:177], v210
    ds_read_b64_tr_b16 a[178:179], v210 offset:2048
    s_waitcnt lgkmcnt(6)
    v_mfma_f32_32x32x16_bf16 v[0:15], a[192:195], a[16:19], v[0:15]
    ds_read_b64_tr_b16 a[180:181], v210 offset:8192
    ds_read_b64_tr_b16 a[182:183], v210 offset:10240
    v_mfma_f32_32x32x16_bf16 v[0:15], a[196:199], a[20:23], v[0:15]
    ds_read_b64_tr_b16 a[184:185], v211
    ds_read_b64_tr_b16 a[186:187], v211 offset:2048
    s_waitcnt lgkmcnt(6)
    v_mfma_f32_32x32x16_bf16 v[16:31], a[200:203], a[16:19], v[16:31]
    ds_read_b64_tr_b16 a[188:189], v211 offset:8192
    ds_read_b64_tr_b16 a[190:191], v211 offset:10240
    v_mfma_f32_32x32x16_bf16 v[16:31], a[204:207], a[20:23], v[16:31]
    ds_read_b64_tr_b16 a[192:193], v208 offset:256
    ds_read_b64_tr_b16 a[194:195], v208 offset:2304
    s_waitcnt lgkmcnt(6)
    v_mfma_f32_32x32x16_bf16 v[32:47], a[176:179], a[16:19], v[32:47]
    ds_read_b64_tr_b16 a[196:197], v208 offset:8448
    ds_read_b64_tr_b16 a[198:199], v208 offset:10496
    v_mfma_f32_32x32x16_bf16 v[32:47], a[180:183], a[20:23], v[32:47]
    ds_read_b64_tr_b16 a[200:201], v209 offset:256
    ds_read_b64_tr_b16 a[202:203], v209 offset:2304
    s_waitcnt lgkmcnt(6)
    v_mfma_f32_32x32x16_bf16 v[48:63], a[184:187], a[16:19], v[48:63]
    ds_read_b64_tr_b16 a[204:205], v209 offset:8448
    ds_read_b64_tr_b16 a[206:207], v209 offset:10496
    v_mfma_f32_32x32x16_bf16 v[48:63], a[188:191], a[20:23], v[48:63]
    ds_read_b64_tr_b16 a[176:177], v210 offset:256
    ds_read_b64_tr_b16 a[178:179], v210 offset:2304
    s_waitcnt lgkmcnt(6)
    v_mfma_f32_32x32x16_bf16 v[64:79], a[192:195], a[16:19], v[64:79]
    ds_read_b64_tr_b16 a[180:181], v210 offset:8448
    ds_read_b64_tr_b16 a[182:183], v210 offset:10496
    v_mfma_f32_32x32x16_bf16 v[64:79], a[196:199], a[20:23], v[64:79]
    ds_read_b64_tr_b16 a[184:185], v208 offset:16384
    ds_read_b64_tr_b16 a[186:187], v208 offset:18432
    s_waitcnt lgkmcnt(6)
    v_mfma_f32_32x32x16_bf16 v[80:95], a[200:203], a[16:19], v[80:95]
    ds_read_b64_tr_b16 a[188:189], v208 offset:24576
    ds_read_b64_tr_b16 a[190:191], v208 offset:26624
    v_mfma_f32_32x32x16_bf16 v[80:95], a[204:207], a[20:23], v[80:95]
    ds_read_b64_tr_b16 a[192:193], v209 offset:16384
    ds_read_b64_tr_b16 a[194:195], v209 offset:18432
    s_waitcnt lgkmcnt(6)
    v_mfma_f32_32x32x16_bf16 v[96:111], a[176:179], a[16:19], v[96:111]
    ds_read_b64_tr_b16 a[196:197], v209 offset:24576
    ds_read_b64_tr_b16 a[198:199], v209 offset:26624
    v_mfma_f32_32x32x16_bf16 v[96:111], a[180:183], a[20:23], v[96:111]
    s_barrier
    ds_read_b64_tr_b16 a[200:201], v210 offset:16384
    ds_read_b64_tr_b16 a[202:203], v210 offset:18432
    s_waitcnt lgkmcnt(6)
    v_mfma_f32_32x32x16_bf16 v[0:15], a[184:187], a[24:27], v[0:15]
    ds_read_b64_tr_b16 a[204:205], v210 offset:24576
    ds_read_b64_tr_b16 a[206:207], v210 offset:26624
    v_mfma_f32_32x32x16_bf16 v[0:15], a[188:191], a[28:31], v[0:15]
    ds_read_b64_tr_b16 a[176:177], v211 offset:16384
    ds_read_b64_tr_b16 a[178:179], v211 offset:18432
    s_waitcnt lgkmcnt(6)
    v_mfma_f32_32x32x16_bf16 v[16:31], a[192:195], a[24:27], v[16:31]
    ds_read_b64_tr_b16 a[180:181], v211 offset:24576
    ds_read_b64_tr_b16 a[182:183], v211 offset:26624
    v_mfma_f32_32x32x16_bf16 v[16:31], a[196:199], a[28:31], v[16:31]
    ds_read_b64_tr_b16 a[184:185], v208 offset:16640
    ds_read_b64_tr_b16 a[186:187], v208 offset:18688
    s_waitcnt lgkmcnt(6)
    v_mfma_f32_32x32x16_bf16 v[32:47], a[200:203], a[24:27], v[32:47]
    ds_read_b64_tr_b16 a[188:189], v208 offset:24832
    ds_read_b64_tr_b16 a[190:191], v208 offset:26880
    v_mfma_f32_32x32x16_bf16 v[32:47], a[204:207], a[28:31], v[32:47]
    ds_read_b64_tr_b16 a[192:193], v209 offset:16640
    ds_read_b64_tr_b16 a[194:195], v209 offset:18688
    s_waitcnt lgkmcnt(6)
    v_mfma_f32_32x32x16_bf16 v[48:63], a[176:179], a[24:27], v[48:63]
    ds_read_b64_tr_b16 a[196:197], v209 offset:24832
    ds_read_b64_tr_b16 a[198:199], v209 offset:26880
    v_mfma_f32_32x32x16_bf16 v[48:63], a[180:183], a[28:31], v[48:63]
    ds_read_b64_tr_b16 a[200:201], v210 offset:16640
    ds_read_b64_tr_b16 a[202:203], v210 offset:18688
    s_waitcnt lgkmcnt(6)
    v_mfma_f32_32x32x16_bf16 v[64:79], a[184:187], a[24:27], v[64:79]
    ds_read_b64_tr_b16 a[204:205], v210 offset:24832
    ds_read_b64_tr_b16 a[206:207], v210 offset:26880
    v_mfma_f32_32x32x16_bf16 v[64:79], a[188:191], a[28:31], v[64:79]
    ds_read_b64_tr_b16 a[176:177], v208 offset:32768
    ds_read_b64_tr_b16 a[178:179], v208 offset:34816
    s_waitcnt lgkmcnt(6)
    v_mfma_f32_32x32x16_bf16 v[80:95], a[192:195], a[24:27], v[80:95]
    ds_read_b64_tr_b16 a[180:181], v208 offset:40960
    ds_read_b64_tr_b16 a[182:183], v208 offset:43008
    v_mfma_f32_32x32x16_bf16 v[80:95], a[196:199], a[28:31], v[80:95]
    ds_read_b64_tr_b16 a[184:185], v209 offset:32768
    ds_read_b64_tr_b16 a[186:187], v209 offset:34816
    s_waitcnt lgkmcnt(6)
    v_mfma_f32_32x32x16_bf16 v[96:111], a[200:203], a[24:27], v[96:111]
    ds_read_b64_tr_b16 a[188:189], v209 offset:40960
    ds_read_b64_tr_b16 a[190:191], v209 offset:43008
    v_mfma_f32_32x32x16_bf16 v[96:111], a[204:207], a[28:31], v[96:111]
    s_barrier
    ds_read_b64_tr_b16 a[192:193], v210 offset:32768
    ds_read_b64_tr_b16 a[194:195], v210 offset:34816
    s_waitcnt lgkmcnt(6)
    v_mfma_f32_32x32x16_bf16 v[0:15], a[176:179], a[32:35], v[0:15]
    ds_read_b64_tr_b16 a[196:197], v210 offset:40960
    ds_read_b64_tr_b16 a[198:199], v210 offset:43008
    v_mfma_f32_32x32x16_bf16 v[0:15], a[180:183], a[36:39], v[0:15]
    ds_read_b64_tr_b16 a[200:201], v211 offset:32768
    ds_read_b64_tr_b16 a[202:203], v211 offset:34816
    s_waitcnt lgkmcnt(6)
    v_mfma_f32_32x32x16_bf16 v[16:31], a[184:187], a[32:35], v[16:31]
    ds_read_b64_tr_b16 a[204:205], v211 offset:40960
    ds_read_b64_tr_b16 a[206:207], v211 offset:43008
    v_mfma_f32_32x32x16_bf16 v[16:31], a[188:191], a[36:39], v[16:31]
    ds_read_b64_tr_b16 a[176:177], v208 offset:33024
    ds_read_b64_tr_b16 a[178:179], v208 offset:35072
    s_waitcnt lgkmcnt(6)
    v_mfma_f32_32x32x16_bf16 v[32:47], a[192:195], a[32:35], v[32:47]
    ds_read_b64_tr_b16 a[180:181], v208 offset:41216
    ds_read_b64_tr_b16 a[182:183], v208 offset:43264
    v_mfma_f32_32x32x16_bf16 v[32:47], a[196:199], a[36:39], v[32:47]
    ds_read_b64_tr_b16 a[184:185], v209 offset:33024
    ds_read_b64_tr_b16 a[186:187], v209 offset:35072
    s_waitcnt lgkmcnt(6)
    v_mfma_f32_32x32x16_bf16 v[48:63], a[200:203], a[32:35], v[48:63]
    ds_read_b64_tr_b16 a[188:189], v209 offset:41216
    ds_read_b64_tr_b16 a[190:191], v209 offset:43264
    v_mfma_f32_32x32x16_bf16 v[48:63], a[204:207], a[36:39], v[48:63]
    ds_read_b64_tr_b16 a[192:193], v210 offset:33024
    ds_read_b64_tr_b16 a[194:195], v210 offset:35072
    s_waitcnt lgkmcnt(6)
    v_mfma_f32_32x32x16_bf16 v[64:79], a[176:179], a[32:35], v[64:79]
    ds_read_b64_tr_b16 a[196:197], v210 offset:41216
    ds_read_b64_tr_b16 a[198:199], v210 offset:43264
    v_mfma_f32_32x32x16_bf16 v[64:79], a[180:183], a[36:39], v[64:79]
    ds_read_b64_tr_b16 a[200:201], v208 offset:49152
    ds_read_b64_tr_b16 a[202:203], v208 offset:51200
    s_waitcnt lgkmcnt(6)
    v_mfma_f32_32x32x16_bf16 v[80:95], a[184:187], a[32:35], v[80:95]
    ds_read_b64_tr_b16 a[204:205], v208 offset:57344
    ds_read_b64_tr_b16 a[206:207], v208 offset:59392
    v_mfma_f32_32x32x16_bf16 v[80:95], a[188:191], a[36:39], v[80:95]
    ds_read_b64_tr_b16 a[176:177], v209 offset:49152
    ds_read_b64_tr_b16 a[178:179], v209 offset:51200
    s_waitcnt lgkmcnt(6)
    v_mfma_f32_32x32x16_bf16 v[96:111], a[192:195], a[32:35], v[96:111]
    ds_read_b64_tr_b16 a[180:181], v209 offset:57344
    ds_read_b64_tr_b16 a[182:183], v209 offset:59392
    v_mfma_f32_32x32x16_bf16 v[96:111], a[196:199], a[36:39], v[96:111]
    s_barrier
    ds_read_b64_tr_b16 a[184:185], v210 offset:49152
    ds_read_b64_tr_b16 a[186:187], v210 offset:51200
    s_waitcnt lgkmcnt(6)
    v_mfma_f32_32x32x16_bf16 v[0:15], a[200:203], a[40:43], v[0:15]
    ds_read_b64_tr_b16 a[188:189], v210 offset:57344
    ds_read_b64_tr_b16 a[190:191], v210 offset:59392
    v_mfma_f32_32x32x16_bf16 v[0:15], a[204:207], a[44:47], v[0:15]
    ds_read_b64_tr_b16 a[192:193], v211 offset:49152
    ds_read_b64_tr_b16 a[194:195], v211 offset:51200
    s_waitcnt lgkmcnt(6)
    v_mfma_f32_32x32x16_bf16 v[16:31], a[176:179], a[40:43], v[16:31]
    ds_read_b64_tr_b16 a[196:197], v211 offset:57344
    ds_read_b64_tr_b16 a[198:199], v211 offset:59392
    v_mfma_f32_32x32x16_bf16 v[16:31], a[180:183], a[44:47], v[16:31]
    ds_read_b64_tr_b16 a[200:201], v208 offset:49408
    ds_read_b64_tr_b16 a[202:203], v208 offset:51456
    s_waitcnt lgkmcnt(6)
    v_mfma_f32_32x32x16_bf16 v[32:47], a[184:187], a[40:43], v[32:47]
    ds_read_b64_tr_b16 a[204:205], v208 offset:57600
    ds_read_b64_tr_b16 a[206:207], v208 offset:59648
    v_mfma_f32_32x32x16_bf16 v[32:47], a[188:191], a[44:47], v[32:47]
    ds_read_b64_tr_b16 a[176:177], v209 offset:49408
    ds_read_b64_tr_b16 a[178:179], v209 offset:51456
    s_waitcnt lgkmcnt(6)
    v_mfma_f32_32x32x16_bf16 v[48:63], a[192:195], a[40:43], v[48:63]
    ds_read_b64_tr_b16 a[180:181], v209 offset:57600
    ds_read_b64_tr_b16 a[182:183], v209 offset:59648
    v_mfma_f32_32x32x16_bf16 v[48:63], a[196:199], a[44:47], v[48:63]
    ds_read_b64_tr_b16 a[184:185], v210 offset:49408
    ds_read_b64_tr_b16 a[186:187], v210 offset:51456
    s_waitcnt lgkmcnt(6)
    v_mfma_f32_32x32x16_bf16 v[64:79], a[200:203], a[40:43], v[64:79]
    ds_read_b64_tr_b16 a[188:189], v210 offset:57600
    ds_read_b64_tr_b16 a[190:191], v210 offset:59648
    v_mfma_f32_32x32x16_bf16 v[64:79], a[204:207], a[44:47], v[64:79]
    ds_read_b64_tr_b16 a[192:193], v212
    ds_read_b64_tr_b16 a[194:195], v212 offset:2048
    s_waitcnt lgkmcnt(6)
    v_mfma_f32_32x32x16_bf16 v[80:95], a[176:179], a[40:43], v[80:95]
    ds_read_b64_tr_b16 a[196:197], v212 offset:8192
    ds_read_b64_tr_b16 a[198:199], v212 offset:10240
    v_mfma_f32_32x32x16_bf16 v[80:95], a[180:183], a[44:47], v[80:95]
    ds_read_b64_tr_b16 a[200:201], v213
    ds_read_b64_tr_b16 a[202:203], v213 offset:2048
    s_waitcnt lgkmcnt(6)
    v_mfma_f32_32x32x16_bf16 v[96:111], a[184:187], a[40:43], v[96:111]
    ds_read_b64_tr_b16 a[204:205], v213 offset:8192
    ds_read_b64_tr_b16 a[206:207], v213 offset:10240
    v_mfma_f32_32x32x16_bf16 v[96:111], a[188:191], a[44:47], v[96:111]
    s_barrier
    ds_read_b64_tr_b16 a[176:177], v214
    ds_read_b64_tr_b16 a[178:179], v214 offset:2048
    s_waitcnt lgkmcnt(6)
    v_mfma_f32_32x32x16_bf16 v[0:15], a[192:195], a[48:51], v[0:15]
    ds_read_b64_tr_b16 a[180:181], v214 offset:8192
    ds_read_b64_tr_b16 a[182:183], v214 offset:10240
    v_mfma_f32_32x32x16_bf16 v[0:15], a[196:199], a[52:55], v[0:15]
    ds_read_b64_tr_b16 a[184:185], v215
    ds_read_b64_tr_b16 a[186:187], v215 offset:2048
    s_waitcnt lgkmcnt(6)
    v_mfma_f32_32x32x16_bf16 v[16:31], a[200:203], a[48:51], v[16:31]
    ds_read_b64_tr_b16 a[188:189], v215 offset:8192
    ds_read_b64_tr_b16 a[190:191], v215 offset:10240
    v_mfma_f32_32x32x16_bf16 v[16:31], a[204:207], a[52:55], v[16:31]
    ds_read_b64_tr_b16 a[192:193], v212 offset:256
    ds_read_b64_tr_b16 a[194:195], v212 offset:2304
    s_waitcnt lgkmcnt(6)
    v_mfma_f32_32x32x16_bf16 v[32:47], a[176:179], a[48:51], v[32:47]
    ds_read_b64_tr_b16 a[196:197], v212 offset:8448
    ds_read_b64_tr_b16 a[198:199], v212 offset:10496
    v_mfma_f32_32x32x16_bf16 v[32:47], a[180:183], a[52:55], v[32:47]
    ds_read_b64_tr_b16 a[200:201], v213 offset:256
    ds_read_b64_tr_b16 a[202:203], v213 offset:2304
    s_waitcnt lgkmcnt(6)
    v_mfma_f32_32x32x16_bf16 v[48:63], a[184:187], a[48:51], v[48:63]
    ds_read_b64_tr_b16 a[204:205], v213 offset:8448
    ds_read_b64_tr_b16 a[206:207], v213 offset:10496
    v_mfma_f32_32x32x16_bf16 v[48:63], a[188:191], a[52:55], v[48:63]
    ds_read_b64_tr_b16 a[176:177], v214 offset:256
    ds_read_b64_tr_b16 a[178:179], v214 offset:2304
    s_waitcnt lgkmcnt(6)
    v_mfma_f32_32x32x16_bf16 v[64:79], a[192:195], a[48:51], v[64:79]
    ds_read_b64_tr_b16 a[180:181], v214 offset:8448
    ds_read_b64_tr_b16 a[182:183], v214 offset:10496
    v_mfma_f32_32x32x16_bf16 v[64:79], a[196:199], a[52:55], v[64:79]
    ds_read_b64_tr_b16 a[184:185], v212 offset:16384
    ds_read_b64_tr_b16 a[186:187], v212 offset:18432
    s_waitcnt lgkmcnt(6)
    v_mfma_f32_32x32x16_bf16 v[80:95], a[200:203], a[48:51], v[80:95]
    ds_read_b64_tr_b16 a[188:189], v212 offset:24576
    ds_read_b64_tr_b16 a[190:191], v212 offset:26624
    v_mfma_f32_32x32x16_bf16 v[80:95], a[204:207], a[52:55], v[80:95]
    ds_read_b64_tr_b16 a[192:193], v213 offset:16384
    ds_read_b64_tr_b16 a[194:195], v213 offset:18432
    s_waitcnt lgkmcnt(6)
    v_mfma_f32_32x32x16_bf16 v[96:111], a[176:179], a[48:51], v[96:111]
    ds_read_b64_tr_b16 a[196:197], v213 offset:24576
    ds_read_b64_tr_b16 a[198:199], v213 offset:26624
    v_mfma_f32_32x32x16_bf16 v[96:111], a[180:183], a[52:55], v[96:111]
    ds_read_b64_tr_b16 a[200:201], v214 offset:16384
    ds_read_b64_tr_b16 a[202:203], v214 offset:18432
    s_waitcnt lgkmcnt(6)
    v_mfma_f32_32x32x16_bf16 v[0:15], a[184:187], a[56:59], v[0:15]
    ds_read_b64_tr_b16 a[204:205], v214 offset:24576
    ds_read_b64_tr_b16 a[206:207], v214 offset:26624
    v_mfma_f32_32x32x16_bf16 v[0:15], a[188:191], a[60:63], v[0:15]
    ds_read_b64_tr_b16 a[176:177], v215 offset:16384
    ds_read_b64_tr_b16 a[178:179], v215 offset:18432
    s_waitcnt lgkmcnt(6)
    v_mfma_f32_32x32x16_bf16 v[16:31], a[192:195], a[56:59], v[16:31]
    ds_read_b64_tr_b16 a[180:181], v215 offset:24576
    ds_read_b64_tr_b16 a[182:183], v215 offset:26624
    v_mfma_f32_32x32x16_bf16 v[16:31], a[196:199], a[60:63], v[16:31]
    ds_read_b64_tr_b16 a[184:185], v212 offset:16640
    ds_read_b64_tr_b16 a[186:187], v212 offset:18688
    s_waitcnt lgkmcnt(6)
    v_mfma_f32_32x32x16_bf16 v[32:47], a[200:203], a[56:59], v[32:47]
    ds_read_b64_tr_b16 a[188:189], v212 offset:24832
    ds_read_b64_tr_b16 a[190:191], v212 offset:26880
    v_mfma_f32_32x32x16_bf16 v[32:47], a[204:207], a[60:63], v[32:47]
    ds_read_b64_tr_b16 a[192:193], v213 offset:16640
    ds_read_b64_tr_b16 a[194:195], v213 offset:18688
    s_waitcnt lgkmcnt(6)
    v_mfma_f32_32x32x16_bf16 v[48:63], a[176:179], a[56:59], v[48:63]
    ds_read_b64_tr_b16 a[196:197], v213 offset:24832
    ds_read_b64_tr_b16 a[198:199], v213 offset:26880
    v_mfma_f32_32x32x16_bf16 v[48:63], a[180:183], a[60:63], v[48:63]
    ds_read_b64_tr_b16 a[200:201], v214 offset:16640
    ds_read_b64_tr_b16 a[202:203], v214 offset:18688
    s_waitcnt lgkmcnt(6)
    v_mfma_f32_32x32x16_bf16 v[64:79], a[184:187], a[56:59], v[64:79]
    ds_read_b64_tr_b16 a[204:205], v214 offset:24832
    ds_read_b64_tr_b16 a[206:207], v214 offset:26880
    v_mfma_f32_32x32x16_bf16 v[64:79], a[188:191], a[60:63], v[64:79]
    s_waitcnt lgkmcnt(4)
    v_mfma_f32_32x32x16_bf16 v[80:95], a[192:195], a[56:59], v[80:95]
    v_mfma_f32_32x32x16_bf16 v[80:95], a[196:199], a[60:63], v[80:95]
    s_waitcnt lgkmcnt(0)
    v_mfma_f32_32x32x16_bf16 v[96:111], a[200:203], a[56:59], v[96:111]
    v_mfma_f32_32x32x16_bf16 v[96:111], a[204:207], a[60:63], v[96:111]
    v_cvt_pk_bf16_f32 v128, v0, v1
    v_cvt_pk_bf16_f32 v129, v2, v3
    v_cvt_pk_bf16_f32 v130, v4, v5
    v_cvt_pk_bf16_f32 v131, v6, v7
    s_add_u32 s38, s47, 14336
    buffer_store_dwordx4 v[128:131], v225, s[20:23], s38 offen
    v_cvt_pk_bf16_f32 v132, v8, v9
    v_cvt_pk_bf16_f32 v133, v10, v11
    v_cvt_pk_bf16_f32 v134, v12, v13
    v_cvt_pk_bf16_f32 v135, v14, v15
    s_add_u32 s38, s47, 15360
    buffer_store_dwordx4 v[132:135], v225, s[20:23], s38 offen
    v_cvt_pk_bf16_f32 v136, v16, v17
    v_cvt_pk_bf16_f32 v137, v18, v19
    v_cvt_pk_bf16_f32 v138, v20, v21
    v_cvt_pk_bf16_f32 v139, v22, v23
    s_add_u32 s38, s47, 16384
    buffer_store_dwordx4 v[136:139], v225, s[20:23], s38 offen
    v_cvt_pk_bf16_f32 v140, v24, v25
    v_cvt_pk_bf16_f32 v141, v26, v27
    v_cvt_pk_bf16_f32 v142, v28, v29
    v_cvt_pk_bf16_f32 v143, v30, v31
    s_add_u32 s38, s47, 17408
    buffer_store_dwordx4 v[140:143], v225, s[20:23], s38 offen
    v_cvt_pk_bf16_f32 v144, v32, v33
    v_cvt_pk_bf16_f32 v145, v34, v35
    v_cvt_pk_bf16_f32 v146, v36, v37
    v_cvt_pk_bf16_f32 v147, v38, v39
    s_add_u32 s38, s47, 18432
    buffer_store_dwordx4 v[144:147], v225, s[20:23], s38 offen
    v_cvt_pk_bf16_f32 v148, v40, v41
    v_cvt_pk_bf16_f32 v149, v42, v43
    v_cvt_pk_bf16_f32 v150, v44, v45
    v_cvt_pk_bf16_f32 v151, v46, v47
    s_add_u32 s38, s47, 19456
    buffer_store_dwordx4 v[148:151], v225, s[20:23], s38 offen
    v_cvt_pk_bf16_f32 v152, v48, v49
    v_cvt_pk_bf16_f32 v153, v50, v51
    v_cvt_pk_bf16_f32 v154, v52, v53
    v_cvt_pk_bf16_f32 v155, v54, v55
    s_add_u32 s38, s47, 20480
    buffer_store_dwordx4 v[152:155], v225, s[20:23], s38 offen
    v_cvt_pk_bf16_f32 v156, v56, v57
    v_cvt_pk_bf16_f32 v157, v58, v59
    v_cvt_pk_bf16_f32 v158, v60, v61
    v_cvt_pk_bf16_f32 v159, v62, v63
    s_add_u32 s38, s47, 21504
    buffer_store_dwordx4 v[156:159], v225, s[20:23], s38 offen
    v_cvt_pk_bf16_f32 v128, v64, v65
    v_cvt_pk_bf16_f32 v129, v66, v67
    v_cvt_pk_bf16_f32 v130, v68, v69
    v_cvt_pk_bf16_f32 v131, v70, v71
    s_add_u32 s38, s47, 22528
    buffer_store_dwordx4 v[128:131], v225, s[20:23], s38 offen
    v_cvt_pk_bf16_f32 v132, v72, v73
    v_cvt_pk_bf16_f32 v133, v74, v75
    v_cvt_pk_bf16_f32 v134, v76, v77
    v_cvt_pk_bf16_f32 v135, v78, v79
    s_add_u32 s38, s47, 23552
    buffer_store_dwordx4 v[132:135], v225, s[20:23], s38 offen
    v_cvt_pk_bf16_f32 v136, v80, v81
    v_cvt_pk_bf16_f32 v137, v82, v83
    v_cvt_pk_bf16_f32 v138, v84, v85
    v_cvt_pk_bf16_f32 v139, v86, v87
    s_add_u32 s38, s47, 24576
    buffer_store_dwordx4 v[136:139], v225, s[20:23], s38 offen
    v_cvt_pk_bf16_f32 v140, v88, v89
    v_cvt_pk_bf16_f32 v141, v90, v91
    v_cvt_pk_bf16_f32 v142, v92, v93
    v_cvt_pk_bf16_f32 v143, v94, v95
    s_add_u32 s38, s47, 25600
    buffer_store_dwordx4 v[140:143], v225, s[20:23], s38 offen
    v_cvt_pk_bf16_f32 v144, v96, v97
    v_cvt_pk_bf16_f32 v145, v98, v99
    v_cvt_pk_bf16_f32 v146, v100, v101
    v_cvt_pk_bf16_f32 v147, v102, v103
    s_add_u32 s38, s47, 26624
    buffer_store_dwordx4 v[144:147], v225, s[20:23], s38 offen
    v_cvt_pk_bf16_f32 v148, v104, v105
    v_cvt_pk_bf16_f32 v149, v106, v107
    v_cvt_pk_bf16_f32 v150, v108, v109
    v_cvt_pk_bf16_f32 v151, v110, v111
    s_add_u32 s38, s47, 27648
    buffer_store_dwordx4 v[148:151], v225, s[20:23], s38 offen
    s_endpgm
attn_kernel_end:
    s_endpgm
.section .rodata,"a"
.p2align 6
.amdhsa_kernel attn_kernel
  .amdhsa_next_free_vgpr 464
  .amdhsa_next_free_sgpr 96
  .amdhsa_accum_offset 256
  .amdhsa_group_segment_fixed_size 0
  .amdhsa_kernarg_size 64
  .amdhsa_user_sgpr_count 2
  .amdhsa_user_sgpr_kernarg_segment_ptr 1
  .amdhsa_system_sgpr_workgroup_id_x 1
.end_amdhsa_kernel
.text
.globl reduce_kernel
.p2align 8
.type reduce_kernel,@function
reduce_kernel:
    s_cmp_ge_u32 s2, 336
    s_cbranch_scc1 reduce_kernel_end
    s_load_dwordx2 s[40:41], s[0:1], 40
    s_load_dwordx2 s[42:43], s[0:1], 56
    s_lshl_b32 s3, s2, 12
    v_lshlrev_b32 v1, 4, v0
    v_add_u32 v1, s3, v1
    v_lshrrev_b32 v2, 10, v1
    s_mov_b32 s13, 9363
    v_mul_u32_u24 v3, s13, v2
    v_lshrrev_b32 v3, 18, v3
    v_mul_u32_u24 v4, 28, v3
    v_sub_u32 v4, v2, v4
    v_and_b32 v5, 31, v0
    v_lshl_add_u32 v5, v3, 5, v5
    v_mul_u32_u24 v5, 896, v5
    v_lshl_add_u32 v5, v4, 5, v5
    v_bfe_u32 v6, v0, 5, 1
    v_lshl_add_u32 v80, v6, 4, v5
    s_waitcnt lgkmcnt(0)
    s_mov_b32 s4, s40
    s_and_b32 s5, s41, 0xffff
    s_mov_b32 s6, 1376256
    s_mov_b32 s7, 0x00020000
    s_mov_b32 s8, s42
    s_and_b32 s9, s43, 0xffff
    s_mov_b32 s10, 22020096
    s_mov_b32 s11, 0x00020000
    s_mov_b32 s12, 0
    buffer_load_dwordx4 v[8:11], v1, s[8:11], s12 offen
    s_mov_b32 s12, 1376256
    buffer_load_dwordx4 v[12:15], v1, s[8:11], s12 offen
    s_mov_b32 s12, 2752512
    buffer_load_dwordx4 v[16:19], v1, s[8:11], s12 offen
    s_mov_b32 s12, 4128768
    buffer_load_dwordx4 v[20:23], v1, s[8:11], s12 offen
    s_mov_b32 s12, 5505024
    buffer_load_dwordx4 v[24:27], v1, s[8:11], s12 offen
    s_mov_b32 s12, 6881280
    buffer_load_dwordx4 v[28:31], v1, s[8:11], s12 offen
    s_mov_b32 s12, 8257536
    buffer_load_dwordx4 v[32:35], v1, s[8:11], s12 offen
    s_mov_b32 s12, 9633792
    buffer_load_dwordx4 v[36:39], v1, s[8:11], s12 offen
    s_mov_b32 s12, 11010048
    buffer_load_dwordx4 v[40:43], v1, s[8:11], s12 offen
    s_mov_b32 s12, 12386304
    buffer_load_dwordx4 v[44:47], v1, s[8:11], s12 offen
    s_mov_b32 s12, 13762560
    buffer_load_dwordx4 v[48:51], v1, s[8:11], s12 offen
    s_mov_b32 s12, 15138816
    buffer_load_dwordx4 v[52:55], v1, s[8:11], s12 offen
    s_mov_b32 s12, 16515072
    buffer_load_dwordx4 v[56:59], v1, s[8:11], s12 offen
    s_mov_b32 s12, 17891328
    buffer_load_dwordx4 v[60:63], v1, s[8:11], s12 offen
    s_mov_b32 s12, 19267584
    buffer_load_dwordx4 v[64:67], v1, s[8:11], s12 offen
    s_mov_b32 s12, 20643840
    buffer_load_dwordx4 v[68:71], v1, s[8:11], s12 offen
    s_waitcnt vmcnt(15)
    v_lshlrev_b32 v72, 16, v8
    v_and_b32 v73, 0xffff0000, v8
    v_lshlrev_b32 v74, 16, v9
    v_and_b32 v75, 0xffff0000, v9
    v_lshlrev_b32 v76, 16, v10
    v_and_b32 v77, 0xffff0000, v10
    v_lshlrev_b32 v78, 16, v11
    v_and_b32 v79, 0xffff0000, v11
    s_waitcnt vmcnt(14)
    v_lshlrev_b32 v2, 16, v12
    v_and_b32 v3, 0xffff0000, v12
    v_add_f32 v72, v72, v2
    v_add_f32 v73, v73, v3
    v_lshlrev_b32 v2, 16, v13
    v_and_b32 v3, 0xffff0000, v13
    v_add_f32 v74, v74, v2
    v_add_f32 v75, v75, v3
    v_lshlrev_b32 v2, 16, v14
    v_and_b32 v3, 0xffff0000, v14
    v_add_f32 v76, v76, v2
    v_add_f32 v77, v77, v3
    v_lshlrev_b32 v2, 16, v15
    v_and_b32 v3, 0xffff0000, v15
    v_add_f32 v78, v78, v2
    v_add_f32 v79, v79, v3
    s_waitcnt vmcnt(13)
    v_lshlrev_b32 v2, 16, v16
    v_and_b32 v3, 0xffff0000, v16
    v_add_f32 v72, v72, v2
    v_add_f32 v73, v73, v3
    v_lshlrev_b32 v2, 16, v17
    v_and_b32 v3, 0xffff0000, v17
    v_add_f32 v74, v74, v2
    v_add_f32 v75, v75, v3
    v_lshlrev_b32 v2, 16, v18
    v_and_b32 v3, 0xffff0000, v18
    v_add_f32 v76, v76, v2
    v_add_f32 v77, v77, v3
    v_lshlrev_b32 v2, 16, v19
    v_and_b32 v3, 0xffff0000, v19
    v_add_f32 v78, v78, v2
    v_add_f32 v79, v79, v3
    s_waitcnt vmcnt(12)
    v_lshlrev_b32 v2, 16, v20
    v_and_b32 v3, 0xffff0000, v20
    v_add_f32 v72, v72, v2
    v_add_f32 v73, v73, v3
    v_lshlrev_b32 v2, 16, v21
    v_and_b32 v3, 0xffff0000, v21
    v_add_f32 v74, v74, v2
    v_add_f32 v75, v75, v3
    v_lshlrev_b32 v2, 16, v22
    v_and_b32 v3, 0xffff0000, v22
    v_add_f32 v76, v76, v2
    v_add_f32 v77, v77, v3
    v_lshlrev_b32 v2, 16, v23
    v_and_b32 v3, 0xffff0000, v23
    v_add_f32 v78, v78, v2
    v_add_f32 v79, v79, v3
    s_waitcnt vmcnt(11)
    v_lshlrev_b32 v2, 16, v24
    v_and_b32 v3, 0xffff0000, v24
    v_add_f32 v72, v72, v2
    v_add_f32 v73, v73, v3
    v_lshlrev_b32 v2, 16, v25
    v_and_b32 v3, 0xffff0000, v25
    v_add_f32 v74, v74, v2
    v_add_f32 v75, v75, v3
    v_lshlrev_b32 v2, 16, v26
    v_and_b32 v3, 0xffff0000, v26
    v_add_f32 v76, v76, v2
    v_add_f32 v77, v77, v3
    v_lshlrev_b32 v2, 16, v27
    v_and_b32 v3, 0xffff0000, v27
    v_add_f32 v78, v78, v2
    v_add_f32 v79, v79, v3
    s_waitcnt vmcnt(10)
    v_lshlrev_b32 v2, 16, v28
    v_and_b32 v3, 0xffff0000, v28
    v_add_f32 v72, v72, v2
    v_add_f32 v73, v73, v3
    v_lshlrev_b32 v2, 16, v29
    v_and_b32 v3, 0xffff0000, v29
    v_add_f32 v74, v74, v2
    v_add_f32 v75, v75, v3
    v_lshlrev_b32 v2, 16, v30
    v_and_b32 v3, 0xffff0000, v30
    v_add_f32 v76, v76, v2
    v_add_f32 v77, v77, v3
    v_lshlrev_b32 v2, 16, v31
    v_and_b32 v3, 0xffff0000, v31
    v_add_f32 v78, v78, v2
    v_add_f32 v79, v79, v3
    s_waitcnt vmcnt(9)
    v_lshlrev_b32 v2, 16, v32
    v_and_b32 v3, 0xffff0000, v32
    v_add_f32 v72, v72, v2
    v_add_f32 v73, v73, v3
    v_lshlrev_b32 v2, 16, v33
    v_and_b32 v3, 0xffff0000, v33
    v_add_f32 v74, v74, v2
    v_add_f32 v75, v75, v3
    v_lshlrev_b32 v2, 16, v34
    v_and_b32 v3, 0xffff0000, v34
    v_add_f32 v76, v76, v2
    v_add_f32 v77, v77, v3
    v_lshlrev_b32 v2, 16, v35
    v_and_b32 v3, 0xffff0000, v35
    v_add_f32 v78, v78, v2
    v_add_f32 v79, v79, v3
    s_waitcnt vmcnt(8)
    v_lshlrev_b32 v2, 16, v36
    v_and_b32 v3, 0xffff0000, v36
    v_add_f32 v72, v72, v2
    v_add_f32 v73, v73, v3
    v_lshlrev_b32 v2, 16, v37
    v_and_b32 v3, 0xffff0000, v37
    v_add_f32 v74, v74, v2
    v_add_f32 v75, v75, v3
    v_lshlrev_b32 v2, 16, v38
    v_and_b32 v3, 0xffff0000, v38
    v_add_f32 v76, v76, v2
    v_add_f32 v77, v77, v3
    v_lshlrev_b32 v2, 16, v39
    v_and_b32 v3, 0xffff0000, v39
    v_add_f32 v78, v78, v2
    v_add_f32 v79, v79, v3
    s_waitcnt vmcnt(7)
    v_lshlrev_b32 v2, 16, v40
    v_and_b32 v3, 0xffff0000, v40
    v_add_f32 v72, v72, v2
    v_add_f32 v73, v73, v3
    v_lshlrev_b32 v2, 16, v41
    v_and_b32 v3, 0xffff0000, v41
    v_add_f32 v74, v74, v2
    v_add_f32 v75, v75, v3
    v_lshlrev_b32 v2, 16, v42
    v_and_b32 v3, 0xffff0000, v42
    v_add_f32 v76, v76, v2
    v_add_f32 v77, v77, v3
    v_lshlrev_b32 v2, 16, v43
    v_and_b32 v3, 0xffff0000, v43
    v_add_f32 v78, v78, v2
    v_add_f32 v79, v79, v3
    s_waitcnt vmcnt(6)
    v_lshlrev_b32 v2, 16, v44
    v_and_b32 v3, 0xffff0000, v44
    v_add_f32 v72, v72, v2
    v_add_f32 v73, v73, v3
    v_lshlrev_b32 v2, 16, v45
    v_and_b32 v3, 0xffff0000, v45
    v_add_f32 v74, v74, v2
    v_add_f32 v75, v75, v3
    v_lshlrev_b32 v2, 16, v46
    v_and_b32 v3, 0xffff0000, v46
    v_add_f32 v76, v76, v2
    v_add_f32 v77, v77, v3
    v_lshlrev_b32 v2, 16, v47
    v_and_b32 v3, 0xffff0000, v47
    v_add_f32 v78, v78, v2
    v_add_f32 v79, v79, v3
    s_waitcnt vmcnt(5)
    v_lshlrev_b32 v2, 16, v48
    v_and_b32 v3, 0xffff0000, v48
    v_add_f32 v72, v72, v2
    v_add_f32 v73, v73, v3
    v_lshlrev_b32 v2, 16, v49
    v_and_b32 v3, 0xffff0000, v49
    v_add_f32 v74, v74, v2
    v_add_f32 v75, v75, v3
    v_lshlrev_b32 v2, 16, v50
    v_and_b32 v3, 0xffff0000, v50
    v_add_f32 v76, v76, v2
    v_add_f32 v77, v77, v3
    v_lshlrev_b32 v2, 16, v51
    v_and_b32 v3, 0xffff0000, v51
    v_add_f32 v78, v78, v2
    v_add_f32 v79, v79, v3
    s_waitcnt vmcnt(4)
    v_lshlrev_b32 v2, 16, v52
    v_and_b32 v3, 0xffff0000, v52
    v_add_f32 v72, v72, v2
    v_add_f32 v73, v73, v3
    v_lshlrev_b32 v2, 16, v53
    v_and_b32 v3, 0xffff0000, v53
    v_add_f32 v74, v74, v2
    v_add_f32 v75, v75, v3
    v_lshlrev_b32 v2, 16, v54
    v_and_b32 v3, 0xffff0000, v54
    v_add_f32 v76, v76, v2
    v_add_f32 v77, v77, v3
    v_lshlrev_b32 v2, 16, v55
    v_and_b32 v3, 0xffff0000, v55
    v_add_f32 v78, v78, v2
    v_add_f32 v79, v79, v3
    s_waitcnt vmcnt(3)
    v_lshlrev_b32 v2, 16, v56
    v_and_b32 v3, 0xffff0000, v56
    v_add_f32 v72, v72, v2
    v_add_f32 v73, v73, v3
    v_lshlrev_b32 v2, 16, v57
    v_and_b32 v3, 0xffff0000, v57
    v_add_f32 v74, v74, v2
    v_add_f32 v75, v75, v3
    v_lshlrev_b32 v2, 16, v58
    v_and_b32 v3, 0xffff0000, v58
    v_add_f32 v76, v76, v2
    v_add_f32 v77, v77, v3
    v_lshlrev_b32 v2, 16, v59
    v_and_b32 v3, 0xffff0000, v59
    v_add_f32 v78, v78, v2
    v_add_f32 v79, v79, v3
    s_waitcnt vmcnt(2)
    v_lshlrev_b32 v2, 16, v60
    v_and_b32 v3, 0xffff0000, v60
    v_add_f32 v72, v72, v2
    v_add_f32 v73, v73, v3
    v_lshlrev_b32 v2, 16, v61
    v_and_b32 v3, 0xffff0000, v61
    v_add_f32 v74, v74, v2
    v_add_f32 v75, v75, v3
    v_lshlrev_b32 v2, 16, v62
    v_and_b32 v3, 0xffff0000, v62
    v_add_f32 v76, v76, v2
    v_add_f32 v77, v77, v3
    v_lshlrev_b32 v2, 16, v63
    v_and_b32 v3, 0xffff0000, v63
    v_add_f32 v78, v78, v2
    v_add_f32 v79, v79, v3
    s_waitcnt vmcnt(1)
    v_lshlrev_b32 v2, 16, v64
    v_and_b32 v3, 0xffff0000, v64
    v_add_f32 v72, v72, v2
    v_add_f32 v73, v73, v3
    v_lshlrev_b32 v2, 16, v65
    v_and_b32 v3, 0xffff0000, v65
    v_add_f32 v74, v74, v2
    v_add_f32 v75, v75, v3
    v_lshlrev_b32 v2, 16, v66
    v_and_b32 v3, 0xffff0000, v66
    v_add_f32 v76, v76, v2
    v_add_f32 v77, v77, v3
    v_lshlrev_b32 v2, 16, v67
    v_and_b32 v3, 0xffff0000, v67
    v_add_f32 v78, v78, v2
    v_add_f32 v79, v79, v3
    s_waitcnt vmcnt(0)
    v_lshlrev_b32 v2, 16, v68
    v_and_b32 v3, 0xffff0000, v68
    v_add_f32 v72, v72, v2
    v_add_f32 v73, v73, v3
    v_lshlrev_b32 v2, 16, v69
    v_and_b32 v3, 0xffff0000, v69
    v_add_f32 v74, v74, v2
    v_add_f32 v75, v75, v3
    v_lshlrev_b32 v2, 16, v70
    v_and_b32 v3, 0xffff0000, v70
    v_add_f32 v76, v76, v2
    v_add_f32 v77, v77, v3
    v_lshlrev_b32 v2, 16, v71
    v_and_b32 v3, 0xffff0000, v71
    v_add_f32 v78, v78, v2
    v_add_f32 v79, v79, v3
    v_cvt_pk_bf16_f32 v4, v72, v73
    v_cvt_pk_bf16_f32 v5, v74, v75
    v_cvt_pk_bf16_f32 v6, v76, v77
    v_cvt_pk_bf16_f32 v7, v78, v79
    buffer_store_dwordx4 v[4:7], v80, s[4:7], 0 offen
reduce_kernel_end:
    s_endpgm
.section .rodata,"a"
.p2align 6
.amdhsa_kernel reduce_kernel
  .amdhsa_next_free_vgpr 84
  .amdhsa_next_free_sgpr 48
  .amdhsa_accum_offset 84
  .amdhsa_group_segment_fixed_size 0
  .amdhsa_kernarg_size 64
  .amdhsa_user_sgpr_count 2
  .amdhsa_user_sgpr_kernarg_segment_ptr 1
  .amdhsa_system_sgpr_workgroup_id_x 1
.end_amdhsa_kernel
.text
```
